```python
import torch

def _softmax(x, axis=-1):
    return torch.softmax(x, dim=axis)

def _gelu(x):
    return torch.nn.functional.gelu(x, approximate='tanh')

def _silu(x):
    return torch.nn.functional.silu(x)

def _sigmoid(x):
    return torch.sigmoid(x)

def _layernorm(x, axis=-1, eps=1e-05):
    m = x.mean(dim=axis, keepdim=True)
    v = x.var(dim=axis, keepdim=True, unbiased=False)
    return (x - m) / torch.sqrt(v + eps)

def _scatter_add(tgt, idx, src, axis=0):
    return tgt.clone().index_add_(axis, idx, src)

def _segment_sum(src, seg, n):
    out = torch.zeros((n,) + src.shape[1:], dtype=src.dtype)
    return out.index_add_(0, seg, src)

def _pad(x, pw):
    flat = tuple((v for pair in reversed(pw) for v in pair))
    return torch.nn.functional.pad(x, flat)
kernel_name = 'parallel_sum__memory_aug_recurrent_mem_tr__glu_gated_geglu__prompt'

def setup_inputs():

    _w = lambda a: (lambda t: t.to(torch.bfloat16) if t.is_floating_point() else t)(torch.as_tensor(a))

    def _A_setup():
        B, S, Dm = (1, 2048, 576)
        H, Dh = (32, 128)
        M, seg = (8, 32)
        seg = min(seg, S)
        S = S // seg * seg
        return {'x': _w((lambda *s: torch.randn(*s, dtype=torch.bfloat16) * 0.05)(B, S, Dm)), 'mem0': _w((lambda *s: torch.randn(*s, dtype=torch.bfloat16) * 0.2)(B, M, Dm)), 'Wq': _w((lambda *s: torch.randn(*s, dtype=torch.bfloat16) * 1.6)(Dm, H, Dh) * Dm ** (-0.5)), 'Wk': _w((lambda *s: torch.randn(*s, dtype=torch.bfloat16) * 1.6)(Dm, H, Dh) * Dm ** (-0.5)), 'Wv': _w((lambda *s: torch.randn(*s, dtype=torch.bfloat16) * 0.2)(Dm, H, Dh) * Dm ** (-0.5)), 'Wo': _w((lambda *s: torch.randn(*s, dtype=torch.bfloat16) * 0.2)(H, Dh, Dm) * (H * Dh) ** (-0.5)), 'seg_len': seg}
    _A_in = _A_setup()

    def _B_setup():
        B, S, Dm, Df = (1, 2048, 576, 4608)
        return {'x': _w((lambda *s: torch.randn(*s, dtype=torch.bfloat16) * 0.05)(B, S, Dm)), 'w_gate': _w((lambda *s: torch.randn(*s, dtype=torch.bfloat16) * 0.4)(Dm, Df) * Dm ** (-0.5)), 'w_up': _w((lambda *s: torch.randn(*s, dtype=torch.bfloat16) * 0.4)(Dm, Df) * Dm ** (-0.5)), 'w_down': _w((lambda *s: torch.randn(*s, dtype=torch.bfloat16) * 0.4)(Df, Dm) * Df ** (-0.5))}
    _B_in = _B_setup()
    return {'A_x': _A_in['x'], 'A_mem0': _A_in['mem0'], 'A_Wq': _A_in['Wq'], 'A_Wk': _A_in['Wk'], 'A_Wv': _A_in['Wv'], 'A_Wo': _A_in['Wo'], 'A_seg_len': _A_in['seg_len'], 'B_x': _B_in['x'], 'B_w_gate': _B_in['w_gate'], 'B_w_up': _B_in['w_up'], 'B_w_down': _B_in['w_down']}

def reference(A_x, A_mem0, A_Wq, A_Wk, A_Wv, A_Wo, A_seg_len, B_x, B_w_gate, B_w_up, B_w_down):

    def _A_ref(x, mem0, Wq, Wk, Wv, Wo, seg_len):
        B, S, Dm = x.shape
        H, Dh = (Wq.shape[1], Wq.shape[2])
        M = mem0.shape[1]
        scale = Dh ** (-0.5)
        n_seg = S // seg_len
        L = M + seg_len
        idx = torch.arange(L)
        mask = (idx[:, None] < M) | (idx[:, None] >= idx[None, :])
        mem = mem0
        outs = []
        for s in range(n_seg):
            xs = x[:, s * seg_len:(s + 1) * seg_len, :].clone()
            h = torch.concatenate([mem, xs], axis=1)
            q = torch.einsum('btd,dhe->bhte', h, Wq)
            k = torch.einsum('btd,dhe->bhte', h, Wk)
            v = torch.einsum('btd,dhe->bhte', h, Wv)
            scores = torch.einsum('bhqe,bhke->bhqk', q, k) * scale
            scores = torch.where(mask[None, None], scores, -1000000000.0)
            p = _softmax(scores, axis=-1)
            o = torch.einsum('bhqk,bhke->bhqe', p, v)
            o = torch.einsum('bhte,hed->btd', o, Wo)
            mem = o[:, :M, :].clone()
            outs.append(o[:, M:, :])
        return torch.concatenate(outs, axis=1)

    def _B_ref(x, w_gate, w_up, w_down):
        g = torch.einsum('bsd,df->bsf', x, w_gate)
        u = torch.einsum('bsd,df->bsf', x, w_up)
        h = _gelu(g) * u
        return torch.einsum('bsf,fd->bsd', h, w_down)
    x = A_x
    xn = _layernorm(x, axis=-1)
    return x + _A_ref(xn, A_mem0, A_Wq, A_Wk, A_Wv, A_Wo, A_seg_len) + _B_ref(xn, B_w_gate, B_w_up, B_w_down)
```

```asm
; @launch kernel=parallel_sum__memory_aug_recurrent_mem_tr__glu_gated_geglu__prompt_kernel grid=(256,1,1) block=(256,1,1) lds=163840
.amdgcn_target "amdgcn-amd-amdhsa--gfx950"
.text
.globl parallel_sum__memory_aug_recurrent_mem_tr__glu_gated_geglu__prompt_kernel
.p2align 8
.type parallel_sum__memory_aug_recurrent_mem_tr__glu_gated_geglu__prompt_kernel,@function
parallel_sum__memory_aug_recurrent_mem_tr__glu_gated_geglu__prompt_kernel:
    s_cmp_ge_u32 s2, 256
    s_cbranch_scc1 L_main_done
    s_load_dwordx16 s[56:71], s[0:1], 0
    s_load_dwordx8 s[72:79], s[0:1], 64
    s_load_dwordx4 s[80:83], s[0:1], 96
    v_lshrrev_b32 v1, 6, v0
    s_nop 0
    v_readfirstlane_b32 s3, v1
    v_and_b32 v1, 63, v0
    s_waitcnt lgkmcnt(0)
    s_mov_b32 s8, s56
    s_mov_b32 s9, s57
    s_mov_b32 s10, 0x240000
    s_mov_b32 s11, 0x00020000
    s_mov_b32 s12, s58
    s_mov_b32 s13, s59
    s_mov_b32 s14, 0x2400
    s_mov_b32 s15, 0x00020000
    s_mov_b32 s16, s60
    s_mov_b32 s17, s61
    s_mov_b32 s18, 0x480000
    s_mov_b32 s19, 0x00020000
    s_mov_b32 s20, s62
    s_mov_b32 s21, s63
    s_mov_b32 s22, 0x480000
    s_mov_b32 s23, 0x00020000
    s_mov_b32 s24, s64
    s_mov_b32 s25, s65
    s_mov_b32 s26, 0x480000
    s_mov_b32 s27, 0x00020000
    s_mov_b32 s28, s66
    s_mov_b32 s29, s67
    s_mov_b32 s30, 0x480000
    s_mov_b32 s31, 0x00020000
    s_mov_b32 s32, s72
    s_mov_b32 s33, s73
    s_mov_b32 s34, 0x510000
    s_mov_b32 s35, 0x00020000
    s_mov_b32 s36, s74
    s_mov_b32 s37, s75
    s_mov_b32 s38, 0x510000
    s_mov_b32 s39, 0x00020000
    s_mov_b32 s40, s76
    s_mov_b32 s41, s77
    s_mov_b32 s42, 0x510000
    s_mov_b32 s43, 0x00020000
    s_mov_b32 s44, s78
    s_mov_b32 s45, s79
    s_mov_b32 s46, 0x240000
    s_mov_b32 s47, 0x00020000
    s_mov_b32 s48, s80
    s_mov_b32 s49, s81
    s_mov_b32 s50, 0x100
    s_mov_b32 s51, 0x00020000
    s_mov_b32 s52, s82
    s_mov_b32 s53, s83
    s_mov_b32 s54, 0x10000000
    s_mov_b32 s55, 0x00020000
    s_mov_b32 s81, 0x200000
    s_getreg_b32 s84, hwreg(HW_REG_XCC_ID)
    s_and_b32 s84, s84, 15
    s_add_u32 s84, s84, 1
    v_mov_b32 v2, 0
    v_mov_b32 v6, 0
    s_cmp_lg_u32 s3, 0
    s_nop 0
    s_cbranch_scc1 L_m_wait
    s_mov_b64 exec, 1
    s_cmp_lg_u32 s84, 1
    s_cbranch_scc1 L_m_worker
    v_mov_b32 v4, 1
    buffer_atomic_add v4, v2, s[48:51], 0 offen offset:128 sc0
    s_waitcnt vmcnt(0)
    v_readfirstlane_b32 s85, v4
    s_nop 0
    s_cmp_lt_u32 s85, 32
    s_nop 2
    s_cbranch_scc1 L_m_pub
L_m_worker:
    v_mov_b32 v4, 1
    buffer_atomic_add v4, v2, s[48:51], 0 offen offset:16 sc0
    s_waitcnt vmcnt(0)
    v_readfirstlane_b32 s85, v4
    v_add_u32 v4, 32, v4
    s_cmp_lt_u32 s85, 224
    s_nop 2
    s_cbranch_scc1 L_m_pub
    v_mov_b32 v4, 1
    buffer_atomic_add v4, v2, s[48:51], 0 offen offset:196 sc0
    s_waitcnt vmcnt(0)
    v_mov_b32 v4, 1
    buffer_atomic_add v4, v2, s[48:51], 0 offen offset:128 sc0
    s_waitcnt vmcnt(0)
L_m_pub:
    ds_write_b32 v6, v4
    s_mov_b64 exec, -1
    s_waitcnt lgkmcnt(0)
L_m_wait:
    s_barrier
    ds_read_b32 v4, v6
    s_waitcnt lgkmcnt(0)
    v_readfirstlane_b32 s4, v4
    s_barrier
    s_cmp_ge_u32 s4, 32
    s_nop 2
    s_cbranch_scc1 L_m_work
    v_mov_b32 v31, v1
    v_lshlrev_b32 v0, 4, v31
    v_lshrrev_b32 v16, 4, v31
    v_bfe_u32 v17, v31, 2, 2
    v_and_b32 v18, 3, v31
    v_and_b32 v19, 15, v31
    v_lshrrev_b32 v21, 5, v31
    v_and_b32 v22, 1, v16
    v_and_b32 v28, 7, v31
    v_bfe_u32 v29, v31, 3, 1
    s_lshl_b32 s84, s3, 10
    s_add_u32 s84, s84, 149504
    v_lshlrev_b32 v2, 4, v19
    v_lshl_add_u32 v2, v16, 2, v2
    v_add_u32 v2, s84, v2
    v_lshl_add_u32 v20, v16, 3, v17
    v_lshlrev_b32 v20, 4, v20
    v_add_u32 v20, s84, v20
    v_and_b32 v23, 1, v18
    v_lshl_add_u32 v3, v23, 3, v20
    v_add_u32 v8, s84, v0
    v_add_u32 v7, 147456, v0
    v_cmp_lt_u32 s[74:75], 7, v19
    v_cmp_eq_u32 s[76:77], 1, v21
    v_cmp_eq_u32 s[62:63], 0, v18
    v_cmp_eq_u32 s[64:65], 1, v18
    v_cmp_eq_u32 s[66:67], 2, v18
    v_cmp_eq_u32 s[78:79], 3, v18
    v_mov_b32 v4, 0x4444
    v_mov_b32 v23, 0xeeee
    v_and_b32 v24, 2, v31
    v_cmp_eq_u32 vcc, 2, v24
    s_nop 1
    v_cndmask_b32 v4, v4, v23, vcc
    v_lshlrev_b32 v23, 4, v28
    v_add_u32 v23, 153600, v23
    v_lshl_add_u32 v10, v21, 7, v23
    v_lshl_add_u32 v10, v22, 3, v10
    s_lshl_b32 s85, s3, 8
    v_lshl_add_u32 v9, v22, 7, v23
    v_lshl_add_u32 v9, v21, 3, v9
    v_lshl_add_u32 v9, v29, 2, v9
    v_add_u32 v9, s85, v9
    s_mul_i32 s84, s4, 9216
    s_mul_i32 s85, s3, 2304
    s_add_u32 s56, s84, s85
    s_add_u32 s56, s56, 0x8000000
    s_lshl_b32 s84, s3, 5
    s_add_u32 s84, s84, s4
    s_cmp_lt_u32 s84, 72
    s_cselect_b32 s101, 1, 0
    s_min_u32 s84, s84, 71
    s_lshl_b32 s60, s84, 7
    s_mul_i32 s85, s84, 3641
    s_lshr_b32 s85, s85, 16
    s_mul_i32 s86, s85, 18
    s_sub_u32 s86, s84, s86
    s_lshr_b32 s87, s86, 3
    s_lshl_b32 s61, s87, 12
    s_lshl_b32 s92, s87, 8
    s_lshl_b32 s87, s85, 10
    s_add_u32 s61, s61, s87
    s_and_b32 s87, s86, 1
    s_lshl_b32 s93, s87, 3
    s_add_u32 s92, s92, s93
    s_lshl_b32 s87, s87, 9
    s_add_u32 s61, s61, s87
    s_bfe_u32 s94, s86, 0x20001
    s_lshl_b32 s87, s94, 6
    s_add_u32 s61, s61, s87
    s_sub_u32 s87, s86, 16
    s_lshl_b32 s95, s87, 1
    s_lshl_b32 s87, s87, 7
    s_lshl_b32 s93, s85, 8
    s_add_u32 s87, s87, s93
    s_add_u32 s87, s87, 8192
    s_cmp_lt_u32 s86, 16
    s_cselect_b32 s61, s61, s87
    s_cselect_b32 s97, 256, 64
    s_cselect_b32 s92, s92, 512
    s_cselect_b32 s94, s94, s95
    s_cselect_b32 s95, 128, 2
    s_cselect_b64 vcc, -1, 0
    s_lshl_b32 s87, s85, 4
    s_add_u32 s92, s92, s87
    v_bfe_u32 v23, v31, 2, 1
    v_mul_u32_u24 v1, s97, v23
    v_bfe_u32 v24, v31, 1, 1
    v_lshl_add_u32 v1, v24, 3, v1
    v_and_b32 v24, 1, v31
    v_lshl_add_u32 v1, v24, 5, v1
    v_lshl_add_u32 v1, v22, 4, v1
    v_add_u32 v1, s61, v1
    v_lshlrev_b32 v33, 2, v18
    v_cndmask_b32 v32, v33, v28, vcc
    v_add_u32 v32, s92, v32
    v_cndmask_b32 v34, v23, 0, vcc
    v_add_u32 v34, s94, v34
    v_lshl_add_u32 v34, v34, 1, v22
    v_mul_u32_u24 v34, 1152, v34
    v_lshl_add_u32 v32, v32, 1, v34
    v_add_u32 v33, s95, v32
    v_add_u32 v34, s95, v33
    v_add_u32 v35, s95, v34
    s_mov_b32 s88, 0x8000000
    s_mov_b32 s89, 0x8012000
    s_mov_b32 s90, 0x8024000
    s_mov_b32 s91, 0x8036000
    s_mul_i32 s84, s3, 36864
    v_add_u32 v5, s84, v0
    s_lshr_b32 s84, s3, 1
    s_lshl_b32 s84, s84, 10
    s_and_b32 s85, s3, 1
    s_lshl_b32 s85, s85, 3
    s_add_u32 s84, s84, s85
    s_add_u32 s84, s84, 147456
    v_lshrrev_b32 v23, 1, v28
    v_and_b32 v24, 1, v28
    v_lshl_add_u32 v6, v23, 2, v24
    v_lshl_add_u32 v6, v29, 1, v6
    v_lshl_add_u32 v6, v16, 4, v6
    v_lshlrev_b32 v6, 4, v6
    v_add_u32 v6, s84, v6
    s_mov_b32 s80, 0x3e0293ee
    s_mov_b32 s5, 0
    s_mov_b32 s69, 0x8100000
    s_mov_b32 s70, 0x8102400
    s_mov_b32 s71, 0
    s_lshl_b32 s72, s4, 13
    s_lshl_b32 s73, s4, 12
    s_mov_b32 s81, 0x200000
    s_lshl_b32 s57, s3, 10
    s_add_u32 s57, s57, 0x1800000
    s_lshl_b32 s58, s3, 11
    s_add_u32 s58, s58, 0x2c00000
    s_lshl_b32 s59, s3, 10
    s_add_u32 s82, s59, 0x5400000
    s_add_u32 s59, s59, 0x7400000
    s_lshl_b32 s68, s3, 12
    s_and_b32 s68, s68, 4096
    s_cmp_lt_u32 s3, 2
    s_cselect_b32 s85, 0, 0x1400000
    s_add_u32 s68, s68, s85
    s_add_u32 s68, s68, 0x1800000
    v_lshrrev_b32 v37, 7, v0
    v_mul_u32_u24 v36, 9216, v37
    v_and_b32 v37, 112, v0
    v_add3_u32 v36, v36, v37, s60
    v_mov_b32 v56, -1
    v_mov_b32 v57, -1
    v_mov_b32 v58, -1
    v_mov_b32 v59, -1
    buffer_load_ushort v60, v32, s[12:15], 0 offen
    buffer_load_ushort v61, v33, s[12:15], 0 offen
    buffer_load_ushort v62, v34, s[12:15], 0 offen
    buffer_load_ushort v63, v35, s[12:15], 0 offen
    buffer_store_dwordx4 v[56:59], v36, s[52:55], s88 offen sc1
    buffer_store_dwordx4 v[56:59], v36, s[52:55], s89 offen sc1
    buffer_store_dwordx4 v[56:59], v36, s[52:55], s90 offen sc1
    buffer_store_dwordx4 v[56:59], v36, s[52:55], s91 offen sc1
    buffer_store_dwordx2 v[56:57], v1, s[52:55], s70 offen sc1
    s_add_u32 s84, s70, 9216
    buffer_store_dwordx2 v[56:57], v1, s[52:55], s84 offen sc1
    s_add_u32 s84, s73, 8257536
    s_add_u32 s85, s84, s59
    buffer_store_dwordx4 v[56:59], v0, s[52:55], s85 offen sc1
    s_add_u32 s85, s84, s82
    buffer_store_dwordx4 v[56:59], v0, s[52:55], s85 offen sc1
    v_lshrrev_b32 v16, 4, v31
    s_and_b32 s84, s3, 1
    s_lshl_b32 s84, s84, 2
    v_or_b32 v17, s84, v16
    v_bfe_u32 v18, v31, 1, 3
    v_xor_b32 v18, v18, v17
    v_lshlrev_b32 v18, 5, v18
    v_and_b32 v19, 1, v31
    v_lshl_add_u32 v18, v19, 4, v18
    v_lshl_add_u32 v20, v16, 13, v18
    v_lshl_add_u32 v49, v16, 15, v18
    v_lshrrev_b32 v16, 2, v31
    v_and_b32 v17, 3, v31
    v_lshlrev_b32 v17, 4, v17
    v_lshl_add_u32 v51, v16, 13, v17
    v_lshl_add_u32 v52, v16, 15, v17
    v_lshrrev_b32 v16, 3, v31
    v_mul_u32_u24 v21, 1152, v16
    v_lshl_add_u32 v21, v19, 4, v21
    v_bfe_u32 v18, v31, 1, 2
    s_and_b32 s84, s3, 1
    s_lshl_b32 s84, s84, 1
    v_xor_b32 v18, s84, v18
    v_lshl_add_u32 v22, v18, 5, v21
    v_xor_b32 v18, 1, v18
    v_lshl_add_u32 v23, v18, 5, v21
    v_bfe_u32 v16, v31, 4, 1
    v_lshrrev_b32 v17, 5, v31
    v_bfe_u32 v18, v31, 2, 2
    v_and_b32 v19, 3, v31
    v_lshrrev_b32 v26, 1, v18
    v_and_b32 v28, 1, v18
    v_lshl_add_u32 v25, v16, 1, v26
    v_lshl_add_u32 v24, v17, 2, v25
    v_lshl_add_u32 v53, v28, 4, v24
    v_lshlrev_b32 v53, 6, v53
    v_lshl_add_u32 v53, v19, 3, v53
    s_mul_i32 s85, s3, 36864
    v_add_u32 v53, s85, v53
    v_lshlrev_b32 v24, 8, v24
    v_lshl_add_u32 v24, v19, 3, v24
    s_mov_b32 s85, 36864
    v_mad_u32_u24 v24, s85, v28, v24
    v_lshl_add_u32 v25, v28, 2, v25
    s_lshl_b32 s85, s3, 1
    v_xor_b32 v25, s85, v25
    v_lshl_add_u32 v24, v25, 5, v24
    v_xor_b32 v25, 32, v24
    v_lshl_add_u32 v27, v16, 1, v26
    v_lshl_add_u32 v28, v27, 4, v28
    v_lshl_add_u32 v28, v17, 2, v28
    v_and_b32 v28, 31, v28
    v_lshlrev_b32 v28, 7, v28
    v_lshl_add_u32 v28, v19, 3, v28
    s_mov_b32 s85, 36864
    v_mad_u32_u24 v28, s85, v16, v28
    v_xor_b32 v27, s3, v27
    v_lshl_add_u32 v26, v27, 5, v28
    s_lshl_b32 s84, s4, 8
    s_lshl_b32 s86, s3, 19
    s_add_u32 s86, s86, s84
    s_lshl_b32 s95, s3, 13
    s_add_u32 s95, s95, s84
    s_mul_i32 s92, s4, 147456
    s_mul_i32 s87, s3, 36864
    s_add_u32 s92, s92, s87
    s_mul_i32 s93, s3, 36864
    s_lshl_b32 s96, s3, 6
    s_add_u32 s96, s96, s84
    s_add_u32 m0, s93, 0
    s_add_u32 s94, s86, 0
    buffer_load_dwordx4 v20, s[16:19], s94 offen lds
    s_add_u32 m0, s93, 1024
    s_add_u32 s94, s86, 32768
    buffer_load_dwordx4 v20, s[16:19], s94 offen lds
    s_add_u32 m0, s93, 2048
    s_add_u32 s94, s86, 65536
    buffer_load_dwordx4 v20, s[16:19], s94 offen lds
    s_add_u32 m0, s93, 3072
    s_add_u32 s94, s86, 98304
    buffer_load_dwordx4 v20, s[16:19], s94 offen lds
    s_add_u32 m0, s93, 4096
    s_add_u32 s94, s86, 131072
    buffer_load_dwordx4 v20, s[16:19], s94 offen lds
    s_add_u32 m0, s93, 5120
    s_add_u32 s94, s86, 163840
    buffer_load_dwordx4 v20, s[16:19], s94 offen lds
    s_add_u32 m0, s93, 6144
    s_add_u32 s94, s86, 196608
    buffer_load_dwordx4 v20, s[16:19], s94 offen lds
    s_add_u32 m0, s93, 7168
    s_add_u32 s94, s86, 229376
    buffer_load_dwordx4 v20, s[16:19], s94 offen lds
    s_add_u32 m0, s93, 8192
    s_add_u32 s94, s86, 262144
    buffer_load_dwordx4 v20, s[16:19], s94 offen lds
    s_add_u32 m0, s93, 9216
    s_add_u32 s94, s86, 294912
    buffer_load_dwordx4 v20, s[16:19], s94 offen lds
    s_add_u32 m0, s93, 10240
    s_add_u32 s94, s86, 327680
    buffer_load_dwordx4 v20, s[16:19], s94 offen lds
    s_add_u32 m0, s93, 11264
    s_add_u32 s94, s86, 360448
    buffer_load_dwordx4 v20, s[16:19], s94 offen lds
    s_add_u32 m0, s93, 12288
    s_add_u32 s94, s86, 393216
    buffer_load_dwordx4 v20, s[16:19], s94 offen lds
    s_add_u32 m0, s93, 13312
    s_add_u32 s94, s86, 425984
    buffer_load_dwordx4 v20, s[16:19], s94 offen lds
    s_add_u32 m0, s93, 14336
    s_add_u32 s94, s86, 458752
    buffer_load_dwordx4 v20, s[16:19], s94 offen lds
    s_add_u32 m0, s93, 15360
    s_add_u32 s94, s86, 491520
    buffer_load_dwordx4 v20, s[16:19], s94 offen lds
    s_add_u32 m0, s93, 16384
    s_add_u32 s94, s86, 2097152
    buffer_load_dwordx4 v20, s[16:19], s94 offen lds
    s_add_u32 m0, s93, 17408
    s_add_u32 s94, s86, 2129920
    buffer_load_dwordx4 v20, s[16:19], s94 offen lds
    s_add_u32 m0, s93, 18432
    s_add_u32 s94, s86, 2162688
    buffer_load_dwordx4 v20, s[16:19], s94 offen lds
    s_add_u32 m0, s93, 19456
    s_add_u32 s94, s86, 2195456
    buffer_load_dwordx4 v20, s[16:19], s94 offen lds
    s_add_u32 m0, s93, 20480
    s_add_u32 s94, s86, 2228224
    buffer_load_dwordx4 v20, s[16:19], s94 offen lds
    s_add_u32 m0, s93, 21504
    s_add_u32 s94, s86, 2260992
    buffer_load_dwordx4 v20, s[16:19], s94 offen lds
    s_add_u32 m0, s93, 22528
    s_add_u32 s94, s86, 2293760
    buffer_load_dwordx4 v20, s[16:19], s94 offen lds
    s_add_u32 m0, s93, 23552
    s_add_u32 s94, s86, 2326528
    buffer_load_dwordx4 v20, s[16:19], s94 offen lds
    s_add_u32 m0, s93, 24576
    s_add_u32 s94, s86, 2359296
    buffer_load_dwordx4 v20, s[16:19], s94 offen lds
    s_add_u32 m0, s93, 25600
    s_add_u32 s94, s86, 2392064
    buffer_load_dwordx4 v20, s[16:19], s94 offen lds
    s_add_u32 m0, s93, 26624
    s_add_u32 s94, s86, 2424832
    buffer_load_dwordx4 v20, s[16:19], s94 offen lds
    s_add_u32 m0, s93, 27648
    s_add_u32 s94, s86, 2457600
    buffer_load_dwordx4 v20, s[16:19], s94 offen lds
    s_add_u32 m0, s93, 28672
    s_add_u32 s94, s86, 2490368
    buffer_load_dwordx4 v20, s[16:19], s94 offen lds
    s_add_u32 m0, s93, 29696
    s_add_u32 s94, s86, 2523136
    buffer_load_dwordx4 v20, s[16:19], s94 offen lds
    s_add_u32 m0, s93, 30720
    s_add_u32 s94, s86, 2555904
    buffer_load_dwordx4 v20, s[16:19], s94 offen lds
    s_add_u32 m0, s93, 31744
    s_add_u32 s94, s86, 2588672
    buffer_load_dwordx4 v20, s[16:19], s94 offen lds
    s_add_u32 m0, s93, 32768
    s_add_u32 s94, s95, 4194304
    buffer_load_dwordx4 v49, s[16:19], s94 offen lds
    s_add_u32 m0, s93, 33792
    s_add_u32 s94, s95, 4325376
    buffer_load_dwordx4 v49, s[16:19], s94 offen lds
    s_add_u32 m0, s93, 34816
    s_add_u32 s94, s95, 4456448
    buffer_load_dwordx4 v49, s[16:19], s94 offen lds
    s_add_u32 m0, s93, 35840
    s_add_u32 s94, s95, 4587520
    buffer_load_dwordx4 v49, s[16:19], s94 offen lds
    s_waitcnt vmcnt(32)
    s_barrier
    v_add_u32 v29, 0, v24
    v_add_u32 v30, 0, v25
    v_add_u32 v54, 73728, v24
    v_add_u32 v55, 73728, v25
    ds_read_b64_tr_b16 a[0:1], v29 offset:0
    ds_read_b64_tr_b16 a[2:3], v54 offset:0
    ds_read_b64_tr_b16 a[4:5], v29 offset:2048
    ds_read_b64_tr_b16 a[6:7], v54 offset:2048
    ds_read_b64_tr_b16 a[72:73], v30 offset:0
    ds_read_b64_tr_b16 a[74:75], v55 offset:0
    ds_read_b64_tr_b16 a[76:77], v30 offset:2048
    ds_read_b64_tr_b16 a[78:79], v55 offset:2048
    s_waitcnt lgkmcnt(0)
    s_barrier
    s_add_u32 m0, s93, 0
    s_add_u32 s94, s86, 0
    buffer_load_dwordx4 v20, s[20:23], s94 offen lds
    s_add_u32 m0, s93, 1024
    s_add_u32 s94, s86, 32768
    buffer_load_dwordx4 v20, s[20:23], s94 offen lds
    s_add_u32 m0, s93, 2048
    s_add_u32 s94, s86, 65536
    buffer_load_dwordx4 v20, s[20:23], s94 offen lds
    s_add_u32 m0, s93, 3072
    s_add_u32 s94, s86, 98304
    buffer_load_dwordx4 v20, s[20:23], s94 offen lds
    v_lshl_or_b32 v60, v61, 16, v60
    v_lshl_or_b32 v61, v63, 16, v62
    v_min_u32 v60, -2, v60
    v_min_u32 v61, -2, v61
    buffer_store_dwordx2 v[60:61], v1, s[52:55], s69 offen sc1
    s_waitcnt vmcnt(33)
    s_barrier
    v_add_u32 v29, 4096, v24
    v_add_u32 v30, 4096, v25
    v_add_u32 v54, 77824, v24
    v_add_u32 v55, 77824, v25
    ds_read_b64_tr_b16 a[8:9], v29 offset:0
    ds_read_b64_tr_b16 a[10:11], v54 offset:0
    ds_read_b64_tr_b16 a[12:13], v29 offset:2048
    ds_read_b64_tr_b16 a[14:15], v54 offset:2048
    ds_read_b64_tr_b16 a[80:81], v30 offset:0
    ds_read_b64_tr_b16 a[82:83], v55 offset:0
    ds_read_b64_tr_b16 a[84:85], v30 offset:2048
    ds_read_b64_tr_b16 a[86:87], v55 offset:2048
    s_waitcnt lgkmcnt(0)
    s_barrier
    s_add_u32 m0, s93, 4096
    s_add_u32 s94, s86, 131072
    buffer_load_dwordx4 v20, s[20:23], s94 offen lds
    s_add_u32 m0, s93, 5120
    s_add_u32 s94, s86, 163840
    buffer_load_dwordx4 v20, s[20:23], s94 offen lds
    s_add_u32 m0, s93, 6144
    s_add_u32 s94, s86, 196608
    buffer_load_dwordx4 v20, s[20:23], s94 offen lds
    s_add_u32 m0, s93, 7168
    s_add_u32 s94, s86, 229376
    buffer_load_dwordx4 v20, s[20:23], s94 offen lds
    s_waitcnt vmcnt(33)
    s_barrier
    v_add_u32 v29, 8192, v24
    v_add_u32 v30, 8192, v25
    v_add_u32 v54, 81920, v24
    v_add_u32 v55, 81920, v25
    ds_read_b64_tr_b16 a[16:17], v29 offset:0
    ds_read_b64_tr_b16 a[18:19], v54 offset:0
    ds_read_b64_tr_b16 a[20:21], v29 offset:2048
    ds_read_b64_tr_b16 a[22:23], v54 offset:2048
    ds_read_b64_tr_b16 a[88:89], v30 offset:0
    ds_read_b64_tr_b16 a[90:91], v55 offset:0
    ds_read_b64_tr_b16 a[92:93], v30 offset:2048
    ds_read_b64_tr_b16 a[94:95], v55 offset:2048
    s_waitcnt lgkmcnt(0)
    s_barrier
    s_add_u32 m0, s93, 8192
    s_add_u32 s94, s86, 262144
    buffer_load_dwordx4 v20, s[20:23], s94 offen lds
    s_add_u32 m0, s93, 9216
    s_add_u32 s94, s86, 294912
    buffer_load_dwordx4 v20, s[20:23], s94 offen lds
    s_add_u32 m0, s93, 10240
    s_add_u32 s94, s86, 327680
    buffer_load_dwordx4 v20, s[20:23], s94 offen lds
    s_add_u32 m0, s93, 11264
    s_add_u32 s94, s86, 360448
    buffer_load_dwordx4 v20, s[20:23], s94 offen lds
    s_waitcnt vmcnt(33)
    s_barrier
    v_add_u32 v29, 12288, v24
    v_add_u32 v30, 12288, v25
    v_add_u32 v54, 86016, v24
    v_add_u32 v55, 86016, v25
    ds_read_b64_tr_b16 a[24:25], v29 offset:0
    ds_read_b64_tr_b16 a[26:27], v54 offset:0
    ds_read_b64_tr_b16 a[28:29], v29 offset:2048
    ds_read_b64_tr_b16 a[30:31], v54 offset:2048
    ds_read_b64_tr_b16 a[96:97], v30 offset:0
    ds_read_b64_tr_b16 a[98:99], v55 offset:0
    ds_read_b64_tr_b16 a[100:101], v30 offset:2048
    ds_read_b64_tr_b16 a[102:103], v55 offset:2048
    s_waitcnt lgkmcnt(0)
    s_barrier
    s_add_u32 m0, s93, 12288
    s_add_u32 s94, s86, 393216
    buffer_load_dwordx4 v20, s[20:23], s94 offen lds
    s_add_u32 m0, s93, 13312
    s_add_u32 s94, s86, 425984
    buffer_load_dwordx4 v20, s[20:23], s94 offen lds
    s_add_u32 m0, s93, 14336
    s_add_u32 s94, s86, 458752
    buffer_load_dwordx4 v20, s[20:23], s94 offen lds
    s_add_u32 m0, s93, 15360
    s_add_u32 s94, s86, 491520
    buffer_load_dwordx4 v20, s[20:23], s94 offen lds
    s_waitcnt vmcnt(33)
    s_barrier
    v_add_u32 v29, 16384, v24
    v_add_u32 v30, 16384, v25
    v_add_u32 v54, 90112, v24
    v_add_u32 v55, 90112, v25
    ds_read_b64_tr_b16 a[32:33], v29 offset:0
    ds_read_b64_tr_b16 a[34:35], v54 offset:0
    ds_read_b64_tr_b16 a[36:37], v29 offset:2048
    ds_read_b64_tr_b16 a[38:39], v54 offset:2048
    ds_read_b64_tr_b16 a[104:105], v30 offset:0
    ds_read_b64_tr_b16 a[106:107], v55 offset:0
    ds_read_b64_tr_b16 a[108:109], v30 offset:2048
    ds_read_b64_tr_b16 a[110:111], v55 offset:2048
    s_waitcnt lgkmcnt(0)
    s_barrier
    s_add_u32 m0, s93, 16384
    s_add_u32 s94, s86, 2097152
    buffer_load_dwordx4 v20, s[20:23], s94 offen lds
    s_add_u32 m0, s93, 17408
    s_add_u32 s94, s86, 2129920
    buffer_load_dwordx4 v20, s[20:23], s94 offen lds
    s_add_u32 m0, s93, 18432
    s_add_u32 s94, s86, 2162688
    buffer_load_dwordx4 v20, s[20:23], s94 offen lds
    s_add_u32 m0, s93, 19456
    s_add_u32 s94, s86, 2195456
    buffer_load_dwordx4 v20, s[20:23], s94 offen lds
    s_waitcnt vmcnt(33)
    s_barrier
    v_add_u32 v29, 20480, v24
    v_add_u32 v30, 20480, v25
    v_add_u32 v54, 94208, v24
    v_add_u32 v55, 94208, v25
    ds_read_b64_tr_b16 a[40:41], v29 offset:0
    ds_read_b64_tr_b16 a[42:43], v54 offset:0
    ds_read_b64_tr_b16 a[44:45], v29 offset:2048
    ds_read_b64_tr_b16 a[46:47], v54 offset:2048
    ds_read_b64_tr_b16 a[112:113], v30 offset:0
    ds_read_b64_tr_b16 a[114:115], v55 offset:0
    ds_read_b64_tr_b16 a[116:117], v30 offset:2048
    ds_read_b64_tr_b16 a[118:119], v55 offset:2048
    s_waitcnt lgkmcnt(0)
    s_barrier
    s_add_u32 m0, s93, 20480
    s_add_u32 s94, s86, 2228224
    buffer_load_dwordx4 v20, s[20:23], s94 offen lds
    s_add_u32 m0, s93, 21504
    s_add_u32 s94, s86, 2260992
    buffer_load_dwordx4 v20, s[20:23], s94 offen lds
    s_add_u32 m0, s93, 22528
    s_add_u32 s94, s86, 2293760
    buffer_load_dwordx4 v20, s[20:23], s94 offen lds
    s_add_u32 m0, s93, 23552
    s_add_u32 s94, s86, 2326528
    buffer_load_dwordx4 v20, s[20:23], s94 offen lds
    s_waitcnt vmcnt(33)
    s_barrier
    v_add_u32 v29, 24576, v24
    v_add_u32 v30, 24576, v25
    v_add_u32 v54, 98304, v24
    v_add_u32 v55, 98304, v25
    ds_read_b64_tr_b16 a[48:49], v29 offset:0
    ds_read_b64_tr_b16 a[50:51], v54 offset:0
    ds_read_b64_tr_b16 a[52:53], v29 offset:2048
    ds_read_b64_tr_b16 a[54:55], v54 offset:2048
    ds_read_b64_tr_b16 a[120:121], v30 offset:0
    ds_read_b64_tr_b16 a[122:123], v55 offset:0
    ds_read_b64_tr_b16 a[124:125], v30 offset:2048
    ds_read_b64_tr_b16 a[126:127], v55 offset:2048
    s_waitcnt lgkmcnt(0)
    s_barrier
    s_add_u32 m0, s93, 24576
    s_add_u32 s94, s86, 2359296
    buffer_load_dwordx4 v20, s[20:23], s94 offen lds
    s_add_u32 m0, s93, 25600
    s_add_u32 s94, s86, 2392064
    buffer_load_dwordx4 v20, s[20:23], s94 offen lds
    s_add_u32 m0, s93, 26624
    s_add_u32 s94, s86, 2424832
    buffer_load_dwordx4 v20, s[20:23], s94 offen lds
    s_add_u32 m0, s93, 27648
    s_add_u32 s94, s86, 2457600
    buffer_load_dwordx4 v20, s[20:23], s94 offen lds
    s_waitcnt vmcnt(33)
    s_barrier
    v_add_u32 v29, 28672, v24
    v_add_u32 v30, 28672, v25
    v_add_u32 v54, 102400, v24
    v_add_u32 v55, 102400, v25
    ds_read_b64_tr_b16 a[56:57], v29 offset:0
    ds_read_b64_tr_b16 a[58:59], v54 offset:0
    ds_read_b64_tr_b16 a[60:61], v29 offset:2048
    ds_read_b64_tr_b16 a[62:63], v54 offset:2048
    ds_read_b64_tr_b16 a[128:129], v30 offset:0
    ds_read_b64_tr_b16 a[130:131], v55 offset:0
    ds_read_b64_tr_b16 a[132:133], v30 offset:2048
    ds_read_b64_tr_b16 a[134:135], v55 offset:2048
    s_waitcnt lgkmcnt(0)
    s_barrier
    s_add_u32 m0, s93, 28672
    s_add_u32 s94, s86, 2490368
    buffer_load_dwordx4 v20, s[20:23], s94 offen lds
    s_add_u32 m0, s93, 29696
    s_add_u32 s94, s86, 2523136
    buffer_load_dwordx4 v20, s[20:23], s94 offen lds
    s_add_u32 m0, s93, 30720
    s_add_u32 s94, s86, 2555904
    buffer_load_dwordx4 v20, s[20:23], s94 offen lds
    s_add_u32 m0, s93, 31744
    s_add_u32 s94, s86, 2588672
    buffer_load_dwordx4 v20, s[20:23], s94 offen lds
    s_waitcnt vmcnt(33)
    s_barrier
    v_add_u32 v29, 32768, v24
    v_add_u32 v30, 32768, v25
    v_add_u32 v54, 106496, v24
    v_add_u32 v55, 106496, v25
    ds_read_b64_tr_b16 a[64:65], v29 offset:0
    ds_read_b64_tr_b16 a[66:67], v54 offset:0
    ds_read_b64_tr_b16 a[68:69], v29 offset:2048
    ds_read_b64_tr_b16 a[70:71], v54 offset:2048
    ds_read_b64_tr_b16 a[136:137], v30 offset:0
    ds_read_b64_tr_b16 a[138:139], v55 offset:0
    ds_read_b64_tr_b16 a[140:141], v30 offset:2048
    ds_read_b64_tr_b16 a[142:143], v55 offset:2048
    s_waitcnt lgkmcnt(0)
    s_barrier
    s_add_u32 m0, s93, 32768
    s_add_u32 s94, s95, 4194304
    buffer_load_dwordx4 v49, s[20:23], s94 offen lds
    s_add_u32 m0, s93, 33792
    s_add_u32 s94, s95, 4325376
    buffer_load_dwordx4 v49, s[20:23], s94 offen lds
    s_add_u32 m0, s93, 34816
    s_add_u32 s94, s95, 4456448
    buffer_load_dwordx4 v49, s[20:23], s94 offen lds
    s_add_u32 m0, s93, 35840
    s_add_u32 s94, s95, 4587520
    buffer_load_dwordx4 v49, s[20:23], s94 offen lds
    s_waitcnt vmcnt(33)
    s_barrier
    v_add_u32 v29, 0, v24
    v_add_u32 v30, 0, v25
    v_add_u32 v54, 73728, v24
    v_add_u32 v55, 73728, v25
    ds_read_b64_tr_b16 a[144:145], v29 offset:0
    ds_read_b64_tr_b16 a[146:147], v54 offset:0
    ds_read_b64_tr_b16 a[148:149], v29 offset:2048
    ds_read_b64_tr_b16 a[150:151], v54 offset:2048
    ds_read_b64_tr_b16 a[216:217], v30 offset:0
    ds_read_b64_tr_b16 a[218:219], v55 offset:0
    ds_read_b64_tr_b16 a[220:221], v30 offset:2048
    ds_read_b64_tr_b16 a[222:223], v55 offset:2048
    s_waitcnt lgkmcnt(0)
    s_barrier
    s_add_u32 m0, s93, 0
    s_add_u32 s94, s92, 0
    buffer_load_dwordx4 v22, s[28:31], s94 offen lds
    s_add_u32 m0, s93, 1024
    s_add_u32 s94, s92, 9216
    buffer_load_dwordx4 v22, s[28:31], s94 offen lds
    s_add_u32 m0, s93, 2048
    s_add_u32 s94, s92, 18432
    buffer_load_dwordx4 v23, s[28:31], s94 offen lds
    s_add_u32 m0, s93, 3072
    s_add_u32 s94, s92, 27648
    buffer_load_dwordx4 v23, s[28:31], s94 offen lds
    s_waitcnt vmcnt(32)
    s_barrier
    v_add_u32 v29, 4096, v24
    v_add_u32 v30, 4096, v25
    v_add_u32 v54, 77824, v24
    v_add_u32 v55, 77824, v25
    ds_read_b64_tr_b16 a[152:153], v29 offset:0
    ds_read_b64_tr_b16 a[154:155], v54 offset:0
    ds_read_b64_tr_b16 a[156:157], v29 offset:2048
    ds_read_b64_tr_b16 a[158:159], v54 offset:2048
    ds_read_b64_tr_b16 a[224:225], v30 offset:0
    ds_read_b64_tr_b16 a[226:227], v55 offset:0
    ds_read_b64_tr_b16 a[228:229], v30 offset:2048
    ds_read_b64_tr_b16 a[230:231], v55 offset:2048
    s_waitcnt lgkmcnt(0)
    s_barrier
    s_add_u32 m0, s93, 4096
    s_add_u32 s94, s92, 128
    buffer_load_dwordx4 v22, s[28:31], s94 offen lds
    s_add_u32 m0, s93, 5120
    s_add_u32 s94, s92, 9344
    buffer_load_dwordx4 v22, s[28:31], s94 offen lds
    s_add_u32 m0, s93, 6144
    s_add_u32 s94, s92, 18560
    buffer_load_dwordx4 v23, s[28:31], s94 offen lds
    s_add_u32 m0, s93, 7168
    s_add_u32 s94, s92, 27776
    buffer_load_dwordx4 v23, s[28:31], s94 offen lds
    s_waitcnt vmcnt(32)
    s_barrier
    v_add_u32 v29, 8192, v24
    v_add_u32 v30, 8192, v25
    v_add_u32 v54, 81920, v24
    v_add_u32 v55, 81920, v25
    ds_read_b64_tr_b16 a[160:161], v29 offset:0
    ds_read_b64_tr_b16 a[162:163], v54 offset:0
    ds_read_b64_tr_b16 a[164:165], v29 offset:2048
    ds_read_b64_tr_b16 a[166:167], v54 offset:2048
    ds_read_b64_tr_b16 a[232:233], v30 offset:0
    ds_read_b64_tr_b16 a[234:235], v55 offset:0
    ds_read_b64_tr_b16 a[236:237], v30 offset:2048
    ds_read_b64_tr_b16 a[238:239], v55 offset:2048
    s_waitcnt lgkmcnt(0)
    s_barrier
    s_add_u32 m0, s93, 8192
    s_add_u32 s94, s92, 256
    buffer_load_dwordx4 v22, s[28:31], s94 offen lds
    s_add_u32 m0, s93, 9216
    s_add_u32 s94, s92, 9472
    buffer_load_dwordx4 v22, s[28:31], s94 offen lds
    s_add_u32 m0, s93, 10240
    s_add_u32 s94, s92, 18688
    buffer_load_dwordx4 v23, s[28:31], s94 offen lds
    s_add_u32 m0, s93, 11264
    s_add_u32 s94, s92, 27904
    buffer_load_dwordx4 v23, s[28:31], s94 offen lds
    v_mov_b32 v56, 0
    v_mov_b32 v57, 1
    s_cmp_lg_u32 s3, 0
    s_cbranch_scc1 L_sig_1
    s_mov_b64 exec, 1
    buffer_atomic_add v57, v56, s[48:51], 0 offen offset:192
    s_mov_b64 exec, -1
L_sig_1:
    s_waitcnt vmcnt(32)
    s_barrier
    v_add_u32 v29, 12288, v24
    v_add_u32 v30, 12288, v25
    v_add_u32 v54, 86016, v24
    v_add_u32 v55, 86016, v25
    ds_read_b64_tr_b16 a[168:169], v29 offset:0
    ds_read_b64_tr_b16 a[170:171], v54 offset:0
    ds_read_b64_tr_b16 a[172:173], v29 offset:2048
    ds_read_b64_tr_b16 a[174:175], v54 offset:2048
    ds_read_b64_tr_b16 a[240:241], v30 offset:0
    ds_read_b64_tr_b16 a[242:243], v55 offset:0
    ds_read_b64_tr_b16 a[244:245], v30 offset:2048
    ds_read_b64_tr_b16 a[246:247], v55 offset:2048
    s_waitcnt lgkmcnt(0)
    s_barrier
    s_add_u32 m0, s93, 12288
    s_add_u32 s94, s92, 384
    buffer_load_dwordx4 v22, s[28:31], s94 offen lds
    s_add_u32 m0, s93, 13312
    s_add_u32 s94, s92, 9600
    buffer_load_dwordx4 v22, s[28:31], s94 offen lds
    s_add_u32 m0, s93, 14336
    s_add_u32 s94, s92, 18816
    buffer_load_dwordx4 v23, s[28:31], s94 offen lds
    s_add_u32 m0, s93, 15360
    s_add_u32 s94, s92, 28032
    buffer_load_dwordx4 v23, s[28:31], s94 offen lds
    s_waitcnt vmcnt(32)
    s_barrier
    v_add_u32 v29, 16384, v24
    v_add_u32 v30, 16384, v25
    v_add_u32 v54, 90112, v24
    v_add_u32 v55, 90112, v25
    ds_read_b64_tr_b16 a[176:177], v29 offset:0
    ds_read_b64_tr_b16 a[178:179], v54 offset:0
    ds_read_b64_tr_b16 a[180:181], v29 offset:2048
    ds_read_b64_tr_b16 a[182:183], v54 offset:2048
    ds_read_b64_tr_b16 a[248:249], v30 offset:0
    ds_read_b64_tr_b16 a[250:251], v55 offset:0
    ds_read_b64_tr_b16 a[252:253], v30 offset:2048
    ds_read_b64_tr_b16 a[254:255], v55 offset:2048
    s_waitcnt lgkmcnt(0)
    s_barrier
    s_add_u32 m0, s93, 16384
    s_add_u32 s94, s92, 512
    buffer_load_dwordx4 v22, s[28:31], s94 offen lds
    s_add_u32 m0, s93, 17408
    s_add_u32 s94, s92, 9728
    buffer_load_dwordx4 v22, s[28:31], s94 offen lds
    s_add_u32 m0, s93, 18432
    s_add_u32 s94, s92, 18944
    buffer_load_dwordx4 v23, s[28:31], s94 offen lds
    s_add_u32 m0, s93, 19456
    s_add_u32 s94, s92, 28160
    buffer_load_dwordx4 v23, s[28:31], s94 offen lds
    s_waitcnt vmcnt(32)
    s_barrier
    v_add_u32 v29, 20480, v24
    v_add_u32 v30, 20480, v25
    v_add_u32 v54, 94208, v24
    v_add_u32 v55, 94208, v25
    ds_read_b64_tr_b16 a[184:185], v29 offset:0
    ds_read_b64_tr_b16 a[186:187], v54 offset:0
    ds_read_b64_tr_b16 a[188:189], v29 offset:2048
    ds_read_b64_tr_b16 a[190:191], v54 offset:2048
    ds_read_b64_tr_b16 v[80:81], v30 offset:0
    ds_read_b64_tr_b16 v[82:83], v55 offset:0
    ds_read_b64_tr_b16 v[84:85], v30 offset:2048
    ds_read_b64_tr_b16 v[86:87], v55 offset:2048
    s_waitcnt lgkmcnt(0)
    s_barrier
    s_add_u32 m0, s93, 20480
    s_add_u32 s94, s92, 640
    buffer_load_dwordx4 v22, s[28:31], s94 offen lds
    s_add_u32 m0, s93, 21504
    s_add_u32 s94, s92, 9856
    buffer_load_dwordx4 v22, s[28:31], s94 offen lds
    s_add_u32 m0, s93, 22528
    s_add_u32 s94, s92, 19072
    buffer_load_dwordx4 v23, s[28:31], s94 offen lds
    s_add_u32 m0, s93, 23552
    s_add_u32 s94, s92, 28288
    buffer_load_dwordx4 v23, s[28:31], s94 offen lds
    s_waitcnt vmcnt(32)
    s_barrier
    v_add_u32 v29, 24576, v24
    v_add_u32 v30, 24576, v25
    v_add_u32 v54, 98304, v24
    v_add_u32 v55, 98304, v25
    ds_read_b64_tr_b16 a[192:193], v29 offset:0
    ds_read_b64_tr_b16 a[194:195], v54 offset:0
    ds_read_b64_tr_b16 a[196:197], v29 offset:2048
    ds_read_b64_tr_b16 a[198:199], v54 offset:2048
    ds_read_b64_tr_b16 v[88:89], v30 offset:0
    ds_read_b64_tr_b16 v[90:91], v55 offset:0
    ds_read_b64_tr_b16 v[92:93], v30 offset:2048
    ds_read_b64_tr_b16 v[94:95], v55 offset:2048
    s_waitcnt lgkmcnt(0)
    s_barrier
    s_add_u32 m0, s93, 24576
    s_add_u32 s94, s92, 768
    buffer_load_dwordx4 v22, s[28:31], s94 offen lds
    s_add_u32 m0, s93, 25600
    s_add_u32 s94, s92, 9984
    buffer_load_dwordx4 v22, s[28:31], s94 offen lds
    s_add_u32 m0, s93, 26624
    s_add_u32 s94, s92, 19200
    buffer_load_dwordx4 v23, s[28:31], s94 offen lds
    s_add_u32 m0, s93, 27648
    s_add_u32 s94, s92, 28416
    buffer_load_dwordx4 v23, s[28:31], s94 offen lds
    s_waitcnt vmcnt(32)
    s_barrier
    v_add_u32 v29, 28672, v24
    v_add_u32 v30, 28672, v25
    v_add_u32 v54, 102400, v24
    v_add_u32 v55, 102400, v25
    ds_read_b64_tr_b16 a[200:201], v29 offset:0
    ds_read_b64_tr_b16 a[202:203], v54 offset:0
    ds_read_b64_tr_b16 a[204:205], v29 offset:2048
    ds_read_b64_tr_b16 a[206:207], v54 offset:2048
    ds_read_b64_tr_b16 v[96:97], v30 offset:0
    ds_read_b64_tr_b16 v[98:99], v55 offset:0
    ds_read_b64_tr_b16 v[100:101], v30 offset:2048
    ds_read_b64_tr_b16 v[102:103], v55 offset:2048
    s_waitcnt lgkmcnt(0)
    s_barrier
    s_add_u32 m0, s93, 28672
    s_add_u32 s94, s92, 896
    buffer_load_dwordx4 v22, s[28:31], s94 offen lds
    s_add_u32 m0, s93, 29696
    s_add_u32 s94, s92, 10112
    buffer_load_dwordx4 v22, s[28:31], s94 offen lds
    s_add_u32 m0, s93, 30720
    s_add_u32 s94, s92, 19328
    buffer_load_dwordx4 v23, s[28:31], s94 offen lds
    s_add_u32 m0, s93, 31744
    s_add_u32 s94, s92, 28544
    buffer_load_dwordx4 v23, s[28:31], s94 offen lds
    s_waitcnt vmcnt(32)
    s_barrier
    v_add_u32 v29, 32768, v24
    v_add_u32 v30, 32768, v25
    v_add_u32 v54, 106496, v24
    v_add_u32 v55, 106496, v25
    ds_read_b64_tr_b16 a[208:209], v29 offset:0
    ds_read_b64_tr_b16 a[210:211], v54 offset:0
    ds_read_b64_tr_b16 a[212:213], v29 offset:2048
    ds_read_b64_tr_b16 a[214:215], v54 offset:2048
    ds_read_b64_tr_b16 v[104:105], v30 offset:0
    ds_read_b64_tr_b16 v[106:107], v55 offset:0
    ds_read_b64_tr_b16 v[108:109], v30 offset:2048
    ds_read_b64_tr_b16 v[110:111], v55 offset:2048
    s_waitcnt lgkmcnt(0)
    s_barrier
    s_add_u32 m0, s93, 32768
    s_add_u32 s94, s92, 1024
    buffer_load_dwordx4 v22, s[28:31], s94 offen lds
    s_add_u32 m0, s93, 33792
    s_add_u32 s94, s92, 10240
    buffer_load_dwordx4 v22, s[28:31], s94 offen lds
    s_add_u32 m0, s93, 34816
    s_add_u32 s94, s92, 19456
    buffer_load_dwordx4 v23, s[28:31], s94 offen lds
    s_add_u32 m0, s93, 35840
    s_add_u32 s94, s92, 28672
    buffer_load_dwordx4 v23, s[28:31], s94 offen lds
    s_waitcnt vmcnt(32)
    s_barrier
    v_add_u32 v29, 0, v26
    v_add_u32 v30, 73728, v26
    ds_read_b64_tr_b16 v[112:113], v29 offset:0
    ds_read_b64_tr_b16 v[114:115], v29 offset:256
    ds_read_b64_tr_b16 v[116:117], v29 offset:1024
    ds_read_b64_tr_b16 v[118:119], v29 offset:1280
    ds_read_b64_tr_b16 v[120:121], v30 offset:0
    ds_read_b64_tr_b16 v[122:123], v30 offset:256
    ds_read_b64_tr_b16 v[124:125], v30 offset:1024
    ds_read_b64_tr_b16 v[126:127], v30 offset:1280
    s_waitcnt lgkmcnt(0)
    s_barrier
    s_add_u32 m0, s93, 0
    s_add_u32 s94, s96, 0
    buffer_load_dwordx4 v51, s[24:27], s94 offen lds
    s_add_u32 m0, s93, 1024
    s_add_u32 s94, s96, 524288
    buffer_load_dwordx4 v51, s[24:27], s94 offen lds
    s_add_u32 m0, s93, 2048
    s_add_u32 s94, s96, 1048576
    buffer_load_dwordx4 v51, s[24:27], s94 offen lds
    s_add_u32 m0, s93, 3072
    s_add_u32 s94, s96, 1572864
    buffer_load_dwordx4 v51, s[24:27], s94 offen lds
    s_waitcnt vmcnt(32)
    s_barrier
    v_add_u32 v29, 4096, v26
    v_add_u32 v30, 77824, v26
    ds_read_b64_tr_b16 v[128:129], v29 offset:0
    ds_read_b64_tr_b16 v[130:131], v29 offset:256
    ds_read_b64_tr_b16 v[132:133], v29 offset:1024
    ds_read_b64_tr_b16 v[134:135], v29 offset:1280
    ds_read_b64_tr_b16 v[136:137], v30 offset:0
    ds_read_b64_tr_b16 v[138:139], v30 offset:256
    ds_read_b64_tr_b16 v[140:141], v30 offset:1024
    ds_read_b64_tr_b16 v[142:143], v30 offset:1280
    s_waitcnt lgkmcnt(0)
    s_barrier
    s_add_u32 m0, s93, 4096
    s_add_u32 s94, s96, 131072
    buffer_load_dwordx4 v51, s[24:27], s94 offen lds
    s_add_u32 m0, s93, 5120
    s_add_u32 s94, s96, 655360
    buffer_load_dwordx4 v51, s[24:27], s94 offen lds
    s_add_u32 m0, s93, 6144
    s_add_u32 s94, s96, 1179648
    buffer_load_dwordx4 v51, s[24:27], s94 offen lds
    s_add_u32 m0, s93, 7168
    s_add_u32 s94, s96, 1703936
    buffer_load_dwordx4 v51, s[24:27], s94 offen lds
    s_waitcnt vmcnt(32)
    s_barrier
    v_add_u32 v29, 8192, v26
    v_add_u32 v30, 81920, v26
    ds_read_b64_tr_b16 v[144:145], v29 offset:0
    ds_read_b64_tr_b16 v[146:147], v29 offset:256
    ds_read_b64_tr_b16 v[148:149], v29 offset:1024
    ds_read_b64_tr_b16 v[150:151], v29 offset:1280
    ds_read_b64_tr_b16 v[152:153], v30 offset:0
    ds_read_b64_tr_b16 v[154:155], v30 offset:256
    ds_read_b64_tr_b16 v[156:157], v30 offset:1024
    ds_read_b64_tr_b16 v[158:159], v30 offset:1280
    s_waitcnt lgkmcnt(0)
    s_barrier
    s_add_u32 m0, s93, 8192
    s_add_u32 s94, s96, 262144
    buffer_load_dwordx4 v51, s[24:27], s94 offen lds
    s_add_u32 m0, s93, 9216
    s_add_u32 s94, s96, 786432
    buffer_load_dwordx4 v51, s[24:27], s94 offen lds
    s_add_u32 m0, s93, 10240
    s_add_u32 s94, s96, 1310720
    buffer_load_dwordx4 v51, s[24:27], s94 offen lds
    s_add_u32 m0, s93, 11264
    s_add_u32 s94, s96, 1835008
    buffer_load_dwordx4 v51, s[24:27], s94 offen lds
    s_waitcnt vmcnt(32)
    s_barrier
    v_add_u32 v29, 12288, v26
    v_add_u32 v30, 86016, v26
    ds_read_b64_tr_b16 v[160:161], v29 offset:0
    ds_read_b64_tr_b16 v[162:163], v29 offset:256
    ds_read_b64_tr_b16 v[164:165], v29 offset:1024
    ds_read_b64_tr_b16 v[166:167], v29 offset:1280
    ds_read_b64_tr_b16 v[168:169], v30 offset:0
    ds_read_b64_tr_b16 v[170:171], v30 offset:256
    ds_read_b64_tr_b16 v[172:173], v30 offset:1024
    ds_read_b64_tr_b16 v[174:175], v30 offset:1280
    s_waitcnt lgkmcnt(0)
    s_barrier
    s_add_u32 m0, s93, 12288
    s_add_u32 s94, s96, 393216
    buffer_load_dwordx4 v51, s[24:27], s94 offen lds
    s_add_u32 m0, s93, 13312
    s_add_u32 s94, s96, 917504
    buffer_load_dwordx4 v51, s[24:27], s94 offen lds
    s_add_u32 m0, s93, 14336
    s_add_u32 s94, s96, 1441792
    buffer_load_dwordx4 v51, s[24:27], s94 offen lds
    s_add_u32 m0, s93, 15360
    s_add_u32 s94, s96, 1966080
    buffer_load_dwordx4 v51, s[24:27], s94 offen lds
    s_waitcnt vmcnt(32)
    s_barrier
    v_add_u32 v29, 16384, v26
    v_add_u32 v30, 90112, v26
    ds_read_b64_tr_b16 v[176:177], v29 offset:0
    ds_read_b64_tr_b16 v[178:179], v29 offset:256
    ds_read_b64_tr_b16 v[180:181], v29 offset:1024
    ds_read_b64_tr_b16 v[182:183], v29 offset:1280
    ds_read_b64_tr_b16 v[184:185], v30 offset:0
    ds_read_b64_tr_b16 v[186:187], v30 offset:256
    ds_read_b64_tr_b16 v[188:189], v30 offset:1024
    ds_read_b64_tr_b16 v[190:191], v30 offset:1280
    s_waitcnt lgkmcnt(0)
    s_barrier
    s_add_u32 m0, s93, 16384
    s_add_u32 s94, s96, 2097152
    buffer_load_dwordx4 v51, s[24:27], s94 offen lds
    s_add_u32 m0, s93, 17408
    s_add_u32 s94, s96, 2621440
    buffer_load_dwordx4 v51, s[24:27], s94 offen lds
    s_add_u32 m0, s93, 18432
    s_add_u32 s94, s96, 3145728
    buffer_load_dwordx4 v51, s[24:27], s94 offen lds
    s_add_u32 m0, s93, 19456
    s_add_u32 s94, s96, 3670016
    buffer_load_dwordx4 v51, s[24:27], s94 offen lds
    s_waitcnt vmcnt(32)
    s_barrier
    v_add_u32 v29, 20480, v26
    v_add_u32 v30, 94208, v26
    ds_read_b64_tr_b16 v[192:193], v29 offset:0
    ds_read_b64_tr_b16 v[194:195], v29 offset:256
    ds_read_b64_tr_b16 v[196:197], v29 offset:1024
    ds_read_b64_tr_b16 v[198:199], v29 offset:1280
    ds_read_b64_tr_b16 v[200:201], v30 offset:0
    ds_read_b64_tr_b16 v[202:203], v30 offset:256
    ds_read_b64_tr_b16 v[204:205], v30 offset:1024
    ds_read_b64_tr_b16 v[206:207], v30 offset:1280
    s_waitcnt lgkmcnt(0)
    s_barrier
    s_add_u32 m0, s93, 20480
    s_add_u32 s94, s96, 2228224
    buffer_load_dwordx4 v51, s[24:27], s94 offen lds
    s_add_u32 m0, s93, 21504
    s_add_u32 s94, s96, 2752512
    buffer_load_dwordx4 v51, s[24:27], s94 offen lds
    s_add_u32 m0, s93, 22528
    s_add_u32 s94, s96, 3276800
    buffer_load_dwordx4 v51, s[24:27], s94 offen lds
    s_add_u32 m0, s93, 23552
    s_add_u32 s94, s96, 3801088
    buffer_load_dwordx4 v51, s[24:27], s94 offen lds
    s_waitcnt vmcnt(32)
    s_barrier
    v_add_u32 v29, 24576, v26
    v_add_u32 v30, 98304, v26
    ds_read_b64_tr_b16 v[208:209], v29 offset:0
    ds_read_b64_tr_b16 v[210:211], v29 offset:256
    ds_read_b64_tr_b16 v[212:213], v29 offset:1024
    ds_read_b64_tr_b16 v[214:215], v29 offset:1280
    ds_read_b64_tr_b16 v[216:217], v30 offset:0
    ds_read_b64_tr_b16 v[218:219], v30 offset:256
    ds_read_b64_tr_b16 v[220:221], v30 offset:1024
    ds_read_b64_tr_b16 v[222:223], v30 offset:1280
    s_waitcnt lgkmcnt(0)
    s_barrier
    s_add_u32 m0, s93, 24576
    s_add_u32 s94, s96, 2359296
    buffer_load_dwordx4 v51, s[24:27], s94 offen lds
    s_add_u32 m0, s93, 25600
    s_add_u32 s94, s96, 2883584
    buffer_load_dwordx4 v51, s[24:27], s94 offen lds
    s_add_u32 m0, s93, 26624
    s_add_u32 s94, s96, 3407872
    buffer_load_dwordx4 v51, s[24:27], s94 offen lds
    s_add_u32 m0, s93, 27648
    s_add_u32 s94, s96, 3932160
    buffer_load_dwordx4 v51, s[24:27], s94 offen lds
    s_waitcnt vmcnt(32)
    s_barrier
    v_add_u32 v29, 28672, v26
    v_add_u32 v30, 102400, v26
    ds_read_b64_tr_b16 v[224:225], v29 offset:0
    ds_read_b64_tr_b16 v[226:227], v29 offset:256
    ds_read_b64_tr_b16 v[228:229], v29 offset:1024
    ds_read_b64_tr_b16 v[230:231], v29 offset:1280
    ds_read_b64_tr_b16 v[232:233], v30 offset:0
    ds_read_b64_tr_b16 v[234:235], v30 offset:256
    ds_read_b64_tr_b16 v[236:237], v30 offset:1024
    ds_read_b64_tr_b16 v[238:239], v30 offset:1280
    s_waitcnt lgkmcnt(0)
    s_barrier
    s_add_u32 m0, s93, 28672
    s_add_u32 s94, s96, 2490368
    buffer_load_dwordx4 v51, s[24:27], s94 offen lds
    s_add_u32 m0, s93, 29696
    s_add_u32 s94, s96, 3014656
    buffer_load_dwordx4 v51, s[24:27], s94 offen lds
    s_add_u32 m0, s93, 30720
    s_add_u32 s94, s96, 3538944
    buffer_load_dwordx4 v51, s[24:27], s94 offen lds
    s_add_u32 m0, s93, 31744
    s_add_u32 s94, s96, 4063232
    buffer_load_dwordx4 v51, s[24:27], s94 offen lds
    s_waitcnt vmcnt(32)
    s_barrier
    v_add_u32 v29, 32768, v26
    v_add_u32 v30, 106496, v26
    ds_read_b64_tr_b16 v[240:241], v29 offset:0
    ds_read_b64_tr_b16 v[242:243], v29 offset:256
    ds_read_b64_tr_b16 v[244:245], v29 offset:1024
    ds_read_b64_tr_b16 v[246:247], v29 offset:1280
    ds_read_b64_tr_b16 v[248:249], v30 offset:0
    ds_read_b64_tr_b16 v[250:251], v30 offset:256
    ds_read_b64_tr_b16 v[252:253], v30 offset:1024
    ds_read_b64_tr_b16 v[254:255], v30 offset:1280
    s_waitcnt lgkmcnt(0)
    s_barrier
    s_add_u32 m0, s93, 32768
    s_add_u32 s94, s96, 4194304
    buffer_load_dwordx4 v52, s[24:27], s94 offen lds
    s_add_u32 m0, s93, 33792
    s_add_u32 s94, s96, 4202496
    buffer_load_dwordx4 v52, s[24:27], s94 offen lds
    s_add_u32 m0, s93, 34816
    s_add_u32 s94, s96, 4210688
    buffer_load_dwordx4 v52, s[24:27], s94 offen lds
    s_add_u32 m0, s93, 35840
    s_add_u32 s94, s96, 4218880
    buffer_load_dwordx4 v52, s[24:27], s94 offen lds
    s_waitcnt vmcnt(32)
    ds_read_b64_tr_b16 v[32:33], v53 offset:0
    ds_read_b64_tr_b16 v[34:35], v53 offset:2048
    ds_read_b64_tr_b16 v[36:37], v53 offset:512
    ds_read_b64_tr_b16 v[38:39], v53 offset:2560
    ds_read_b64_tr_b16 v[40:41], v53 offset:32
    ds_read_b64_tr_b16 v[42:43], v53 offset:2080
    ds_read_b64_tr_b16 v[44:45], v53 offset:544
    ds_read_b64_tr_b16 v[46:47], v53 offset:2592
    s_waitcnt lgkmcnt(0)
    ds_write_b128 v5, v[32:35] offset:0
    ds_write_b128 v5, v[36:39] offset:1024
    ds_write_b128 v5, v[40:43] offset:2048
    ds_write_b128 v5, v[44:47] offset:3072
    s_waitcnt vmcnt(28)
    ds_read_b64_tr_b16 v[32:33], v53 offset:4096
    ds_read_b64_tr_b16 v[34:35], v53 offset:6144
    ds_read_b64_tr_b16 v[36:37], v53 offset:4608
    ds_read_b64_tr_b16 v[38:39], v53 offset:6656
    ds_read_b64_tr_b16 v[40:41], v53 offset:4128
    ds_read_b64_tr_b16 v[42:43], v53 offset:6176
    ds_read_b64_tr_b16 v[44:45], v53 offset:4640
    ds_read_b64_tr_b16 v[46:47], v53 offset:6688
    s_waitcnt lgkmcnt(0)
    ds_write_b128 v5, v[32:35] offset:4096
    ds_write_b128 v5, v[36:39] offset:5120
    ds_write_b128 v5, v[40:43] offset:6144
    ds_write_b128 v5, v[44:47] offset:7168
    s_waitcnt vmcnt(24)
    ds_read_b64_tr_b16 v[32:33], v53 offset:8192
    ds_read_b64_tr_b16 v[34:35], v53 offset:10240
    ds_read_b64_tr_b16 v[36:37], v53 offset:8704
    ds_read_b64_tr_b16 v[38:39], v53 offset:10752
    ds_read_b64_tr_b16 v[40:41], v53 offset:8224
    ds_read_b64_tr_b16 v[42:43], v53 offset:10272
    ds_read_b64_tr_b16 v[44:45], v53 offset:8736
    ds_read_b64_tr_b16 v[46:47], v53 offset:10784
    s_waitcnt lgkmcnt(0)
    ds_write_b128 v5, v[32:35] offset:8192
    ds_write_b128 v5, v[36:39] offset:9216
    ds_write_b128 v5, v[40:43] offset:10240
    ds_write_b128 v5, v[44:47] offset:11264
    s_waitcnt vmcnt(20)
    ds_read_b64_tr_b16 v[32:33], v53 offset:12288
    ds_read_b64_tr_b16 v[34:35], v53 offset:14336
    ds_read_b64_tr_b16 v[36:37], v53 offset:12800
    ds_read_b64_tr_b16 v[38:39], v53 offset:14848
    ds_read_b64_tr_b16 v[40:41], v53 offset:12320
    ds_read_b64_tr_b16 v[42:43], v53 offset:14368
    ds_read_b64_tr_b16 v[44:45], v53 offset:12832
    ds_read_b64_tr_b16 v[46:47], v53 offset:14880
    s_waitcnt lgkmcnt(0)
    ds_write_b128 v5, v[32:35] offset:12288
    ds_write_b128 v5, v[36:39] offset:13312
    ds_write_b128 v5, v[40:43] offset:14336
    ds_write_b128 v5, v[44:47] offset:15360
    s_waitcnt vmcnt(16)
    ds_read_b64_tr_b16 v[32:33], v53 offset:16384
    ds_read_b64_tr_b16 v[34:35], v53 offset:18432
    ds_read_b64_tr_b16 v[36:37], v53 offset:16896
    ds_read_b64_tr_b16 v[38:39], v53 offset:18944
    ds_read_b64_tr_b16 v[40:41], v53 offset:16416
    ds_read_b64_tr_b16 v[42:43], v53 offset:18464
    ds_read_b64_tr_b16 v[44:45], v53 offset:16928
    ds_read_b64_tr_b16 v[46:47], v53 offset:18976
    s_waitcnt lgkmcnt(0)
    ds_write_b128 v5, v[32:35] offset:16384
    ds_write_b128 v5, v[36:39] offset:17408
    ds_write_b128 v5, v[40:43] offset:18432
    ds_write_b128 v5, v[44:47] offset:19456
    s_waitcnt vmcnt(12)
    ds_read_b64_tr_b16 v[32:33], v53 offset:20480
    ds_read_b64_tr_b16 v[34:35], v53 offset:22528
    ds_read_b64_tr_b16 v[36:37], v53 offset:20992
    ds_read_b64_tr_b16 v[38:39], v53 offset:23040
    ds_read_b64_tr_b16 v[40:41], v53 offset:20512
    ds_read_b64_tr_b16 v[42:43], v53 offset:22560
    ds_read_b64_tr_b16 v[44:45], v53 offset:21024
    ds_read_b64_tr_b16 v[46:47], v53 offset:23072
    s_waitcnt lgkmcnt(0)
    ds_write_b128 v5, v[32:35] offset:20480
    ds_write_b128 v5, v[36:39] offset:21504
    ds_write_b128 v5, v[40:43] offset:22528
    ds_write_b128 v5, v[44:47] offset:23552
    s_waitcnt vmcnt(8)
    ds_read_b64_tr_b16 v[32:33], v53 offset:24576
    ds_read_b64_tr_b16 v[34:35], v53 offset:26624
    ds_read_b64_tr_b16 v[36:37], v53 offset:25088
    ds_read_b64_tr_b16 v[38:39], v53 offset:27136
    ds_read_b64_tr_b16 v[40:41], v53 offset:24608
    ds_read_b64_tr_b16 v[42:43], v53 offset:26656
    ds_read_b64_tr_b16 v[44:45], v53 offset:25120
    ds_read_b64_tr_b16 v[46:47], v53 offset:27168
    s_waitcnt lgkmcnt(0)
    ds_write_b128 v5, v[32:35] offset:24576
    ds_write_b128 v5, v[36:39] offset:25600
    ds_write_b128 v5, v[40:43] offset:26624
    ds_write_b128 v5, v[44:47] offset:27648
    s_waitcnt vmcnt(4)
    ds_read_b64_tr_b16 v[32:33], v53 offset:28672
    ds_read_b64_tr_b16 v[34:35], v53 offset:30720
    ds_read_b64_tr_b16 v[36:37], v53 offset:29184
    ds_read_b64_tr_b16 v[38:39], v53 offset:31232
    ds_read_b64_tr_b16 v[40:41], v53 offset:28704
    ds_read_b64_tr_b16 v[42:43], v53 offset:30752
    ds_read_b64_tr_b16 v[44:45], v53 offset:29216
    ds_read_b64_tr_b16 v[46:47], v53 offset:31264
    s_waitcnt lgkmcnt(0)
    ds_write_b128 v5, v[32:35] offset:28672
    ds_write_b128 v5, v[36:39] offset:29696
    ds_write_b128 v5, v[40:43] offset:30720
    ds_write_b128 v5, v[44:47] offset:31744
    s_waitcnt vmcnt(0)
    ds_read_b64_tr_b16 v[32:33], v53 offset:32768
    ds_read_b64_tr_b16 v[34:35], v53 offset:34816
    ds_read_b64_tr_b16 v[36:37], v53 offset:33280
    ds_read_b64_tr_b16 v[38:39], v53 offset:35328
    ds_read_b64_tr_b16 v[40:41], v53 offset:32800
    ds_read_b64_tr_b16 v[42:43], v53 offset:34848
    ds_read_b64_tr_b16 v[44:45], v53 offset:33312
    ds_read_b64_tr_b16 v[46:47], v53 offset:35360
    s_waitcnt lgkmcnt(0)
    ds_write_b128 v5, v[32:35] offset:32768
    ds_write_b128 v5, v[36:39] offset:33792
    ds_write_b128 v5, v[40:43] offset:34816
    ds_write_b128 v5, v[44:47] offset:35840
    s_waitcnt lgkmcnt(0)
    v_mov_b32 v16, 0
    s_nop 1
L_wait_2:
    buffer_load_dword v17, v16, s[48:51], 0 offen offset:192 sc1
    s_waitcnt vmcnt(0)
    v_readfirstlane_b32 s83, v17
    s_nop 0
    s_cmp_ge_u32 s83, 32
    s_nop 2
    s_cbranch_scc1 L_waitok_3
    s_sleep 2
    s_sub_u32 s81, s81, 1
    s_cbranch_scc1 L_main_done
    s_branch L_wait_2
L_waitok_3:
    v_mov_b32 v16, 0
    buffer_load_dword v17, v16, s[48:51], 0 offen offset:196 sc1
    s_waitcnt vmcnt(0)
    v_readfirstlane_b32 s87, v17
    s_mov_b32 s83, 0
    s_lshl_b32 s100, s4, 7
    s_add_u32 s100, s100, 0x8305000
    s_cmp_lg_u32 s87, 0
    s_nop 0
    s_cbranch_scc1 L_m_slow
    ds_read_b128 v[64:67], v5 offset:0
    ds_read_b128 v[68:71], v5 offset:1024
    ds_read_b128 v[72:75], v5 offset:2048
    ds_read_b128 v[76:79], v5 offset:3072
    v_mov_b64 v[12:13], 0
    v_mov_b64 v[14:15], 0
    v_mov_b64 v[16:17], 0
    v_mov_b64 v[18:19], 0
    s_nop 1
    s_waitcnt lgkmcnt(0)
L_stepf:
    s_add_u32 s84, s5, 1
    s_min_u32 s84, s84, 63
    s_cmp_lt_u32 s84, s83
    s_cbranch_scc1 L_kvok_5
    s_branch L_kv_4b
L_kv_4:
    s_sleep 6
L_kv_4b:
    v_lshrrev_b32 v52, 2, v0
    v_and_b32 v52, 63, v52
    buffer_load_dword v53, v52, s[48:51], 0 offen offset:32 sc1
    s_waitcnt vmcnt(0)
    v_cmp_gt_u32 vcc, 64, v53
    s_nop 0
    s_or_b32 s85, vcc_lo, 0x10000
    s_ff1_i32_b32 s85, s85
    s_lshl_b32 s83, s85, 2
    s_sub_u32 s81, s81, 1
    s_cbranch_scc1 L_main_done
    s_cmp_lt_u32 s84, s83
    s_cbranch_scc0 L_kv_4
L_kvok_5:
    v_mov_b64 v[20:21], 0
    v_mov_b64 v[22:23], 0
    v_mov_b64 v[24:25], 0
    v_mov_b64 v[26:27], 0
    v_mov_b64 v[28:29], 0
    v_mov_b64 v[30:31], 0
    v_mov_b64 v[32:33], 0
    v_mov_b64 v[34:35], 0
    s_sub_u32 s84, s69, 149504
    s_add_u32 s85, s84, 3072
    s_add_u32 s86, s84, 6144
    s_cmp_eq_u32 s3, 3
    s_cbranch_scc1 L_joinf
L_gatherf:
    buffer_load_dwordx4 v[52:55], v8, s[52:55], s84 offen sc1
    buffer_load_dwordx4 v[56:59], v8, s[52:55], s85 offen sc1
    buffer_load_dwordx4 v[60:63], v8, s[52:55], s86 offen sc1
    s_sub_u32 s81, s81, 1
    s_cbranch_scc1 L_main_done
    s_waitcnt vmcnt(2)
    ds_write_b128 v8, v[52:55] offset:5120
    v_max_u32 v11, v52, v54
    s_waitcnt vmcnt(1)
    ds_write_b128 v8, v[56:59] offset:8192
    v_max3_u32 v11, v11, v56, v58
    s_waitcnt vmcnt(0)
    ds_write_b128 v8, v[60:63] offset:11264
    v_max3_u32 v11, v11, v60, v62
    v_cmp_eq_u32 vcc, -1, v11
    s_waitcnt lgkmcnt(0)
    s_nop 2
    s_cbranch_vccnz L_gatherf
    s_nop 1
L_joinf:
    s_barrier
    ds_read_b128 v[52:55], v7 offset:7168
    ds_read_b128 v[56:59], v7 offset:8192
    ds_read_b128 v[60:63], v7 offset:9216
    s_add_u32 s85, s57, s72
    s_add_u32 s86, s58, s72
    s_add_u32 s84, s85, 4096
    s_cmp_ge_u32 s5, 63
    s_cselect_b32 s87, 0, 262144
    s_add_u32 s87, s87, s72
    s_add_u32 s87, s87, s68
    v_lshlrev_b32 v11, 2, v0
    s_waitcnt lgkmcnt(2)
    v_smfmac_f32_16x16x64_bf16 v[28:31], v[52:55], v[64:71], v4
    ds_read_b128 v[64:67], v5 offset:4096
    v_smfmac_f32_16x16x64_bf16 v[12:15], v[52:55], a[0:7], v4
    ds_read_b128 v[68:71], v5 offset:5120
    v_smfmac_f32_16x16x64_bf16 v[20:23], v[52:55], a[144:151], v4
    buffer_load_dwordx4 v[36:39], v0, s[52:55], s85 offen sc1
    v_smfmac_f32_16x16x64_bf16 v[32:35], v[52:55], v[72:79], v4
    ds_read_b128 v[72:75], v5 offset:6144
    v_smfmac_f32_16x16x64_bf16 v[16:19], v[52:55], a[72:79], v4
    ds_read_b128 v[76:79], v5 offset:7168
    v_smfmac_f32_16x16x64_bf16 v[24:27], v[52:55], a[216:223], v4
    ds_read_b128 v[52:55], v7 offset:10240
    s_waitcnt lgkmcnt(3)
    v_smfmac_f32_16x16x64_bf16 v[28:31], v[56:59], v[64:71], v4
    ds_read_b128 v[64:67], v5 offset:8192
    v_smfmac_f32_16x16x64_bf16 v[12:15], v[56:59], a[8:15], v4
    ds_read_b128 v[68:71], v5 offset:9216
    v_smfmac_f32_16x16x64_bf16 v[20:23], v[56:59], a[152:159], v4
    buffer_load_dwordx4 v[40:43], v0, s[52:55], s84 offen sc1
    s_waitcnt lgkmcnt(3)
    v_smfmac_f32_16x16x64_bf16 v[32:35], v[56:59], v[72:79], v4
    ds_read_b128 v[72:75], v5 offset:10240
    v_smfmac_f32_16x16x64_bf16 v[16:19], v[56:59], a[80:87], v4
    ds_read_b128 v[76:79], v5 offset:11264
    v_smfmac_f32_16x16x64_bf16 v[24:27], v[56:59], a[224:231], v4
    ds_read_b128 v[56:59], v7 offset:11264
    s_waitcnt lgkmcnt(3)
    v_smfmac_f32_16x16x64_bf16 v[28:31], v[60:63], v[64:71], v4
    ds_read_b128 v[64:67], v5 offset:12288
    v_smfmac_f32_16x16x64_bf16 v[12:15], v[60:63], a[16:23], v4
    ds_read_b128 v[68:71], v5 offset:13312
    v_smfmac_f32_16x16x64_bf16 v[20:23], v[60:63], a[160:167], v4
    buffer_load_dwordx4 v[44:47], v0, s[52:55], s86 offen sc1
    s_waitcnt lgkmcnt(3)
    v_smfmac_f32_16x16x64_bf16 v[32:35], v[60:63], v[72:79], v4
    ds_read_b128 v[72:75], v5 offset:14336
    v_smfmac_f32_16x16x64_bf16 v[16:19], v[60:63], a[88:95], v4
    ds_read_b128 v[76:79], v5 offset:15360
    v_smfmac_f32_16x16x64_bf16 v[24:27], v[60:63], a[232:239], v4
    ds_read_b128 v[60:63], v7 offset:12288
    s_waitcnt lgkmcnt(3)
    v_smfmac_f32_16x16x64_bf16 v[28:31], v[52:55], v[64:71], v4
    ds_read_b128 v[64:67], v5 offset:16384
    v_smfmac_f32_16x16x64_bf16 v[12:15], v[52:55], a[24:31], v4
    ds_read_b128 v[68:71], v5 offset:17408
    v_smfmac_f32_16x16x64_bf16 v[20:23], v[52:55], a[168:175], v4
    buffer_load_dwordx4 v[48:51], v0, s[52:55], s86 offen offset:1024 sc1
    s_waitcnt lgkmcnt(3)
    v_smfmac_f32_16x16x64_bf16 v[32:35], v[52:55], v[72:79], v4
    ds_read_b128 v[72:75], v5 offset:18432
    v_smfmac_f32_16x16x64_bf16 v[16:19], v[52:55], a[96:103], v4
    ds_read_b128 v[76:79], v5 offset:19456
    v_smfmac_f32_16x16x64_bf16 v[24:27], v[52:55], a[240:247], v4
    ds_read_b128 v[52:55], v7 offset:13312
    s_waitcnt lgkmcnt(3)
    v_smfmac_f32_16x16x64_bf16 v[28:31], v[56:59], v[64:71], v4
    ds_read_b128 v[64:67], v5 offset:20480
    v_smfmac_f32_16x16x64_bf16 v[12:15], v[56:59], a[32:39], v4
    ds_read_b128 v[68:71], v5 offset:21504
    v_smfmac_f32_16x16x64_bf16 v[20:23], v[56:59], a[176:183], v4
    buffer_load_dword v11, v11, s[52:55], s87 offen sc1
    s_waitcnt lgkmcnt(3)
    v_smfmac_f32_16x16x64_bf16 v[32:35], v[56:59], v[72:79], v4
    ds_read_b128 v[72:75], v5 offset:22528
    v_smfmac_f32_16x16x64_bf16 v[16:19], v[56:59], a[104:111], v4
    ds_read_b128 v[76:79], v5 offset:23552
    v_smfmac_f32_16x16x64_bf16 v[24:27], v[56:59], a[248:255], v4
    ds_read_b128 v[56:59], v7 offset:14336
    s_waitcnt lgkmcnt(3)
    v_smfmac_f32_16x16x64_bf16 v[28:31], v[60:63], v[64:71], v4
    ds_read_b128 v[64:67], v5 offset:24576
    v_smfmac_f32_16x16x64_bf16 v[12:15], v[60:63], a[40:47], v4
    ds_read_b128 v[68:71], v5 offset:25600
    v_smfmac_f32_16x16x64_bf16 v[20:23], v[60:63], a[184:191], v4
    s_waitcnt lgkmcnt(3)
    v_smfmac_f32_16x16x64_bf16 v[32:35], v[60:63], v[72:79], v4
    ds_read_b128 v[72:75], v5 offset:26624
    v_smfmac_f32_16x16x64_bf16 v[16:19], v[60:63], a[112:119], v4
    ds_read_b128 v[76:79], v5 offset:27648
    v_smfmac_f32_16x16x64_bf16 v[24:27], v[60:63], v[80:87], v4
    ds_read_b128 v[60:63], v7 offset:15360
    s_waitcnt lgkmcnt(3)
    v_smfmac_f32_16x16x64_bf16 v[28:31], v[52:55], v[64:71], v4
    ds_read_b128 v[64:67], v5 offset:28672
    v_smfmac_f32_16x16x64_bf16 v[12:15], v[52:55], a[48:55], v4
    ds_read_b128 v[68:71], v5 offset:29696
    v_smfmac_f32_16x16x64_bf16 v[20:23], v[52:55], a[192:199], v4
    s_waitcnt vmcnt(1)
    s_waitcnt lgkmcnt(3)
    v_smfmac_f32_16x16x64_bf16 v[32:35], v[52:55], v[72:79], v4
    ds_read_b128 v[72:75], v5 offset:30720
    v_smfmac_f32_16x16x64_bf16 v[16:19], v[52:55], a[120:127], v4
    ds_read_b128 v[76:79], v5 offset:31744
    v_smfmac_f32_16x16x64_bf16 v[24:27], v[52:55], v[88:95], v4
    ds_read_b128 v[52:55], v7 offset:15360
    v_smfmac_f32_16x16x64_bf16 v[12:15], v[56:59], a[56:63], v4
    v_smfmac_f32_16x16x64_bf16 v[20:23], v[56:59], a[200:207], v4
    s_cmp_lg_u32 s3, 3
    s_cbranch_scc1 L_prog_6
    v_mov_b32 v1, s5
    buffer_store_dword v1, off, s[52:55], s100 sc1
L_prog_6:
    v_smfmac_f32_16x16x64_bf16 v[16:19], v[56:59], a[128:135], v4
    v_smfmac_f32_16x16x64_bf16 v[24:27], v[56:59], v[96:103], v4
    ds_read_b128 v[56:59], v7 offset:14336
    s_waitcnt lgkmcnt(6)
    v_smfmac_f32_16x16x64_bf16 v[12:15], v[60:63], a[64:71], v4
    v_smfmac_f32_16x16x64_bf16 v[16:19], v[60:63], a[136:143], v4
    v_smfmac_f32_16x16x64_bf16 v[20:23], v[60:63], a[208:215], v4
    v_smfmac_f32_16x16x64_bf16 v[24:27], v[60:63], v[104:111], v4
    s_add_u32 s84, s73, s82
    s_add_u32 s85, s59, s73
    s_mov_b32 s86, 0x3f803f80
    s_waitcnt lgkmcnt(0)
    v_smfmac_f32_16x16x64_bf16 v[28:31], v[56:59], v[64:71], v4
    ds_read_b128 v[64:67], v5 offset:32768
    ds_read_b128 v[68:71], v5 offset:33792
    v_add_f32 v12, v12, v14
    v_add_f32 v13, v13, v15
    v_cvt_pk_bf16_f32 v60, v12, v13
    v_add_f32 v16, v16, v18
    v_add_f32_e64 v17, v17, v19
    v_cvt_pk_bf16_f32 v61, v16, v17
    ds_write2_b32 v2, v60, v61 offset0:0 offset1:64
    v_pk_add_f32 v[20:21], v[20:21], v[22:23]
    v_cvt_pk_bf16_f32 v62, v20, v21
    v_pk_add_f32 v[24:25], v[24:25], v[26:27]
    v_cvt_pk_bf16_f32 v63, v24, v25
    ds_read_b64_tr_b16 v[12:13], v3 offset:0
    ds_read_b64_tr_b16 v[14:15], v3 offset:64
    ds_write2_b32 v2, v62, v63 offset0:128 offset1:192
    ds_read_b64_tr_b16 v[16:17], v3 offset:512
    ds_read_b64_tr_b16 v[18:19], v3 offset:576
    v_smfmac_f32_16x16x64_bf16 v[32:35], v[56:59], v[72:79], v4
    ds_read_b128 v[72:75], v5 offset:34816
    ds_read_b128 v[76:79], v5 offset:35840
    s_waitcnt lgkmcnt(5)
    v_mfma_f32_16x16x32_bf16 v[20:23], v[36:39], v[12:15], 0
    v_mfma_f32_16x16x32_bf16 v[24:27], v[40:43], v[12:15], 0
    s_waitcnt lgkmcnt(2)
    v_mfma_f32_16x16x32_bf16 v[60:63], v[16:19], v[12:15], 0
    buffer_store_dwordx4 v[16:19], v0, s[52:55], s85 offen sc1
    v_mov_b64_e64 v[36:37], 0
    v_mov_b64 v[38:39], 0
    s_nop 2
    v_cndmask_b32 v20, v20, v24, s[74:75]
    v_cndmask_b32 v21, v21, v25, s[74:75]
    v_cndmask_b32 v22, v22, v26, s[74:75]
    v_cndmask_b32 v23, v23, v27, s[74:75]
    ds_write_b128 v8, v[20:23]
    v_cndmask_b32 v60, v60, v61, s[74:75]
    v_cndmask_b32 v62, v62, v63, s[74:75]
    v_cndmask_b32 v60, v60, v62, s[76:77]
    ds_write_b32 v9, v60
    v_smfmac_f32_16x16x64_bf16 v[28:31], v[52:55], v[64:71], v4
    s_waitcnt lgkmcnt(2)
    v_smfmac_f32_16x16x64_bf16 v[32:35], v[52:55], v[72:79], v4
    v_mfma_f32_32x32x16_bf16 v[64:79], v[36:39], v[36:39], 0
    s_waitcnt lgkmcnt(0)
    s_barrier
    ds_read_b128 v[12:15], v7 offset:2048
    ds_read_b128 v[16:19], v7 offset:3072
    ds_read2_b64 v[36:39], v10 offset0:0 offset1:32
    ds_read2_b64 v[40:43], v10 offset0:64 offset1:96
    ds_read_b128 v[20:23], v7 offset:4096
    ds_read_b128 v[24:27], v7 offset:5120
    v_mov_b32 v52, s86
    v_mov_b32 v53, s86
    v_mov_b32 v54, s86
    v_mov_b32 v55, s86
    s_waitcnt lgkmcnt(4)
    v_pk_add_f32 v[12:13], v[12:13], v[16:17]
    v_pk_add_f32 v[14:15], v[14:15], v[18:19]
    s_waitcnt lgkmcnt(3)
    v_pk_add_f32 v[36:37], v[36:37], v[38:39]
    s_waitcnt lgkmcnt(2)
    v_pk_add_f32 v[40:41], v[40:41], v[42:43]
    v_pk_add_f32 v[36:37], v[36:37], v[40:41]
    s_waitcnt lgkmcnt(0)
    v_pk_add_f32 v[20:21], v[20:21], v[24:25]
    v_pk_add_f32 v[22:23], v[22:23], v[26:27]
    v_pk_add_f32 v[12:13], v[12:13], v[20:21]
    v_pk_add_f32 v[14:15], v[14:15], v[22:23]
    v_max3_f32 v60, v36, v37, v12
    v_max3_f32 v60, v60, v13, v14
    v_max_f32 v60, v60, v15
    v_pk_add_f32 v[28:29], v[28:29], v[30:31]
    v_pk_add_f32 v[32:33], v[32:33], v[34:35]
    v_max_f32_dpp v60, v60, v60 row_ror:8 row_mask:0xf bank_mask:0xf bound_ctrl:0
    v_mov_b32_e64 v61, v60
    v_cvt_pk_bf16_f32 v62, v28, v29
    v_cvt_pk_bf16_f32 v63, v32, v33
    v_permlane16_swap_b32 v60, v61
    v_max_f32 v60, v60, v61
    v_mov_b32 v61, v60
    buffer_store_dwordx4 v[60:63], v0, s[52:55], s84 offen sc1
    s_nop 1
    v_permlane32_swap_b32 v60, v61
    v_max_f32 v60, v60, v61
    s_cmp_eq_u32 s5, 63
    s_cbranch_scc1 L_stependf
    v_pk_add_f32 v[36:37], v[36:37], v[60:61] op_sel_hi:[1,0] neg_lo:[0,1] neg_hi:[0,1]
    v_pk_add_f32 v[12:13], v[12:13], v[60:61] op_sel_hi:[1,0] neg_lo:[0,1] neg_hi:[0,1]
    v_pk_add_f32 v[14:15], v[14:15], v[60:61] op_sel_hi:[1,0] neg_lo:[0,1] neg_hi:[0,1]
    v_pk_mul_f32 v[36:37], v[36:37], s[80:81] op_sel_hi:[1,0]
    v_pk_mul_f32 v[12:13], v[12:13], s[80:81] op_sel_hi:[1,0]
    v_pk_mul_f32 v[14:15], v[14:15], s[80:81] op_sel_hi:[1,0]
    v_exp_f32 v36, v36
    v_exp_f32 v37, v37
    v_exp_f32 v12, v12
    v_cvt_pk_bf16_f32 v61, v36, v37
    v_exp_f32 v13, v13
    v_cndmask_b32 v22, v61, 0, s[74:75]
    v_cndmask_b32 v23, 0, v61, s[74:75]
    v_exp_f32 v14, v14
    v_exp_f32 v15, v15
    v_mfma_f32_16x16x16_bf16 v[24:27], v[62:63], v[22:23], 0
    v_cvt_pk_bf16_f32 v18, v12, v13
    v_mfma_f32_16x16x16_bf16 v[40:43], v[52:53], v[22:23], 0
    v_cvt_pk_bf16_f32 v19, v14, v15
    v_mov_b32_dpp v20, v18 row_ror:8 row_mask:0xf bank_mask:0xf bound_ctrl:0
    v_mov_b32_dpp v16, v18 row_ror:8 row_mask:0xf bank_mask:0xf bound_ctrl:0
    v_mov_b32_dpp v21, v19 row_ror:8 row_mask:0xf bank_mask:0xf bound_ctrl:0
    v_mov_b32_dpp v17, v19 row_ror:8 row_mask:0xf bank_mask:0xf bound_ctrl:0
    s_nop 0
    v_mfma_f32_16x16x32_bf16 v[28:31], v[44:47], v[18:21], v[24:27]
    v_mfma_f32_16x16x32_bf16 v[32:35], v[48:51], v[16:19], v[24:27]
    v_mfma_f32_16x16x32_bf16 v[40:43], v[52:55], v[18:21], v[40:43]
    s_nop 6
    v_cndmask_b32 v28, v28, v32, s[74:75]
    v_cndmask_b32 v29, v29, v33, s[74:75]
    v_cndmask_b32 v30, v30, v34, s[74:75]
    v_cndmask_b32 v31, v31, v35, s[74:75]
    v_rcp_f32 v36, v40
    s_nop 0
    v_pk_mul_f32 v[28:29], v[28:29], v[36:37] op_sel_hi:[1,0]
    v_pk_mul_f32 v[30:31], v[30:31], v[36:37] op_sel_hi:[1,0]
    v_cvt_pk_bf16_f32 v36, v28, v29
    v_cvt_pk_bf16_f32 v37, v30, v31
    ds_write_b64 v6, v[36:37]
    v_mfma_f32_16x16x32_bf16 v[44:47], v[64:67], v[64:67], 0
    v_mfma_f32_32x32x16_bf16 v[48:63], v[64:67], v[64:67], 0
    v_lshrrev_b32_e64 v29, 2, v0
    s_waitcnt lgkmcnt(0)
    s_barrier
    ds_read_b128 v[12:15], v7
    ds_read_b128 v[16:19], v7 offset:1024
    s_waitcnt lgkmcnt(1)
    v_smfmac_f32_16x16x64_bf16 v[44:47], v[12:15], v[112:119], v4
    s_waitcnt lgkmcnt(0)
    v_smfmac_f32_16x16x64_bf16 v[44:47], v[16:19], v[120:127], v4
    s_nop 0
    v_smfmac_f32_16x16x64_bf16 v[48:51], v[12:15], v[128:135], v4
    v_smfmac_f32_16x16x64_bf16 v[48:51], v[16:19], v[136:143], v4
    v_smfmac_f32_16x16x64_bf16 v[52:55], v[12:15], v[144:151], v4
    v_smfmac_f32_16x16x64_bf16 v[52:55], v[16:19], v[152:159], v4
    s_nop 2
    v_add_f32 v44, v44, v46
    v_add_f32 v45, v45, v47
    v_smfmac_f32_16x16x64_bf16 v[56:59], v[12:15], v[160:167], v4
    v_cvt_pk_bf16_f32 v20, v44, v45
    v_bfi_b32 v20, 1, s71, v20
    v_smfmac_f32_16x16x64_bf16 v[56:59], v[16:19], v[168:175], v4
    v_add_f32 v48, v48, v50
    v_add_f32 v49, v49, v51
    v_smfmac_f32_16x16x64_bf16 v[76:79], v[12:15], v[240:247], v4
    v_cvt_pk_bf16_f32 v21, v48, v49
    v_add_f32 v52, v52, v54
    v_smfmac_f32_16x16x64_bf16 v[76:79], v[16:19], v[248:255], v4
    v_add_f32 v53, v53, v55
    v_cvt_pk_bf16_f32 v22, v52, v53
    v_smfmac_f32_16x16x64_bf16 v[60:63], v[12:15], v[176:183], v4
    v_add_f32 v56, v56, v58
    v_add_f32 v57, v57, v59
    v_smfmac_f32_16x16x64_bf16 v[60:63], v[16:19], v[184:191], v4
    v_cvt_pk_bf16_f32 v23, v56, v57
    buffer_store_dwordx4 v[20:23], v0, s[52:55], s56 offen offset:0
    v_smfmac_f32_16x16x64_bf16 v[64:67], v[12:15], v[192:199], v4
    v_add_f32 v76, v76, v78
    v_add_f32 v77, v77, v79
    v_smfmac_f32_16x16x64_bf16 v[64:67], v[16:19], v[200:207], v4
    v_cvt_pk_bf16_f32 v28, v76, v77
    v_bfi_b32 v28, 1, s71, v28
    v_smfmac_f32_16x16x64_bf16 v[68:71], v[12:15], v[208:215], v4
    buffer_store_dword v28, v29, s[52:55], s56 offen offset:2048
    v_add_f32 v60, v60, v62
    v_smfmac_f32_16x16x64_bf16 v[68:71], v[16:19], v[216:223], v4
    v_add_f32 v61, v61, v63
    v_cvt_pk_bf16_f32 v24, v60, v61
    v_smfmac_f32_16x16x64_bf16 v[72:75], v[12:15], v[224:231], v4
    v_bfi_b32 v24, 1, s71, v24
    v_add_f32 v64, v64, v66
    v_smfmac_f32_16x16x64_bf16 v[72:75], v[16:19], v[232:239], v4
    v_add_f32 v65, v65, v67
    v_cvt_pk_bf16_f32 v25, v64, v65
    v_add_f32 v68, v68, v70
    v_add_f32 v69, v69, v71
    v_cvt_pk_bf16_f32 v26, v68, v69
    s_nop 2
    v_add_f32 v72, v72, v74
    v_add_f32_e64 v73, v73, v75
    v_cvt_pk_bf16_f32 v27, v72, v73
    buffer_store_dwordx4 v[24:27], v0, s[52:55], s56 offen offset:1024
    v_mov_b64 v[12:13], 0
    v_mov_b64 v[14:15], 0
    v_mov_b64 v[16:17], 0
    v_mov_b64 v[18:19], 0
    ds_read_b128 v[64:67], v5 offset:0
    ds_read_b128 v[68:71], v5 offset:1024
    ds_read_b128 v[72:75], v5 offset:2048
    ds_read_b128 v[76:79], v5 offset:3072
    s_cmp_eq_u32 s101, 0
    s_waitcnt lgkmcnt(0)
    s_cbranch_scc1 L_noredfp
    v_bfe_u32 v30, v0, 6, 1
    v_lshlrev_b32 v30, 4, v30
    v_mov_b32 v31, 0x3f80
    v_lshlrev_b32 v31, v30, v31
    v_lshrrev_b32 v30, 7, v0
    v_mul_u32_u24 v40, 9216, v30
    v_and_b32 v30, 112, v0
    v_add3_u32 v40, v40, v30, s60
    v_cndmask_b32 v32, 0, v31, s[62:63]
    v_cndmask_b32 v33, 0, v31, s[64:65]
    v_cndmask_b32 v34, 0, v31, s[66:67]
    v_cndmask_b32 v35, 0, v31, s[78:79]
    v_mov_b32 v30, s71
    v_mov_b64 v[42:43], -1
    s_waitcnt vmcnt(0)
    s_nop 0
L_redf:
    buffer_load_dwordx4 v[44:47], v40, s[52:55], s88 offen sc1
    buffer_load_dwordx4 v[48:51], v40, s[52:55], s89 offen sc1
    buffer_load_dwordx4 v[52:55], v40, s[52:55], s90 offen sc1
    buffer_load_dwordx4 v[56:59], v40, s[52:55], s91 offen sc1
    s_sub_u32 s81, s81, 1
    s_cbranch_scc1 L_main_done
    s_waitcnt vmcnt(3)
    v_mfma_f32_16x16x32_bf16 v[36:39], v[32:35], v[44:47], 0
    s_waitcnt vmcnt(2)
    v_mfma_f32_16x16x32_bf16 v[36:39], v[32:35], v[48:51], v[36:39]
    v_bitop3_b32 v60, v44, v48, v30 bitop3:0x7e
    s_waitcnt vmcnt(1)
    v_mfma_f32_16x16x32_bf16 v[36:39], v[32:35], v[52:55], v[36:39]
    s_waitcnt vmcnt(0)
    v_mfma_f32_16x16x32_bf16 v[36:39], v[32:35], v[56:59], v[36:39]
    v_bitop3_b32 v61, v52, v56, v30 bitop3:0x7e
    v_bitop3_b32 v60, v60, v61, 1 bitop3:0xa8
    v_cmp_ne_u32 vcc, 0, v60
    s_nop 4
    v_add_f32_dpp v20, v36, v36 row_ror:8 row_mask:0xf bank_mask:0xf bound_ctrl:0
    v_add_f32_dpp v21, v37, v37 row_ror:8 row_mask:0xf bank_mask:0xf bound_ctrl:0
    v_add_f32_dpp v22, v38, v38 row_ror:8 row_mask:0xf bank_mask:0xf bound_ctrl:0
    v_add_f32_dpp v23, v39, v39 row_ror:8 row_mask:0xf bank_mask:0xf bound_ctrl:0
    s_cbranch_vccnz L_redf
    v_cvt_pk_bf16_f32 v62, v20, v21
    v_cvt_pk_bf16_f32 v63, v22, v23
    v_min_u32 v62, -2, v62
    buffer_store_dwordx2 v[62:63], v1, s[52:55], s70 offen
    buffer_store_dwordx2 v[42:43], v1, s[52:55], s69 offen
L_noredf:
    s_barrier
    s_mov_b32 s69, s70
    s_add_u32 s70, s70, 9216
    s_cmp_eq_u32 s70, 0x8106c00
    s_cselect_b32 s70, 0x8100000, s70
    s_xor_b32 s71, s71, 1
    s_add_u32 s72, s72, 262144
    s_add_u32 s73, s73, 131072
    s_add_u32 s5, s5, 1
    s_branch L_stepf
L_noredfp:
    s_waitcnt vmcnt(0)
    s_branch L_noredf
L_stependf:
    s_waitcnt vmcnt(0)
    s_barrier
    v_mov_b32 v16, 64
    buffer_store_dword v16, off, s[52:55], s100 sc1
    s_nop 1
    s_branch L_main_done
L_m_slow:
    ds_read_b128 v[64:67], v5 offset:0
    ds_read_b128 v[68:71], v5 offset:1024
    ds_read_b128 v[72:75], v5 offset:2048
    ds_read_b128 v[76:79], v5 offset:3072
    v_mov_b64 v[12:13], 0
    v_mov_b64 v[14:15], 0
    v_mov_b64 v[16:17], 0
    v_mov_b64 v[18:19], 0
    s_nop 1
    s_waitcnt lgkmcnt(0)
L_steps:
    s_add_u32 s84, s5, 1
    s_min_u32 s84, s84, 63
    s_cmp_lt_u32 s84, s83
    s_cbranch_scc1 L_kvok_8
    s_branch L_kv_7b
L_kv_7:
    s_sleep 6
L_kv_7b:
    v_lshrrev_b32 v52, 2, v0
    v_and_b32 v52, 63, v52
    buffer_load_dword v53, v52, s[48:51], 0 offen offset:32 sc1
    s_waitcnt vmcnt(0)
    v_cmp_gt_u32 vcc, 64, v53
    s_nop 0
    s_or_b32 s85, vcc_lo, 0x10000
    s_ff1_i32_b32 s85, s85
    s_lshl_b32 s83, s85, 2
    s_sub_u32 s81, s81, 1
    s_cbranch_scc1 L_main_done
    s_cmp_lt_u32 s84, s83
    s_cbranch_scc0 L_kv_7
L_kvok_8:
    v_mov_b64 v[20:21], 0
    v_mov_b64 v[22:23], 0
    v_mov_b64 v[24:25], 0
    v_mov_b64 v[26:27], 0
    v_mov_b64 v[28:29], 0
    v_mov_b64 v[30:31], 0
    v_mov_b64 v[32:33], 0
    v_mov_b64_e64 v[34:35], 0
    s_sub_u32 s84, s69, 149504
    s_add_u32 s85, s84, 3072
    s_add_u32 s86, s84, 6144
    s_cmp_eq_u32 s3, 3
    s_cbranch_scc1 L_joins
L_gathers:
    buffer_load_dwordx4 v[52:55], v8, s[52:55], s84 offen sc1
    buffer_load_dwordx4 v[56:59], v8, s[52:55], s85 offen sc1
    buffer_load_dwordx4 v[60:63], v8, s[52:55], s86 offen sc1
    s_sub_u32 s81, s81, 1
    s_cbranch_scc1 L_main_done
    s_waitcnt vmcnt(2)
    ds_write_b128 v8, v[52:55] offset:5120
    v_max_u32 v11, v52, v54
    s_waitcnt vmcnt(1)
    ds_write_b128 v8, v[56:59] offset:8192
    v_max3_u32 v11, v11, v56, v58
    s_waitcnt vmcnt(0)
    ds_write_b128 v8, v[60:63] offset:11264
    v_max3_u32 v11, v11, v60, v62
    v_cmp_eq_u32 vcc, -1, v11
    s_waitcnt lgkmcnt(0)
    s_nop 2
    s_cbranch_vccnz L_gathers
    s_nop 1
L_joins:
    s_barrier
    ds_read_b128 v[52:55], v7 offset:7168
    ds_read_b128 v[56:59], v7 offset:8192
    ds_read_b128 v[60:63], v7 offset:9216
    s_add_u32 s85, s57, s72
    s_add_u32 s86, s58, s72
    s_add_u32 s84, s85, 4096
    s_cmp_ge_u32 s5, 63
    s_cselect_b32 s87, 0, 262144
    s_add_u32 s87, s87, s72
    s_add_u32 s87, s87, s68
    v_lshlrev_b32 v11, 2, v0
    s_waitcnt lgkmcnt(2)
    v_smfmac_f32_16x16x64_bf16 v[28:31], v[52:55], v[64:71], v4
    ds_read_b128 v[64:67], v5 offset:4096
    v_smfmac_f32_16x16x64_bf16 v[12:15], v[52:55], a[0:7], v4
    ds_read_b128 v[68:71], v5 offset:5120
    v_smfmac_f32_16x16x64_bf16 v[20:23], v[52:55], a[144:151], v4
    buffer_load_dwordx4 v[36:39], v0, s[52:55], s85 offen sc1
    v_smfmac_f32_16x16x64_bf16 v[32:35], v[52:55], v[72:79], v4
    ds_read_b128 v[72:75], v5 offset:6144
    v_smfmac_f32_16x16x64_bf16 v[16:19], v[52:55], a[72:79], v4
    ds_read_b128 v[76:79], v5 offset:7168
    v_smfmac_f32_16x16x64_bf16 v[24:27], v[52:55], a[216:223], v4
    ds_read_b128 v[52:55], v7 offset:10240
    s_waitcnt lgkmcnt(3)
    v_smfmac_f32_16x16x64_bf16 v[28:31], v[56:59], v[64:71], v4
    ds_read_b128 v[64:67], v5 offset:8192
    v_smfmac_f32_16x16x64_bf16 v[12:15], v[56:59], a[8:15], v4
    ds_read_b128 v[68:71], v5 offset:9216
    v_smfmac_f32_16x16x64_bf16 v[20:23], v[56:59], a[152:159], v4
    buffer_load_dwordx4 v[40:43], v0, s[52:55], s84 offen sc1
    s_waitcnt lgkmcnt(3)
    v_smfmac_f32_16x16x64_bf16 v[32:35], v[56:59], v[72:79], v4
    ds_read_b128 v[72:75], v5 offset:10240
    v_smfmac_f32_16x16x64_bf16 v[16:19], v[56:59], a[80:87], v4
    ds_read_b128 v[76:79], v5 offset:11264
    v_smfmac_f32_16x16x64_bf16 v[24:27], v[56:59], a[224:231], v4
    ds_read_b128 v[56:59], v7 offset:11264
    s_waitcnt lgkmcnt(3)
    v_smfmac_f32_16x16x64_bf16 v[28:31], v[60:63], v[64:71], v4
    ds_read_b128 v[64:67], v5 offset:12288
    v_smfmac_f32_16x16x64_bf16 v[12:15], v[60:63], a[16:23], v4
    ds_read_b128 v[68:71], v5 offset:13312
    v_smfmac_f32_16x16x64_bf16 v[20:23], v[60:63], a[160:167], v4
    buffer_load_dwordx4 v[44:47], v0, s[52:55], s86 offen sc1
    s_waitcnt lgkmcnt(3)
    v_smfmac_f32_16x16x64_bf16 v[32:35], v[60:63], v[72:79], v4
    ds_read_b128 v[72:75], v5 offset:14336
    v_smfmac_f32_16x16x64_bf16 v[16:19], v[60:63], a[88:95], v4
    ds_read_b128 v[76:79], v5 offset:15360
    v_smfmac_f32_16x16x64_bf16 v[24:27], v[60:63], a[232:239], v4
    ds_read_b128 v[60:63], v7 offset:12288
    s_waitcnt lgkmcnt(3)
    v_smfmac_f32_16x16x64_bf16 v[28:31], v[52:55], v[64:71], v4
    ds_read_b128 v[64:67], v5 offset:16384
    v_smfmac_f32_16x16x64_bf16 v[12:15], v[52:55], a[24:31], v4
    ds_read_b128 v[68:71], v5 offset:17408
    v_smfmac_f32_16x16x64_bf16 v[20:23], v[52:55], a[168:175], v4
    buffer_load_dwordx4 v[48:51], v0, s[52:55], s86 offen offset:1024 sc1
    s_waitcnt lgkmcnt(3)
    v_smfmac_f32_16x16x64_bf16 v[32:35], v[52:55], v[72:79], v4
    ds_read_b128 v[72:75], v5 offset:18432
    v_smfmac_f32_16x16x64_bf16 v[16:19], v[52:55], a[96:103], v4
    ds_read_b128 v[76:79], v5 offset:19456
    v_smfmac_f32_16x16x64_bf16 v[24:27], v[52:55], a[240:247], v4
    ds_read_b128 v[52:55], v7 offset:13312
    s_waitcnt lgkmcnt(3)
    v_smfmac_f32_16x16x64_bf16 v[28:31], v[56:59], v[64:71], v4
    ds_read_b128 v[64:67], v5 offset:20480
    v_smfmac_f32_16x16x64_bf16 v[12:15], v[56:59], a[32:39], v4
    ds_read_b128 v[68:71], v5 offset:21504
    v_smfmac_f32_16x16x64_bf16 v[20:23], v[56:59], a[176:183], v4
    buffer_load_dword v11, v11, s[52:55], s87 offen sc1
    s_waitcnt lgkmcnt(3)
    v_smfmac_f32_16x16x64_bf16 v[32:35], v[56:59], v[72:79], v4
    ds_read_b128 v[72:75], v5 offset:22528
    v_smfmac_f32_16x16x64_bf16 v[16:19], v[56:59], a[104:111], v4
    ds_read_b128 v[76:79], v5 offset:23552
    v_smfmac_f32_16x16x64_bf16 v[24:27], v[56:59], a[248:255], v4
    ds_read_b128 v[56:59], v7 offset:14336
    s_waitcnt lgkmcnt(3)
    v_smfmac_f32_16x16x64_bf16 v[28:31], v[60:63], v[64:71], v4
    ds_read_b128 v[64:67], v5 offset:24576
    v_smfmac_f32_16x16x64_bf16 v[12:15], v[60:63], a[40:47], v4
    ds_read_b128 v[68:71], v5 offset:25600
    v_smfmac_f32_16x16x64_bf16 v[20:23], v[60:63], a[184:191], v4
    s_waitcnt lgkmcnt(3)
    v_smfmac_f32_16x16x64_bf16 v[32:35], v[60:63], v[72:79], v4
    ds_read_b128 v[72:75], v5 offset:26624
    v_smfmac_f32_16x16x64_bf16 v[16:19], v[60:63], a[112:119], v4
    ds_read_b128 v[76:79], v5 offset:27648
    v_smfmac_f32_16x16x64_bf16 v[24:27], v[60:63], v[80:87], v4
    ds_read_b128 v[60:63], v7 offset:15360
    s_waitcnt lgkmcnt(3)
    v_smfmac_f32_16x16x64_bf16 v[28:31], v[52:55], v[64:71], v4
    ds_read_b128 v[64:67], v5 offset:28672
    v_smfmac_f32_16x16x64_bf16 v[12:15], v[52:55], a[48:55], v4
    ds_read_b128 v[68:71], v5 offset:29696
    v_smfmac_f32_16x16x64_bf16 v[20:23], v[52:55], a[192:199], v4
    s_waitcnt vmcnt(1)
    s_waitcnt lgkmcnt(3)
    v_smfmac_f32_16x16x64_bf16 v[32:35], v[52:55], v[72:79], v4
    ds_read_b128 v[72:75], v5 offset:30720
    v_smfmac_f32_16x16x64_bf16 v[16:19], v[52:55], a[120:127], v4
    ds_read_b128 v[76:79], v5 offset:31744
    v_smfmac_f32_16x16x64_bf16 v[24:27], v[52:55], v[88:95], v4
    ds_read_b128 v[52:55], v7 offset:15360
    v_smfmac_f32_16x16x64_bf16 v[12:15], v[56:59], a[56:63], v4
    v_smfmac_f32_16x16x64_bf16 v[20:23], v[56:59], a[200:207], v4
    s_cmp_lg_u32 s3, 3
    s_cbranch_scc1 L_prog_9
    v_mov_b32 v1, s5
    buffer_store_dword v1, off, s[52:55], s100 sc1
L_prog_9:
    v_smfmac_f32_16x16x64_bf16 v[16:19], v[56:59], a[128:135], v4
    v_smfmac_f32_16x16x64_bf16 v[24:27], v[56:59], v[96:103], v4
    ds_read_b128 v[56:59], v7 offset:14336
    s_waitcnt lgkmcnt(6)
    v_smfmac_f32_16x16x64_bf16 v[12:15], v[60:63], a[64:71], v4
    v_smfmac_f32_16x16x64_bf16 v[16:19], v[60:63], a[136:143], v4
    v_smfmac_f32_16x16x64_bf16 v[20:23], v[60:63], a[208:215], v4
    v_smfmac_f32_16x16x64_bf16 v[24:27], v[60:63], v[104:111], v4
    s_add_u32 s84, s73, s82
    s_add_u32 s85, s59, s73
    s_mov_b32 s86, 0x3f803f80
    s_waitcnt lgkmcnt(0)
    v_smfmac_f32_16x16x64_bf16 v[28:31], v[56:59], v[64:71], v4
    ds_read_b128 v[64:67], v5 offset:32768
    ds_read_b128 v[68:71], v5 offset:33792
    v_add_f32 v12, v12, v14
    v_add_f32 v13, v13, v15
    v_cvt_pk_bf16_f32 v60, v12, v13
    v_add_f32 v16, v16, v18
    v_add_f32_e64 v17, v17, v19
    v_cvt_pk_bf16_f32 v61, v16, v17
    ds_write2_b32 v2, v60, v61 offset0:0 offset1:64
    v_pk_add_f32 v[20:21], v[20:21], v[22:23]
    v_cvt_pk_bf16_f32 v62, v20, v21
    v_pk_add_f32 v[24:25], v[24:25], v[26:27]
    v_cvt_pk_bf16_f32 v63, v24, v25
    ds_read_b64_tr_b16 v[12:13], v3 offset:0
    ds_read_b64_tr_b16 v[14:15], v3 offset:64
    ds_write2_b32 v2, v62, v63 offset0:128 offset1:192
    ds_read_b64_tr_b16 v[16:17], v3 offset:512
    ds_read_b64_tr_b16 v[18:19], v3 offset:576
    v_smfmac_f32_16x16x64_bf16 v[32:35], v[56:59], v[72:79], v4
    ds_read_b128 v[72:75], v5 offset:34816
    ds_read_b128 v[76:79], v5 offset:35840
    s_waitcnt lgkmcnt(5)
    v_mfma_f32_16x16x32_bf16 v[20:23], v[36:39], v[12:15], 0
    v_mfma_f32_16x16x32_bf16 v[24:27], v[40:43], v[12:15], 0
    s_waitcnt lgkmcnt(2)
    v_mfma_f32_16x16x32_bf16 v[60:63], v[16:19], v[12:15], 0
    buffer_store_dwordx4 v[16:19], v0, s[52:55], s85 offen sc1
    v_mov_b64_e64 v[36:37], 0
    v_mov_b64 v[38:39], 0
    s_nop 2
    v_cndmask_b32 v20, v20, v24, s[74:75]
    v_cndmask_b32 v21, v21, v25, s[74:75]
    v_cndmask_b32 v22, v22, v26, s[74:75]
    v_cndmask_b32 v23, v23, v27, s[74:75]
    ds_write_b128 v8, v[20:23]
    v_cndmask_b32 v60, v60, v61, s[74:75]
    v_cndmask_b32 v62, v62, v63, s[74:75]
    v_cndmask_b32 v60, v60, v62, s[76:77]
    ds_write_b32 v9, v60
    v_smfmac_f32_16x16x64_bf16 v[28:31], v[52:55], v[64:71], v4
    s_waitcnt lgkmcnt(2)
    v_smfmac_f32_16x16x64_bf16 v[32:35], v[52:55], v[72:79], v4
    v_mfma_f32_32x32x16_bf16 v[64:79], v[36:39], v[36:39], 0
    s_waitcnt lgkmcnt(0)
    s_barrier
    ds_read_b128 v[12:15], v7 offset:2048
    ds_read_b128 v[16:19], v7 offset:3072
    ds_read2_b64 v[36:39], v10 offset0:0 offset1:32
    ds_read2_b64 v[40:43], v10 offset0:64 offset1:96
    ds_read_b128 v[20:23], v7 offset:4096
    ds_read_b128 v[24:27], v7 offset:5120
    v_mov_b32 v52, s86
    v_mov_b32 v53, s86
    v_mov_b32 v54, s86
    v_mov_b32 v55, s86
    s_waitcnt lgkmcnt(4)
    v_pk_add_f32 v[12:13], v[12:13], v[16:17]
    v_pk_add_f32 v[14:15], v[14:15], v[18:19]
    s_waitcnt lgkmcnt(3)
    v_pk_add_f32 v[36:37], v[36:37], v[38:39]
    s_waitcnt lgkmcnt(2)
    v_pk_add_f32 v[40:41], v[40:41], v[42:43]
    v_pk_add_f32 v[36:37], v[36:37], v[40:41]
    s_waitcnt lgkmcnt(0)
    v_pk_add_f32 v[20:21], v[20:21], v[24:25]
    v_pk_add_f32 v[22:23], v[22:23], v[26:27]
    v_pk_add_f32 v[12:13], v[12:13], v[20:21]
    v_pk_add_f32 v[14:15], v[14:15], v[22:23]
    v_max3_f32 v60, v36, v37, v12
    v_max3_f32 v60, v60, v13, v14
    v_max_f32 v60, v60, v15
    v_pk_add_f32 v[28:29], v[28:29], v[30:31]
    v_pk_add_f32 v[32:33], v[32:33], v[34:35]
    v_max_f32_dpp v60, v60, v60 row_ror:8 row_mask:0xf bank_mask:0xf bound_ctrl:0
    v_mov_b32_e64 v61, v60
    v_cvt_pk_bf16_f32 v62, v28, v29
    v_cvt_pk_bf16_f32 v63, v32, v33
    v_permlane16_swap_b32 v60, v61
    v_max_f32 v60, v60, v61
    v_mov_b32 v61, v60
    buffer_store_dwordx4 v[60:63], v0, s[52:55], s84 offen sc1
    s_nop 1
    v_permlane32_swap_b32 v60, v61
    v_max_f32 v60, v60, v61
    s_cmp_eq_u32 s5, 63
    s_cbranch_scc1 L_stepends
    v_pk_add_f32 v[36:37], v[36:37], v[60:61] op_sel_hi:[1,0] neg_lo:[0,1] neg_hi:[0,1]
    v_pk_add_f32 v[12:13], v[12:13], v[60:61] op_sel_hi:[1,0] neg_lo:[0,1] neg_hi:[0,1]
    v_pk_add_f32 v[14:15], v[14:15], v[60:61] op_sel_hi:[1,0] neg_lo:[0,1] neg_hi:[0,1]
    v_pk_mul_f32 v[36:37], v[36:37], s[80:81] op_sel_hi:[1,0]
    v_pk_mul_f32 v[12:13], v[12:13], s[80:81] op_sel_hi:[1,0]
    v_pk_mul_f32 v[14:15], v[14:15], s[80:81] op_sel_hi:[1,0]
    v_exp_f32 v36, v36
    v_exp_f32 v37, v37
    v_exp_f32 v12, v12
    v_cvt_pk_bf16_f32 v61, v36, v37
    v_exp_f32 v13, v13
    v_cndmask_b32 v22, v61, 0, s[74:75]
    v_cndmask_b32 v23, 0, v61, s[74:75]
    v_exp_f32 v14, v14
    v_exp_f32 v15, v15
    v_mfma_f32_16x16x16_bf16 v[24:27], v[62:63], v[22:23], 0
    v_cvt_pk_bf16_f32 v18, v12, v13
    v_mfma_f32_16x16x16_bf16 v[40:43], v[52:53], v[22:23], 0
    v_cvt_pk_bf16_f32 v19, v14, v15
    v_mov_b32_dpp v20, v18 row_ror:8 row_mask:0xf bank_mask:0xf bound_ctrl:0
    v_mov_b32_dpp v16, v18 row_ror:8 row_mask:0xf bank_mask:0xf bound_ctrl:0
    v_mov_b32_dpp v21, v19 row_ror:8 row_mask:0xf bank_mask:0xf bound_ctrl:0
    v_mov_b32_dpp v17, v19 row_ror:8 row_mask:0xf bank_mask:0xf bound_ctrl:0
    s_nop 0
    v_mfma_f32_16x16x32_bf16 v[28:31], v[44:47], v[18:21], v[24:27]
    v_mfma_f32_16x16x32_bf16 v[32:35], v[48:51], v[16:19], v[24:27]
    v_mfma_f32_16x16x32_bf16 v[40:43], v[52:55], v[18:21], v[40:43]
    s_nop 6
    v_cndmask_b32 v28, v28, v32, s[74:75]
    v_cndmask_b32 v29, v29, v33, s[74:75]
    v_cndmask_b32 v30, v30, v34, s[74:75]
    v_cndmask_b32 v31, v31, v35, s[74:75]
    v_rcp_f32 v36, v40
    s_nop 0
    v_pk_mul_f32 v[28:29], v[28:29], v[36:37] op_sel_hi:[1,0]
    v_pk_mul_f32 v[30:31], v[30:31], v[36:37] op_sel_hi:[1,0]
    v_cvt_pk_bf16_f32 v36, v28, v29
    v_cvt_pk_bf16_f32 v37, v30, v31
    ds_write_b64 v6, v[36:37]
    v_mfma_f32_16x16x32_bf16 v[44:47], v[64:67], v[64:67], 0
    v_mfma_f32_32x32x16_bf16 v[48:63], v[64:67], v[64:67], 0
    v_lshrrev_b32_e64 v29, 2, v0
    s_waitcnt lgkmcnt(0)
    s_barrier
    ds_read_b128 v[12:15], v7
    ds_read_b128 v[16:19], v7 offset:1024
    s_waitcnt lgkmcnt(1)
    v_smfmac_f32_16x16x64_bf16 v[44:47], v[12:15], v[112:119], v4
    s_waitcnt lgkmcnt(0)
    v_smfmac_f32_16x16x64_bf16 v[44:47], v[16:19], v[120:127], v4
    s_nop 0
    v_smfmac_f32_16x16x64_bf16 v[48:51], v[12:15], v[128:135], v4
    v_smfmac_f32_16x16x64_bf16 v[48:51], v[16:19], v[136:143], v4
    v_smfmac_f32_16x16x64_bf16 v[52:55], v[12:15], v[144:151], v4
    v_smfmac_f32_16x16x64_bf16 v[52:55], v[16:19], v[152:159], v4
    s_nop 2
    v_add_f32 v44, v44, v46
    v_add_f32 v45, v45, v47
    v_smfmac_f32_16x16x64_bf16 v[56:59], v[12:15], v[160:167], v4
    v_cvt_pk_bf16_f32 v20, v44, v45
    v_bfi_b32 v20, 1, s71, v20
    v_smfmac_f32_16x16x64_bf16 v[56:59], v[16:19], v[168:175], v4
    v_add_f32 v48, v48, v50
    v_add_f32 v49, v49, v51
    v_smfmac_f32_16x16x64_bf16 v[76:79], v[12:15], v[240:247], v4
    v_cvt_pk_bf16_f32 v21, v48, v49
    v_add_f32 v52, v52, v54
    v_smfmac_f32_16x16x64_bf16 v[76:79], v[16:19], v[248:255], v4
    v_add_f32 v53, v53, v55
    v_cvt_pk_bf16_f32 v22, v52, v53
    v_smfmac_f32_16x16x64_bf16 v[60:63], v[12:15], v[176:183], v4
    v_add_f32 v56, v56, v58
    v_add_f32 v57, v57, v59
    v_smfmac_f32_16x16x64_bf16 v[60:63], v[16:19], v[184:191], v4
    v_cvt_pk_bf16_f32 v23, v56, v57
    buffer_store_dwordx4 v[20:23], v0, s[52:55], s56 offen offset:0 sc1
    v_smfmac_f32_16x16x64_bf16 v[64:67], v[12:15], v[192:199], v4
    v_add_f32 v76, v76, v78
    v_add_f32 v77, v77, v79
    v_smfmac_f32_16x16x64_bf16 v[64:67], v[16:19], v[200:207], v4
    v_cvt_pk_bf16_f32 v28, v76, v77
    v_bfi_b32 v28, 1, s71, v28
    v_smfmac_f32_16x16x64_bf16 v[68:71], v[12:15], v[208:215], v4
    buffer_store_dword v28, v29, s[52:55], s56 offen offset:2048 sc1
    v_add_f32 v60, v60, v62
    v_smfmac_f32_16x16x64_bf16 v[68:71], v[16:19], v[216:223], v4
    v_add_f32 v61, v61, v63
    v_cvt_pk_bf16_f32 v24, v60, v61
    v_smfmac_f32_16x16x64_bf16 v[72:75], v[12:15], v[224:231], v4
    v_bfi_b32 v24, 1, s71, v24
    v_add_f32 v64, v64, v66
    v_smfmac_f32_16x16x64_bf16 v[72:75], v[16:19], v[232:239], v4
    v_add_f32 v65, v65, v67
    v_cvt_pk_bf16_f32 v25, v64, v65
    v_add_f32 v68, v68, v70
    v_add_f32 v69, v69, v71
    v_cvt_pk_bf16_f32 v26, v68, v69
    s_nop 2
    v_add_f32 v72, v72, v74
    v_add_f32_e64 v73, v73, v75
    v_cvt_pk_bf16_f32 v27, v72, v73
    buffer_store_dwordx4 v[24:27], v0, s[52:55], s56 offen offset:1024 sc1
    v_mov_b64 v[12:13], 0
    v_mov_b64 v[14:15], 0
    v_mov_b64 v[16:17], 0
    v_mov_b64 v[18:19], 0
    ds_read_b128 v[64:67], v5 offset:0
    ds_read_b128 v[68:71], v5 offset:1024
    ds_read_b128 v[72:75], v5 offset:2048
    ds_read_b128 v[76:79], v5 offset:3072
    s_cmp_eq_u32 s101, 0
    s_waitcnt lgkmcnt(0)
    s_cbranch_scc1 L_noredsp
    v_bfe_u32 v30, v0, 6, 1
    v_lshlrev_b32 v30, 4, v30
    v_mov_b32 v31, 0x3f80
    v_lshlrev_b32 v31, v30, v31
    v_lshrrev_b32 v30, 7, v0
    v_mul_u32_u24 v40, 9216, v30
    v_and_b32 v30, 112, v0
    v_add3_u32 v40, v40, v30, s60
    v_cndmask_b32 v32, 0, v31, s[62:63]
    v_cndmask_b32 v33, 0, v31, s[64:65]
    v_cndmask_b32 v34, 0, v31, s[66:67]
    v_cndmask_b32 v35, 0, v31, s[78:79]
    v_mov_b32 v30, s71
    v_mov_b64 v[42:43], -1
    s_waitcnt vmcnt(0)
    s_nop 0
L_reds:
    buffer_load_dwordx4 v[44:47], v40, s[52:55], s88 offen sc1
    buffer_load_dwordx4 v[48:51], v40, s[52:55], s89 offen sc1
    buffer_load_dwordx4 v[52:55], v40, s[52:55], s90 offen sc1
    buffer_load_dwordx4 v[56:59], v40, s[52:55], s91 offen sc1
    s_sub_u32 s81, s81, 1
    s_cbranch_scc1 L_main_done
    s_waitcnt vmcnt(3)
    v_mfma_f32_16x16x32_bf16 v[36:39], v[32:35], v[44:47], 0
    s_waitcnt vmcnt(2)
    v_mfma_f32_16x16x32_bf16 v[36:39], v[32:35], v[48:51], v[36:39]
    v_bitop3_b32 v60, v44, v48, v30 bitop3:0x7e
    s_waitcnt vmcnt(1)
    v_mfma_f32_16x16x32_bf16 v[36:39], v[32:35], v[52:55], v[36:39]
    s_waitcnt vmcnt(0)
    v_mfma_f32_16x16x32_bf16 v[36:39], v[32:35], v[56:59], v[36:39]
    v_bitop3_b32 v61, v52, v56, v30 bitop3:0x7e
    v_bitop3_b32 v60, v60, v61, 1 bitop3:0xa8
    v_cmp_ne_u32 vcc, 0, v60
    s_nop 4
    v_add_f32_dpp v20, v36, v36 row_ror:8 row_mask:0xf bank_mask:0xf bound_ctrl:0
    v_add_f32_dpp v21, v37, v37 row_ror:8 row_mask:0xf bank_mask:0xf bound_ctrl:0
    v_add_f32_dpp v22, v38, v38 row_ror:8 row_mask:0xf bank_mask:0xf bound_ctrl:0
    v_add_f32_dpp v23, v39, v39 row_ror:8 row_mask:0xf bank_mask:0xf bound_ctrl:0
    s_cbranch_vccnz L_reds
    v_cvt_pk_bf16_f32 v62, v20, v21
    v_cvt_pk_bf16_f32 v63, v22, v23
    v_min_u32 v62, -2, v62
    buffer_store_dwordx2 v[62:63], v1, s[52:55], s70 offen sc1
    buffer_store_dwordx2 v[42:43], v1, s[52:55], s69 offen sc1
L_noreds:
    s_barrier
    s_mov_b32 s69, s70
    s_add_u32 s70, s70, 9216
    s_cmp_eq_u32 s70, 0x8106c00
    s_cselect_b32 s70, 0x8100000, s70
    s_xor_b32 s71, s71, 1
    s_add_u32 s72, s72, 262144
    s_add_u32 s73, s73, 131072
    s_add_u32 s5, s5, 1
    s_branch L_steps
L_noredsp:
    s_waitcnt vmcnt(0)
    s_branch L_noreds
L_stepends:
    s_waitcnt vmcnt(0)
    s_barrier
    v_mov_b32 v16, 64
    buffer_store_dword v16, off, s[52:55], s100 sc1
    s_nop 1
    s_branch L_main_done
L_m_work:
    s_sub_u32 s5, s4, 32
    s_sub_u32 s101, s5, 96
    s_cmp_ge_u32 s5, 128
    s_cbranch_scc1 L_m_doln
    s_cmp_lt_u32 s5, 64
    s_cbranch_scc1 L_m_noln
    s_bitcmp0_b32 s5, 0
    s_cbranch_scc1 L_m_noln
    s_sub_u32 s101, s5, 64
    s_lshr_b32 s101, s101, 1
L_m_doln:
    v_and_b32 v2, 15, v1
    v_lshrrev_b32 v3, 4, v1
    v_mov_b32 v57, 0
    v_mov_b32 v58, 0
    s_cmp_eq_u32 s3, 3
    s_nop 0
    s_cbranch_scc1 L_ln_skip168_2251
    s_mul_i32 s84, s101, 18432
    s_mul_i32 s85, s3, 384
    s_add_u32 s84, s84, s85
    v_mul_u32_u24 v4, 1152, v2
    v_lshl_add_u32 v4, v3, 4, v4
    buffer_load_dwordx4 v[8:11], v4, s[8:11], s84 offen offset:0
    buffer_load_dwordx4 v[12:15], v4, s[8:11], s84 offen offset:64
    buffer_load_dwordx4 v[16:19], v4, s[8:11], s84 offen offset:128
    buffer_load_dwordx4 v[20:23], v4, s[8:11], s84 offen offset:192
    buffer_load_dwordx4 v[24:27], v4, s[8:11], s84 offen offset:256
    buffer_load_dwordx4 v[28:31], v4, s[8:11], s84 offen offset:320
    v_mov_b32 v5, 0
    s_waitcnt vmcnt(5)
    v_lshlrev_b32 v32, 16, v8
    v_and_b32 v33, 0xffff0000, v8
    v_add_f32 v5, v5, v32
    v_add_f32 v5, v5, v33
    v_lshlrev_b32 v32, 16, v9
    v_and_b32 v33, 0xffff0000, v9
    v_add_f32 v5, v5, v32
    v_add_f32 v5, v5, v33
    v_lshlrev_b32 v32, 16, v10
    v_and_b32 v33, 0xffff0000, v10
    v_add_f32 v5, v5, v32
    v_add_f32 v5, v5, v33
    v_lshlrev_b32 v32, 16, v11
    v_and_b32 v33, 0xffff0000, v11
    v_add_f32 v5, v5, v32
    v_add_f32 v5, v5, v33
    s_waitcnt vmcnt(4)
    v_lshlrev_b32 v32, 16, v12
    v_and_b32 v33, 0xffff0000, v12
    v_add_f32 v5, v5, v32
    v_add_f32 v5, v5, v33
    v_lshlrev_b32 v32, 16, v13
    v_and_b32 v33, 0xffff0000, v13
    v_add_f32 v5, v5, v32
    v_add_f32 v5, v5, v33
    v_lshlrev_b32 v32, 16, v14
    v_and_b32 v33, 0xffff0000, v14
    v_add_f32 v5, v5, v32
    v_add_f32 v5, v5, v33
    v_lshlrev_b32 v32, 16, v15
    v_and_b32 v33, 0xffff0000, v15
    v_add_f32 v5, v5, v32
    v_add_f32 v5, v5, v33
    s_waitcnt vmcnt(3)
    v_lshlrev_b32 v32, 16, v16
    v_and_b32 v33, 0xffff0000, v16
    v_add_f32 v5, v5, v32
    v_add_f32 v5, v5, v33
    v_lshlrev_b32 v32, 16, v17
    v_and_b32 v33, 0xffff0000, v17
    v_add_f32 v5, v5, v32
    v_add_f32 v5, v5, v33
    v_lshlrev_b32 v32, 16, v18
    v_and_b32 v33, 0xffff0000, v18
    v_add_f32 v5, v5, v32
    v_add_f32 v5, v5, v33
    v_lshlrev_b32 v32, 16, v19
    v_and_b32 v33, 0xffff0000, v19
    v_add_f32 v5, v5, v32
    v_add_f32 v5, v5, v33
    s_waitcnt vmcnt(2)
    v_lshlrev_b32 v32, 16, v20
    v_and_b32 v33, 0xffff0000, v20
    v_add_f32 v5, v5, v32
    v_add_f32 v5, v5, v33
    v_lshlrev_b32 v32, 16, v21
    v_and_b32 v33, 0xffff0000, v21
    v_add_f32 v5, v5, v32
    v_add_f32 v5, v5, v33
    v_lshlrev_b32 v32, 16, v22
    v_and_b32 v33, 0xffff0000, v22
    v_add_f32 v5, v5, v32
    v_add_f32 v5, v5, v33
    v_lshlrev_b32 v32, 16, v23
    v_and_b32 v33, 0xffff0000, v23
    v_add_f32 v5, v5, v32
    v_add_f32 v5, v5, v33
    s_waitcnt vmcnt(1)
    v_lshlrev_b32 v32, 16, v24
    v_and_b32 v33, 0xffff0000, v24
    v_add_f32 v5, v5, v32
    v_add_f32 v5, v5, v33
    v_lshlrev_b32 v32, 16, v25
    v_and_b32 v33, 0xffff0000, v25
    v_add_f32 v5, v5, v32
    v_add_f32 v5, v5, v33
    v_lshlrev_b32 v32, 16, v26
    v_and_b32 v33, 0xffff0000, v26
    v_add_f32 v5, v5, v32
    v_add_f32 v5, v5, v33
    v_lshlrev_b32 v32, 16, v27
    v_and_b32 v33, 0xffff0000, v27
    v_add_f32 v5, v5, v32
    v_add_f32 v5, v5, v33
    s_waitcnt vmcnt(0)
    v_lshlrev_b32 v32, 16, v28
    v_and_b32 v33, 0xffff0000, v28
    v_add_f32 v5, v5, v32
    v_add_f32 v5, v5, v33
    v_lshlrev_b32 v32, 16, v29
    v_and_b32 v33, 0xffff0000, v29
    v_add_f32 v5, v5, v32
    v_add_f32 v5, v5, v33
    v_lshlrev_b32 v32, 16, v30
    v_and_b32 v33, 0xffff0000, v30
    v_add_f32 v5, v5, v32
    v_add_f32 v5, v5, v33
    v_lshlrev_b32 v32, 16, v31
    v_and_b32 v33, 0xffff0000, v31
    v_add_f32 v5, v5, v32
    v_add_f32 v5, v5, v33
    v_mov_b32 v6, v5
    s_nop 1
    v_permlane16_swap_b32 v5, v6
    v_add_f32 v5, v5, v6
    v_mov_b32 v6, v5
    s_nop 1
    v_permlane32_swap_b32 v5, v6
    v_add_f32 v5, v5, v6
    v_mul_f32 v7, 0x3baaaaab, v5
    v_mov_b32 v56, 0
    v_lshlrev_b32 v32, 16, v8
    v_and_b32 v33, 0xffff0000, v8
    v_sub_f32 v32, v32, v7
    v_sub_f32 v33, v33, v7
    v_fmac_f32 v56, v32, v32
    v_fmac_f32 v56, v33, v33
    v_lshlrev_b32 v32, 16, v9
    v_and_b32 v33, 0xffff0000, v9
    v_sub_f32 v32, v32, v7
    v_sub_f32 v33, v33, v7
    v_fmac_f32 v56, v32, v32
    v_fmac_f32 v56, v33, v33
    v_lshlrev_b32 v32, 16, v10
    v_and_b32 v33, 0xffff0000, v10
    v_sub_f32 v32, v32, v7
    v_sub_f32 v33, v33, v7
    v_fmac_f32 v56, v32, v32
    v_fmac_f32 v56, v33, v33
    v_lshlrev_b32 v32, 16, v11
    v_and_b32 v33, 0xffff0000, v11
    v_sub_f32 v32, v32, v7
    v_sub_f32 v33, v33, v7
    v_fmac_f32 v56, v32, v32
    v_fmac_f32 v56, v33, v33
    v_lshlrev_b32 v32, 16, v12
    v_and_b32 v33, 0xffff0000, v12
    v_sub_f32 v32, v32, v7
    v_sub_f32 v33, v33, v7
    v_fmac_f32 v56, v32, v32
    v_fmac_f32 v56, v33, v33
    v_lshlrev_b32 v32, 16, v13
    v_and_b32 v33, 0xffff0000, v13
    v_sub_f32 v32, v32, v7
    v_sub_f32 v33, v33, v7
    v_fmac_f32 v56, v32, v32
    v_fmac_f32 v56, v33, v33
    v_lshlrev_b32 v32, 16, v14
    v_and_b32 v33, 0xffff0000, v14
    v_sub_f32 v32, v32, v7
    v_sub_f32 v33, v33, v7
    v_fmac_f32 v56, v32, v32
    v_fmac_f32 v56, v33, v33
    v_lshlrev_b32 v32, 16, v15
    v_and_b32 v33, 0xffff0000, v15
    v_sub_f32 v32, v32, v7
    v_sub_f32 v33, v33, v7
    v_fmac_f32 v56, v32, v32
    v_fmac_f32 v56, v33, v33
    v_lshlrev_b32 v32, 16, v16
    v_and_b32 v33, 0xffff0000, v16
    v_sub_f32 v32, v32, v7
    v_sub_f32 v33, v33, v7
    v_fmac_f32 v56, v32, v32
    v_fmac_f32 v56, v33, v33
    v_lshlrev_b32 v32, 16, v17
    v_and_b32 v33, 0xffff0000, v17
    v_sub_f32 v32, v32, v7
    v_sub_f32 v33, v33, v7
    v_fmac_f32 v56, v32, v32
    v_fmac_f32 v56, v33, v33
    v_lshlrev_b32 v32, 16, v18
    v_and_b32 v33, 0xffff0000, v18
    v_sub_f32 v32, v32, v7
    v_sub_f32 v33, v33, v7
    v_fmac_f32 v56, v32, v32
    v_fmac_f32 v56, v33, v33
    v_lshlrev_b32 v32, 16, v19
    v_and_b32 v33, 0xffff0000, v19
    v_sub_f32 v32, v32, v7
    v_sub_f32 v33, v33, v7
    v_fmac_f32 v56, v32, v32
    v_fmac_f32 v56, v33, v33
    v_lshlrev_b32 v32, 16, v20
    v_and_b32 v33, 0xffff0000, v20
    v_sub_f32 v32, v32, v7
    v_sub_f32 v33, v33, v7
    v_fmac_f32 v56, v32, v32
    v_fmac_f32 v56, v33, v33
    v_lshlrev_b32 v32, 16, v21
    v_and_b32 v33, 0xffff0000, v21
    v_sub_f32 v32, v32, v7
    v_sub_f32 v33, v33, v7
    v_fmac_f32 v56, v32, v32
    v_fmac_f32 v56, v33, v33
    v_lshlrev_b32 v32, 16, v22
    v_and_b32 v33, 0xffff0000, v22
    v_sub_f32 v32, v32, v7
    v_sub_f32 v33, v33, v7
    v_fmac_f32 v56, v32, v32
    v_fmac_f32 v56, v33, v33
    v_lshlrev_b32 v32, 16, v23
    v_and_b32 v33, 0xffff0000, v23
    v_sub_f32 v32, v32, v7
    v_sub_f32 v33, v33, v7
    v_fmac_f32 v56, v32, v32
    v_fmac_f32 v56, v33, v33
    v_lshlrev_b32 v32, 16, v24
    v_and_b32 v33, 0xffff0000, v24
    v_sub_f32 v32, v32, v7
    v_sub_f32 v33, v33, v7
    v_fmac_f32 v56, v32, v32
    v_fmac_f32 v56, v33, v33
    v_lshlrev_b32 v32, 16, v25
    v_and_b32 v33, 0xffff0000, v25
    v_sub_f32 v32, v32, v7
    v_sub_f32 v33, v33, v7
    v_fmac_f32 v56, v32, v32
    v_fmac_f32 v56, v33, v33
    v_lshlrev_b32 v32, 16, v26
    v_and_b32 v33, 0xffff0000, v26
    v_sub_f32 v32, v32, v7
    v_sub_f32 v33, v33, v7
    v_fmac_f32 v56, v32, v32
    v_fmac_f32 v56, v33, v33
    v_lshlrev_b32 v32, 16, v27
    v_and_b32 v33, 0xffff0000, v27
    v_sub_f32 v32, v32, v7
    v_sub_f32 v33, v33, v7
    v_fmac_f32 v56, v32, v32
    v_fmac_f32 v56, v33, v33
    v_lshlrev_b32 v32, 16, v28
    v_and_b32 v33, 0xffff0000, v28
    v_sub_f32 v32, v32, v7
    v_sub_f32 v33, v33, v7
    v_fmac_f32 v56, v32, v32
    v_fmac_f32 v56, v33, v33
    v_lshlrev_b32 v32, 16, v29
    v_and_b32 v33, 0xffff0000, v29
    v_sub_f32 v32, v32, v7
    v_sub_f32 v33, v33, v7
    v_fmac_f32 v56, v32, v32
    v_fmac_f32 v56, v33, v33
    v_lshlrev_b32 v32, 16, v30
    v_and_b32 v33, 0xffff0000, v30
    v_sub_f32 v32, v32, v7
    v_sub_f32 v33, v33, v7
    v_fmac_f32 v56, v32, v32
    v_fmac_f32 v56, v33, v33
    v_lshlrev_b32 v32, 16, v31
    v_and_b32 v33, 0xffff0000, v31
    v_sub_f32 v32, v32, v7
    v_sub_f32 v33, v33, v7
    v_fmac_f32 v56, v32, v32
    v_fmac_f32 v56, v33, v33
    v_mov_b32 v6, v56
    s_nop 1
    v_permlane16_swap_b32 v56, v6
    v_add_f32 v56, v56, v6
    v_mov_b32 v6, v56
    s_nop 1
    v_permlane32_swap_b32 v56, v6
    v_add_f32 v56, v56, v6
    s_lshl_b32 s85, s3, 7
    v_lshlrev_b32 v6, 3, v2
    v_add_u32 v6, s85, v6
    v_mov_b32 v57, v7
    v_mov_b32 v58, v56
    ds_write2_b32 v6, v57, v58 offset0:0 offset1:1
    s_waitcnt lgkmcnt(0)
L_ln_skip168_2251:
    s_barrier
    s_cmp_eq_u32 s3, 3
    s_cbranch_scc1 L_ln_skip168_2251b
    v_lshlrev_b32 v6, 3, v2
    ds_read_b64 v[32:33], v6 offset:0
    ds_read_b64 v[34:35], v6 offset:128
    ds_read_b64 v[36:37], v6 offset:256
    s_waitcnt lgkmcnt(1)
    v_add_f32 v7, v32, v34
    s_waitcnt lgkmcnt(0)
    v_add_f32 v7, v7, v36
    v_mul_f32 v7, 0x3eaaaaab, v7
    v_add_f32 v56, v33, v35
    v_add_f32 v56, v56, v37
    v_mov_b32 v5, 0
    v_sub_f32 v6, v32, v7
    v_fmac_f32 v5, v6, v6
    v_sub_f32 v6, v34, v7
    v_fmac_f32 v5, v6, v6
    v_sub_f32 v6, v36, v7
    v_fmac_f32 v5, v6, v6
    v_mov_b32 v6, 0x43400000
    v_fmac_f32 v56, v5, v6
    v_mul_f32 v56, 0x3ae38e39, v56
    v_cvt_pk_bf16_f32 v6, v7, v56
    v_lshlrev_b32 v7, 16, v6
    v_and_b32 v56, 0xffff0000, v6
    v_add_f32 v56, 0x3727c5ac, v56
    v_cvt_pk_bf16_f32 v6, v56, v56
    v_and_b32 v56, 0xffff0000, v6
    v_sqrt_f32 v56, v56
    s_nop 0
    v_cvt_pk_bf16_f32 v6, v56, v56
    v_and_b32 v56, 0xffff0000, v6
    v_rcp_f32 v56, v56
    v_lshlrev_b32 v32, 16, v8
    v_and_b32 v33, 0xffff0000, v8
    v_sub_f32 v32, v32, v7
    v_sub_f32 v33, v33, v7
    v_cvt_pk_bf16_f32 v34, v32, v33
    v_lshlrev_b32 v32, 16, v34
    v_and_b32 v33, 0xffff0000, v34
    v_mul_f32 v32, v32, v56
    v_mul_f32 v33, v33, v56
    v_cvt_pk_bf16_f32 v8, v32, v33
    v_lshlrev_b32 v32, 16, v9
    v_and_b32 v33, 0xffff0000, v9
    v_sub_f32 v32, v32, v7
    v_sub_f32 v33, v33, v7
    v_cvt_pk_bf16_f32 v34, v32, v33
    v_lshlrev_b32 v32, 16, v34
    v_and_b32 v33, 0xffff0000, v34
    v_mul_f32 v32, v32, v56
    v_mul_f32 v33, v33, v56
    v_cvt_pk_bf16_f32 v9, v32, v33
    v_lshlrev_b32 v32, 16, v10
    v_and_b32 v33, 0xffff0000, v10
    v_sub_f32 v32, v32, v7
    v_sub_f32 v33, v33, v7
    v_cvt_pk_bf16_f32 v34, v32, v33
    v_lshlrev_b32 v32, 16, v34
    v_and_b32 v33, 0xffff0000, v34
    v_mul_f32 v32, v32, v56
    v_mul_f32 v33, v33, v56
    v_cvt_pk_bf16_f32 v10, v32, v33
    v_lshlrev_b32 v32, 16, v11
    v_and_b32 v33, 0xffff0000, v11
    v_sub_f32 v32, v32, v7
    v_sub_f32 v33, v33, v7
    v_cvt_pk_bf16_f32 v34, v32, v33
    v_lshlrev_b32 v32, 16, v34
    v_and_b32 v33, 0xffff0000, v34
    v_mul_f32 v32, v32, v56
    v_mul_f32 v33, v33, v56
    v_cvt_pk_bf16_f32 v11, v32, v33
    v_lshlrev_b32 v32, 16, v12
    v_and_b32 v33, 0xffff0000, v12
    v_sub_f32 v32, v32, v7
    v_sub_f32 v33, v33, v7
    v_cvt_pk_bf16_f32 v34, v32, v33
    v_lshlrev_b32 v32, 16, v34
    v_and_b32 v33, 0xffff0000, v34
    v_mul_f32 v32, v32, v56
    v_mul_f32 v33, v33, v56
    v_cvt_pk_bf16_f32 v12, v32, v33
    v_lshlrev_b32 v32, 16, v13
    v_and_b32 v33, 0xffff0000, v13
    v_sub_f32 v32, v32, v7
    v_sub_f32 v33, v33, v7
    v_cvt_pk_bf16_f32 v34, v32, v33
    v_lshlrev_b32 v32, 16, v34
    v_and_b32 v33, 0xffff0000, v34
    v_mul_f32 v32, v32, v56
    v_mul_f32 v33, v33, v56
    v_cvt_pk_bf16_f32 v13, v32, v33
    v_lshlrev_b32 v32, 16, v14
    v_and_b32 v33, 0xffff0000, v14
    v_sub_f32 v32, v32, v7
    v_sub_f32 v33, v33, v7
    v_cvt_pk_bf16_f32 v34, v32, v33
    v_lshlrev_b32 v32, 16, v34
    v_and_b32 v33, 0xffff0000, v34
    v_mul_f32 v32, v32, v56
    v_mul_f32 v33, v33, v56
    v_cvt_pk_bf16_f32 v14, v32, v33
    v_lshlrev_b32 v32, 16, v15
    v_and_b32 v33, 0xffff0000, v15
    v_sub_f32 v32, v32, v7
    v_sub_f32 v33, v33, v7
    v_cvt_pk_bf16_f32 v34, v32, v33
    v_lshlrev_b32 v32, 16, v34
    v_and_b32 v33, 0xffff0000, v34
    v_mul_f32 v32, v32, v56
    v_mul_f32 v33, v33, v56
    v_cvt_pk_bf16_f32 v15, v32, v33
    v_lshlrev_b32 v32, 16, v16
    v_and_b32 v33, 0xffff0000, v16
    v_sub_f32 v32, v32, v7
    v_sub_f32 v33, v33, v7
    v_cvt_pk_bf16_f32 v34, v32, v33
    v_lshlrev_b32 v32, 16, v34
    v_and_b32 v33, 0xffff0000, v34
    v_mul_f32 v32, v32, v56
    v_mul_f32 v33, v33, v56
    v_cvt_pk_bf16_f32 v16, v32, v33
    v_lshlrev_b32 v32, 16, v17
    v_and_b32 v33, 0xffff0000, v17
    v_sub_f32 v32, v32, v7
    v_sub_f32 v33, v33, v7
    v_cvt_pk_bf16_f32 v34, v32, v33
    v_lshlrev_b32 v32, 16, v34
    v_and_b32 v33, 0xffff0000, v34
    v_mul_f32 v32, v32, v56
    v_mul_f32 v33, v33, v56
    v_cvt_pk_bf16_f32 v17, v32, v33
    v_lshlrev_b32 v32, 16, v18
    v_and_b32 v33, 0xffff0000, v18
    v_sub_f32 v32, v32, v7
    v_sub_f32 v33, v33, v7
    v_cvt_pk_bf16_f32 v34, v32, v33
    v_lshlrev_b32 v32, 16, v34
    v_and_b32 v33, 0xffff0000, v34
    v_mul_f32 v32, v32, v56
    v_mul_f32 v33, v33, v56
    v_cvt_pk_bf16_f32 v18, v32, v33
    v_lshlrev_b32 v32, 16, v19
    v_and_b32 v33, 0xffff0000, v19
    v_sub_f32 v32, v32, v7
    v_sub_f32 v33, v33, v7
    v_cvt_pk_bf16_f32 v34, v32, v33
    v_lshlrev_b32 v32, 16, v34
    v_and_b32 v33, 0xffff0000, v34
    v_mul_f32 v32, v32, v56
    v_mul_f32 v33, v33, v56
    v_cvt_pk_bf16_f32 v19, v32, v33
    v_lshlrev_b32 v32, 16, v20
    v_and_b32 v33, 0xffff0000, v20
    v_sub_f32 v32, v32, v7
    v_sub_f32 v33, v33, v7
    v_cvt_pk_bf16_f32 v34, v32, v33
    v_lshlrev_b32 v32, 16, v34
    v_and_b32 v33, 0xffff0000, v34
    v_mul_f32 v32, v32, v56
    v_mul_f32 v33, v33, v56
    v_cvt_pk_bf16_f32 v20, v32, v33
    v_lshlrev_b32 v32, 16, v21
    v_and_b32 v33, 0xffff0000, v21
    v_sub_f32 v32, v32, v7
    v_sub_f32 v33, v33, v7
    v_cvt_pk_bf16_f32 v34, v32, v33
    v_lshlrev_b32 v32, 16, v34
    v_and_b32 v33, 0xffff0000, v34
    v_mul_f32 v32, v32, v56
    v_mul_f32 v33, v33, v56
    v_cvt_pk_bf16_f32 v21, v32, v33
    v_lshlrev_b32 v32, 16, v22
    v_and_b32 v33, 0xffff0000, v22
    v_sub_f32 v32, v32, v7
    v_sub_f32 v33, v33, v7
    v_cvt_pk_bf16_f32 v34, v32, v33
    v_lshlrev_b32 v32, 16, v34
    v_and_b32 v33, 0xffff0000, v34
    v_mul_f32 v32, v32, v56
    v_mul_f32 v33, v33, v56
    v_cvt_pk_bf16_f32 v22, v32, v33
    v_lshlrev_b32 v32, 16, v23
    v_and_b32 v33, 0xffff0000, v23
    v_sub_f32 v32, v32, v7
    v_sub_f32 v33, v33, v7
    v_cvt_pk_bf16_f32 v34, v32, v33
    v_lshlrev_b32 v32, 16, v34
    v_and_b32 v33, 0xffff0000, v34
    v_mul_f32 v32, v32, v56
    v_mul_f32 v33, v33, v56
    v_cvt_pk_bf16_f32 v23, v32, v33
    v_lshlrev_b32 v32, 16, v24
    v_and_b32 v33, 0xffff0000, v24
    v_sub_f32 v32, v32, v7
    v_sub_f32 v33, v33, v7
    v_cvt_pk_bf16_f32 v34, v32, v33
    v_lshlrev_b32 v32, 16, v34
    v_and_b32 v33, 0xffff0000, v34
    v_mul_f32 v32, v32, v56
    v_mul_f32 v33, v33, v56
    v_cvt_pk_bf16_f32 v24, v32, v33
    v_lshlrev_b32 v32, 16, v25
    v_and_b32 v33, 0xffff0000, v25
    v_sub_f32 v32, v32, v7
    v_sub_f32 v33, v33, v7
    v_cvt_pk_bf16_f32 v34, v32, v33
    v_lshlrev_b32 v32, 16, v34
    v_and_b32 v33, 0xffff0000, v34
    v_mul_f32 v32, v32, v56
    v_mul_f32 v33, v33, v56
    v_cvt_pk_bf16_f32 v25, v32, v33
    v_lshlrev_b32 v32, 16, v26
    v_and_b32 v33, 0xffff0000, v26
    v_sub_f32 v32, v32, v7
    v_sub_f32 v33, v33, v7
    v_cvt_pk_bf16_f32 v34, v32, v33
    v_lshlrev_b32 v32, 16, v34
    v_and_b32 v33, 0xffff0000, v34
    v_mul_f32 v32, v32, v56
    v_mul_f32 v33, v33, v56
    v_cvt_pk_bf16_f32 v26, v32, v33
    v_lshlrev_b32 v32, 16, v27
    v_and_b32 v33, 0xffff0000, v27
    v_sub_f32 v32, v32, v7
    v_sub_f32 v33, v33, v7
    v_cvt_pk_bf16_f32 v34, v32, v33
    v_lshlrev_b32 v32, 16, v34
    v_and_b32 v33, 0xffff0000, v34
    v_mul_f32 v32, v32, v56
    v_mul_f32 v33, v33, v56
    v_cvt_pk_bf16_f32 v27, v32, v33
    v_lshlrev_b32 v32, 16, v28
    v_and_b32 v33, 0xffff0000, v28
    v_sub_f32 v32, v32, v7
    v_sub_f32 v33, v33, v7
    v_cvt_pk_bf16_f32 v34, v32, v33
    v_lshlrev_b32 v32, 16, v34
    v_and_b32 v33, 0xffff0000, v34
    v_mul_f32 v32, v32, v56
    v_mul_f32 v33, v33, v56
    v_cvt_pk_bf16_f32 v28, v32, v33
    v_lshlrev_b32 v32, 16, v29
    v_and_b32 v33, 0xffff0000, v29
    v_sub_f32 v32, v32, v7
    v_sub_f32 v33, v33, v7
    v_cvt_pk_bf16_f32 v34, v32, v33
    v_lshlrev_b32 v32, 16, v34
    v_and_b32 v33, 0xffff0000, v34
    v_mul_f32 v32, v32, v56
    v_mul_f32 v33, v33, v56
    v_cvt_pk_bf16_f32 v29, v32, v33
    v_lshlrev_b32 v32, 16, v30
    v_and_b32 v33, 0xffff0000, v30
    v_sub_f32 v32, v32, v7
    v_sub_f32 v33, v33, v7
    v_cvt_pk_bf16_f32 v34, v32, v33
    v_lshlrev_b32 v32, 16, v34
    v_and_b32 v33, 0xffff0000, v34
    v_mul_f32 v32, v32, v56
    v_mul_f32 v33, v33, v56
    v_cvt_pk_bf16_f32 v30, v32, v33
    v_lshlrev_b32 v32, 16, v31
    v_and_b32 v33, 0xffff0000, v31
    v_sub_f32 v32, v32, v7
    v_sub_f32 v33, v33, v7
    v_cvt_pk_bf16_f32 v34, v32, v33
    v_lshlrev_b32 v32, 16, v34
    v_and_b32 v33, 0xffff0000, v34
    v_mul_f32 v32, v32, v56
    v_mul_f32 v33, v33, v56
    v_cvt_pk_bf16_f32 v31, v32, v33
    s_mul_i32 s84, s101, 18432
    s_mul_i32 s85, s3, 6144
    s_add_u32 s84, s84, s85
    s_add_u32 s84, s84, 0x0
    v_lshlrev_b32 v4, 4, v1
    buffer_store_dwordx4 v[8:11], v4, s[52:55], s84 offen offset:0 sc1
    buffer_store_dwordx4 v[12:15], v4, s[52:55], s84 offen offset:1024 sc1
    buffer_store_dwordx4 v[16:19], v4, s[52:55], s84 offen offset:2048 sc1
    buffer_store_dwordx4 v[20:23], v4, s[52:55], s84 offen offset:3072 sc1
    s_add_u32 s84, s84, 4096
    buffer_store_dwordx4 v[24:27], v4, s[52:55], s84 offen offset:0 sc1
    buffer_store_dwordx4 v[28:31], v4, s[52:55], s84 offen offset:1024 sc1
    s_nop 1
L_ln_skip168_2251b:
    s_waitcnt vmcnt(0)
    s_barrier
    v_mov_b32 v8, 0
    v_mov_b32 v9, 1
    s_cmp_lg_u32 s3, 0
    s_cbranch_scc1 L_sig_10
    s_mov_b64 exec, 1
    buffer_atomic_add v9, v8, s[48:51], 0 offen offset:20
    s_mov_b64 exec, -1
L_sig_10:
L_m_noln:
    s_and_b32 s99, s5, 1
    s_lshl_b32 s99, s99, 3
    s_cmp_ge_u32 s5, 128
    s_cbranch_scc1 L_g1glu_m
    s_lshr_b32 s100, s5, 2
    s_bfe_u32 s101, s5, 0x10001
    s_lshl_b32 s84, s100, 8
    s_lshl_b32 s85, s101, 7
    s_add_u32 s84, s84, s85
    s_lshl_b32 s85, s3, 16
    s_add_u32 s85, s85, s84
    v_lshrrev_b32 v2, 3, v1
    v_and_b32 v3, 7, v1
    v_lshlrev_b32 v4, 13, v2
    v_lshl_add_u32 v4, v3, 4, v4
    s_mul_i32 s86, s3, 768
    v_mul_u32_u24 v5, 96, v2
    v_add_u32 v5, s86, v5
    s_mov_b32 s86, 18432
    v_lshrrev_b32 v10, 2, v3
    v_mad_u32_u24 v6, s86, v10, v5
    v_and_b32 v10, 3, v3
    v_lshl_add_u32 v6, v10, 3, v6
    v_lshrrev_b32 v10, 1, v3
    v_mad_u32_u24 v7, s86, v10, v5
    v_and_b32 v10, 1, v3
    v_lshl_add_u32 v7, v10, 4, v7
    s_mul_i32 s87, s3, 18432
    buffer_load_dwordx4 a[0:3], v4, s[16:19], s85 offen
    buffer_load_dwordx4 a[4:7], v4, s[20:23], s85 offen
    buffer_load_dwordx4 a[8:11], v4, s[24:27], s85 offen
    s_add_u32 s85, s85, 262144
    buffer_load_dwordx4 a[12:15], v4, s[16:19], s85 offen
    buffer_load_dwordx4 a[16:19], v4, s[20:23], s85 offen
    buffer_load_dwordx4 a[20:23], v4, s[24:27], s85 offen
    s_add_u32 s85, s85, 262144
    buffer_load_dwordx4 a[24:27], v4, s[16:19], s85 offen
    buffer_load_dwordx4 a[28:31], v4, s[20:23], s85 offen
    buffer_load_dwordx4 a[32:35], v4, s[24:27], s85 offen
    s_add_u32 s85, s85, 262144
    buffer_load_dwordx4 a[36:39], v4, s[16:19], s85 offen
    buffer_load_dwordx4 a[40:43], v4, s[20:23], s85 offen
    buffer_load_dwordx4 a[44:47], v4, s[24:27], s85 offen
    s_add_u32 s85, s85, 262144
    buffer_load_dwordx4 a[48:51], v4, s[16:19], s85 offen
    buffer_load_dwordx4 a[52:55], v4, s[20:23], s85 offen
    buffer_load_dwordx4 a[56:59], v4, s[24:27], s85 offen
    s_add_u32 s85, s85, 262144
    buffer_load_dwordx4 a[60:63], v4, s[16:19], s85 offen
    buffer_load_dwordx4 a[64:67], v4, s[20:23], s85 offen
    buffer_load_dwordx4 a[68:71], v4, s[24:27], s85 offen
    s_add_u32 s85, s85, 262144
    buffer_load_dwordx4 a[72:75], v4, s[16:19], s85 offen
    buffer_load_dwordx4 a[76:79], v4, s[20:23], s85 offen
    buffer_load_dwordx4 a[80:83], v4, s[24:27], s85 offen
    s_add_u32 s85, s85, 262144
    buffer_load_dwordx4 a[84:87], v4, s[16:19], s85 offen
    buffer_load_dwordx4 a[88:91], v4, s[20:23], s85 offen
    buffer_load_dwordx4 a[92:95], v4, s[24:27], s85 offen
    s_add_u32 s85, s85, 262144
    buffer_load_dwordx4 a[96:99], v4, s[16:19], s85 offen
    buffer_load_dwordx4 a[100:103], v4, s[20:23], s85 offen
    buffer_load_dwordx4 a[104:107], v4, s[24:27], s85 offen
    s_add_u32 s85, s85, 262144
    buffer_load_dwordx4 a[108:111], v4, s[16:19], s85 offen
    buffer_load_dwordx4 a[112:115], v4, s[20:23], s85 offen
    buffer_load_dwordx4 a[116:119], v4, s[24:27], s85 offen
    s_add_u32 s85, s85, 262144
    buffer_load_dwordx4 a[120:123], v4, s[16:19], s85 offen
    buffer_load_dwordx4 a[124:127], v4, s[20:23], s85 offen
    buffer_load_dwordx4 a[128:131], v4, s[24:27], s85 offen
    s_add_u32 s85, s85, 262144
    buffer_load_dwordx4 a[132:135], v4, s[16:19], s85 offen
    buffer_load_dwordx4 a[136:139], v4, s[20:23], s85 offen
    buffer_load_dwordx4 a[140:143], v4, s[24:27], s85 offen
    s_add_u32 s85, s85, 262144
    buffer_load_dwordx4 a[144:147], v4, s[16:19], s85 offen
    buffer_load_dwordx4 a[148:151], v4, s[20:23], s85 offen
    buffer_load_dwordx4 a[152:155], v4, s[24:27], s85 offen
    s_add_u32 s85, s85, 262144
    buffer_load_dwordx4 a[156:159], v4, s[16:19], s85 offen
    buffer_load_dwordx4 a[160:163], v4, s[20:23], s85 offen
    buffer_load_dwordx4 a[164:167], v4, s[24:27], s85 offen
    s_add_u32 s85, s85, 262144
    buffer_load_dwordx4 a[168:171], v4, s[16:19], s85 offen
    buffer_load_dwordx4 a[172:175], v4, s[20:23], s85 offen
    buffer_load_dwordx4 a[176:179], v4, s[24:27], s85 offen
    s_add_u32 s85, s85, 262144
    buffer_load_dwordx4 a[180:183], v4, s[16:19], s85 offen
    buffer_load_dwordx4 a[184:187], v4, s[20:23], s85 offen
    buffer_load_dwordx4 a[188:191], v4, s[24:27], s85 offen
    s_add_u32 s85, s85, 262144
    buffer_load_dwordx4 a[192:195], v4, s[16:19], s85 offen
    buffer_load_dwordx4 a[196:199], v4, s[20:23], s85 offen
    buffer_load_dwordx4 a[200:203], v4, s[24:27], s85 offen
    s_add_u32 s85, s85, 262144
    buffer_load_dwordx4 a[204:207], v4, s[16:19], s85 offen
    buffer_load_dwordx4 a[208:211], v4, s[20:23], s85 offen
    buffer_load_dwordx4 a[212:215], v4, s[24:27], s85 offen
    s_add_u32 s85, s85, 262144
    v_lshrrev_b32 v2, 4, v1
    v_bfe_u32 v3, v1, 2, 2
    v_lshl_add_u32 v2, v2, 3, v3
    v_mul_u32_u24 v8, 96, v2
    v_and_b32 v3, 3, v1
    v_lshl_add_u32 v8, v3, 3, v8
    v_add_u32 v8, s87, v8
    v_add_u32 v9, 0, v6
    s_waitcnt vmcnt(53)
    ds_write2_b64 v9, a[0:1], a[2:3] offset0:0 offset1:4
    v_add_u32 v9, 36864, v6
    s_waitcnt vmcnt(52)
    ds_write2_b64 v9, a[4:5], a[6:7] offset0:0 offset1:4
    s_waitcnt vmcnt(51)
    ds_write_b128 v7, a[8:11] offset:64
    v_add_u32 v9, 3072, v6
    s_waitcnt vmcnt(50)
    ds_write2_b64 v9, a[12:13], a[14:15] offset0:0 offset1:4
    v_add_u32 v9, 39936, v6
    s_waitcnt vmcnt(49)
    ds_write2_b64 v9, a[16:17], a[18:19] offset0:0 offset1:4
    s_waitcnt vmcnt(48)
    ds_write_b128 v7, a[20:23] offset:3136
    v_add_u32 v9, 6144, v6
    s_waitcnt vmcnt(47)
    ds_write2_b64 v9, a[24:25], a[26:27] offset0:0 offset1:4
    v_add_u32 v9, 43008, v6
    s_waitcnt vmcnt(46)
    ds_write2_b64 v9, a[28:29], a[30:31] offset0:0 offset1:4
    s_waitcnt vmcnt(45)
    ds_write_b128 v7, a[32:35] offset:6208
    v_add_u32 v9, 9216, v6
    s_waitcnt vmcnt(44)
    ds_write2_b64 v9, a[36:37], a[38:39] offset0:0 offset1:4
    v_add_u32 v9, 46080, v6
    s_waitcnt vmcnt(43)
    ds_write2_b64 v9, a[40:41], a[42:43] offset0:0 offset1:4
    s_waitcnt vmcnt(42)
    ds_write_b128 v7, a[44:47] offset:9280
    v_add_u32 v9, 12288, v6
    s_waitcnt vmcnt(41)
    ds_write2_b64 v9, a[48:49], a[50:51] offset0:0 offset1:4
    v_add_u32 v9, 49152, v6
    s_waitcnt vmcnt(40)
    ds_write2_b64 v9, a[52:53], a[54:55] offset0:0 offset1:4
    s_waitcnt vmcnt(39)
    ds_write_b128 v7, a[56:59] offset:12352
    v_add_u32 v9, 15360, v6
    s_waitcnt vmcnt(38)
    ds_write2_b64 v9, a[60:61], a[62:63] offset0:0 offset1:4
    v_add_u32 v9, 52224, v6
    s_waitcnt vmcnt(37)
    ds_write2_b64 v9, a[64:65], a[66:67] offset0:0 offset1:4
    s_waitcnt vmcnt(36)
    ds_write_b128 v7, a[68:71] offset:15424
    s_waitcnt lgkmcnt(0)
    s_barrier
    ds_read_b64_tr_b16 a[0:1], v8 offset:0
    ds_read_b64_tr_b16 a[2:3], v8 offset:384
    ds_read_b64_tr_b16 a[4:5], v8 offset:32
    ds_read_b64_tr_b16 a[6:7], v8 offset:416
    ds_read_b64_tr_b16 a[8:9], v8 offset:64
    ds_read_b64_tr_b16 a[10:11], v8 offset:448
    ds_read_b64_tr_b16 a[12:13], v8 offset:3072
    ds_read_b64_tr_b16 a[14:15], v8 offset:3456
    ds_read_b64_tr_b16 a[16:17], v8 offset:3104
    ds_read_b64_tr_b16 a[18:19], v8 offset:3488
    ds_read_b64_tr_b16 a[20:21], v8 offset:3136
    ds_read_b64_tr_b16 a[22:23], v8 offset:3520
    ds_read_b64_tr_b16 a[24:25], v8 offset:6144
    ds_read_b64_tr_b16 a[26:27], v8 offset:6528
    ds_read_b64_tr_b16 a[28:29], v8 offset:6176
    ds_read_b64_tr_b16 a[30:31], v8 offset:6560
    ds_read_b64_tr_b16 a[32:33], v8 offset:6208
    ds_read_b64_tr_b16 a[34:35], v8 offset:6592
    ds_read_b64_tr_b16 a[36:37], v8 offset:9216
    ds_read_b64_tr_b16 a[38:39], v8 offset:9600
    ds_read_b64_tr_b16 a[40:41], v8 offset:9248
    ds_read_b64_tr_b16 a[42:43], v8 offset:9632
    ds_read_b64_tr_b16 a[44:45], v8 offset:9280
    ds_read_b64_tr_b16 a[46:47], v8 offset:9664
    ds_read_b64_tr_b16 a[48:49], v8 offset:12288
    ds_read_b64_tr_b16 a[50:51], v8 offset:12672
    ds_read_b64_tr_b16 a[52:53], v8 offset:12320
    ds_read_b64_tr_b16 a[54:55], v8 offset:12704
    ds_read_b64_tr_b16 a[56:57], v8 offset:12352
    ds_read_b64_tr_b16 a[58:59], v8 offset:12736
    ds_read_b64_tr_b16 a[60:61], v8 offset:15360
    ds_read_b64_tr_b16 a[62:63], v8 offset:15744
    ds_read_b64_tr_b16 a[64:65], v8 offset:15392
    ds_read_b64_tr_b16 a[66:67], v8 offset:15776
    ds_read_b64_tr_b16 a[68:69], v8 offset:15424
    ds_read_b64_tr_b16 a[70:71], v8 offset:15808
    s_waitcnt lgkmcnt(0)
    s_barrier
    v_add_u32 v9, 0, v6
    s_waitcnt vmcnt(35)
    ds_write2_b64 v9, a[72:73], a[74:75] offset0:0 offset1:4
    v_add_u32 v9, 36864, v6
    s_waitcnt vmcnt(34)
    ds_write2_b64 v9, a[76:77], a[78:79] offset0:0 offset1:4
    s_waitcnt vmcnt(33)
    ds_write_b128 v7, a[80:83] offset:64
    v_add_u32 v9, 3072, v6
    s_waitcnt vmcnt(32)
    ds_write2_b64 v9, a[84:85], a[86:87] offset0:0 offset1:4
    v_add_u32 v9, 39936, v6
    s_waitcnt vmcnt(31)
    ds_write2_b64 v9, a[88:89], a[90:91] offset0:0 offset1:4
    s_waitcnt vmcnt(30)
    ds_write_b128 v7, a[92:95] offset:3136
    v_add_u32 v9, 6144, v6
    s_waitcnt vmcnt(29)
    ds_write2_b64 v9, a[96:97], a[98:99] offset0:0 offset1:4
    v_add_u32 v9, 43008, v6
    s_waitcnt vmcnt(28)
    ds_write2_b64 v9, a[100:101], a[102:103] offset0:0 offset1:4
    s_waitcnt vmcnt(27)
    ds_write_b128 v7, a[104:107] offset:6208
    v_add_u32 v9, 9216, v6
    s_waitcnt vmcnt(26)
    ds_write2_b64 v9, a[108:109], a[110:111] offset0:0 offset1:4
    v_add_u32 v9, 46080, v6
    s_waitcnt vmcnt(25)
    ds_write2_b64 v9, a[112:113], a[114:115] offset0:0 offset1:4
    s_waitcnt vmcnt(24)
    ds_write_b128 v7, a[116:119] offset:9280
    v_add_u32 v9, 12288, v6
    s_waitcnt vmcnt(23)
    ds_write2_b64 v9, a[120:121], a[122:123] offset0:0 offset1:4
    v_add_u32 v9, 49152, v6
    s_waitcnt vmcnt(22)
    ds_write2_b64 v9, a[124:125], a[126:127] offset0:0 offset1:4
    s_waitcnt vmcnt(21)
    ds_write_b128 v7, a[128:131] offset:12352
    v_add_u32 v9, 15360, v6
    s_waitcnt vmcnt(20)
    ds_write2_b64 v9, a[132:133], a[134:135] offset0:0 offset1:4
    v_add_u32 v9, 52224, v6
    s_waitcnt vmcnt(19)
    ds_write2_b64 v9, a[136:137], a[138:139] offset0:0 offset1:4
    s_waitcnt vmcnt(18)
    ds_write_b128 v7, a[140:143] offset:15424
    s_waitcnt lgkmcnt(0)
    s_barrier
    ds_read_b64_tr_b16 a[72:73], v8 offset:0
    ds_read_b64_tr_b16 a[74:75], v8 offset:384
    ds_read_b64_tr_b16 a[76:77], v8 offset:32
    ds_read_b64_tr_b16 a[78:79], v8 offset:416
    ds_read_b64_tr_b16 a[80:81], v8 offset:64
    ds_read_b64_tr_b16 a[82:83], v8 offset:448
    ds_read_b64_tr_b16 a[84:85], v8 offset:3072
    ds_read_b64_tr_b16 a[86:87], v8 offset:3456
    ds_read_b64_tr_b16 a[88:89], v8 offset:3104
    ds_read_b64_tr_b16 a[90:91], v8 offset:3488
    ds_read_b64_tr_b16 a[92:93], v8 offset:3136
    ds_read_b64_tr_b16 a[94:95], v8 offset:3520
    ds_read_b64_tr_b16 a[96:97], v8 offset:6144
    ds_read_b64_tr_b16 a[98:99], v8 offset:6528
    ds_read_b64_tr_b16 a[100:101], v8 offset:6176
    ds_read_b64_tr_b16 a[102:103], v8 offset:6560
    ds_read_b64_tr_b16 a[104:105], v8 offset:6208
    ds_read_b64_tr_b16 a[106:107], v8 offset:6592
    ds_read_b64_tr_b16 a[108:109], v8 offset:9216
    ds_read_b64_tr_b16 a[110:111], v8 offset:9600
    ds_read_b64_tr_b16 a[112:113], v8 offset:9248
    ds_read_b64_tr_b16 a[114:115], v8 offset:9632
    ds_read_b64_tr_b16 a[116:117], v8 offset:9280
    ds_read_b64_tr_b16 a[118:119], v8 offset:9664
    ds_read_b64_tr_b16 a[120:121], v8 offset:12288
    ds_read_b64_tr_b16 a[122:123], v8 offset:12672
    ds_read_b64_tr_b16 a[124:125], v8 offset:12320
    ds_read_b64_tr_b16 a[126:127], v8 offset:12704
    ds_read_b64_tr_b16 a[128:129], v8 offset:12352
    ds_read_b64_tr_b16 a[130:131], v8 offset:12736
    ds_read_b64_tr_b16 a[132:133], v8 offset:15360
    ds_read_b64_tr_b16 a[134:135], v8 offset:15744
    ds_read_b64_tr_b16 a[136:137], v8 offset:15392
    ds_read_b64_tr_b16 a[138:139], v8 offset:15776
    ds_read_b64_tr_b16 a[140:141], v8 offset:15424
    ds_read_b64_tr_b16 a[142:143], v8 offset:15808
    s_waitcnt lgkmcnt(0)
    s_barrier
    v_add_u32 v9, 0, v6
    s_waitcnt vmcnt(17)
    ds_write2_b64 v9, a[144:145], a[146:147] offset0:0 offset1:4
    v_add_u32 v9, 36864, v6
    s_waitcnt vmcnt(16)
    ds_write2_b64 v9, a[148:149], a[150:151] offset0:0 offset1:4
    s_waitcnt vmcnt(15)
    ds_write_b128 v7, a[152:155] offset:64
    v_add_u32 v9, 3072, v6
    s_waitcnt vmcnt(14)
    ds_write2_b64 v9, a[156:157], a[158:159] offset0:0 offset1:4
    v_add_u32 v9, 39936, v6
    s_waitcnt vmcnt(13)
    ds_write2_b64 v9, a[160:161], a[162:163] offset0:0 offset1:4
    s_waitcnt vmcnt(12)
    ds_write_b128 v7, a[164:167] offset:3136
    v_add_u32 v9, 6144, v6
    s_waitcnt vmcnt(11)
    ds_write2_b64 v9, a[168:169], a[170:171] offset0:0 offset1:4
    v_add_u32 v9, 43008, v6
    s_waitcnt vmcnt(10)
    ds_write2_b64 v9, a[172:173], a[174:175] offset0:0 offset1:4
    s_waitcnt vmcnt(9)
    ds_write_b128 v7, a[176:179] offset:6208
    v_add_u32 v9, 9216, v6
    s_waitcnt vmcnt(8)
    ds_write2_b64 v9, a[180:181], a[182:183] offset0:0 offset1:4
    v_add_u32 v9, 46080, v6
    s_waitcnt vmcnt(7)
    ds_write2_b64 v9, a[184:185], a[186:187] offset0:0 offset1:4
    s_waitcnt vmcnt(6)
    ds_write_b128 v7, a[188:191] offset:9280
    v_add_u32 v9, 12288, v6
    s_waitcnt vmcnt(5)
    ds_write2_b64 v9, a[192:193], a[194:195] offset0:0 offset1:4
    v_add_u32 v9, 49152, v6
    s_waitcnt vmcnt(4)
    ds_write2_b64 v9, a[196:197], a[198:199] offset0:0 offset1:4
    s_waitcnt vmcnt(3)
    ds_write_b128 v7, a[200:203] offset:12352
    v_add_u32 v9, 15360, v6
    s_waitcnt vmcnt(2)
    ds_write2_b64 v9, a[204:205], a[206:207] offset0:0 offset1:4
    v_add_u32 v9, 52224, v6
    s_waitcnt vmcnt(1)
    ds_write2_b64 v9, a[208:209], a[210:211] offset0:0 offset1:4
    s_waitcnt vmcnt(0)
    ds_write_b128 v7, a[212:215] offset:15424
    s_waitcnt lgkmcnt(0)
    s_barrier
    ds_read_b64_tr_b16 a[144:145], v8 offset:0
    ds_read_b64_tr_b16 a[146:147], v8 offset:384
    ds_read_b64_tr_b16 a[148:149], v8 offset:32
    ds_read_b64_tr_b16 a[150:151], v8 offset:416
    ds_read_b64_tr_b16 a[152:153], v8 offset:64
    ds_read_b64_tr_b16 a[154:155], v8 offset:448
    ds_read_b64_tr_b16 a[156:157], v8 offset:3072
    ds_read_b64_tr_b16 a[158:159], v8 offset:3456
    ds_read_b64_tr_b16 a[160:161], v8 offset:3104
    ds_read_b64_tr_b16 a[162:163], v8 offset:3488
    ds_read_b64_tr_b16 a[164:165], v8 offset:3136
    ds_read_b64_tr_b16 a[166:167], v8 offset:3520
    ds_read_b64_tr_b16 a[168:169], v8 offset:6144
    ds_read_b64_tr_b16 a[170:171], v8 offset:6528
    ds_read_b64_tr_b16 a[172:173], v8 offset:6176
    ds_read_b64_tr_b16 a[174:175], v8 offset:6560
    ds_read_b64_tr_b16 a[176:177], v8 offset:6208
    ds_read_b64_tr_b16 a[178:179], v8 offset:6592
    ds_read_b64_tr_b16 a[180:181], v8 offset:9216
    ds_read_b64_tr_b16 a[182:183], v8 offset:9600
    ds_read_b64_tr_b16 a[184:185], v8 offset:9248
    ds_read_b64_tr_b16 a[186:187], v8 offset:9632
    ds_read_b64_tr_b16 a[188:189], v8 offset:9280
    ds_read_b64_tr_b16 a[190:191], v8 offset:9664
    ds_read_b64_tr_b16 a[192:193], v8 offset:12288
    ds_read_b64_tr_b16 a[194:195], v8 offset:12672
    ds_read_b64_tr_b16 a[196:197], v8 offset:12320
    ds_read_b64_tr_b16 a[198:199], v8 offset:12704
    ds_read_b64_tr_b16 a[200:201], v8 offset:12352
    ds_read_b64_tr_b16 a[202:203], v8 offset:12736
    ds_read_b64_tr_b16 a[204:205], v8 offset:15360
    ds_read_b64_tr_b16 a[206:207], v8 offset:15744
    ds_read_b64_tr_b16 a[208:209], v8 offset:15392
    ds_read_b64_tr_b16 a[210:211], v8 offset:15776
    ds_read_b64_tr_b16 a[212:213], v8 offset:15424
    ds_read_b64_tr_b16 a[214:215], v8 offset:15808
    s_waitcnt lgkmcnt(0)
    s_lshr_b32 s84, s99, 1
    s_lshl_b32 s84, s84, 5
    s_add_u32 s84, s84, s100
    s_lshl_b32 s84, s84, 13
    s_and_b32 s85, s3, 1
    s_lshl_b32 s86, s101, 1
    s_add_u32 s85, s85, s86
    s_lshl_b32 s85, s85, 10
    s_add_u32 s96, s84, s85
    s_cmp_lt_u32 s3, 2
    s_cselect_b32 s85, 0, 0x1400000
    s_add_u32 s96, s96, s85
    s_add_u32 s96, s96, 0x400000
    s_lshl_b32 s85, s101, 2
    s_add_u32 s85, s85, s3
    s_lshl_b32 s85, s85, 10
    s_add_u32 s97, s84, s85
    s_add_u32 s97, s97, 0x2c00000
    v_mov_b32 v8, 0
    s_nop 1
L_wait_11:
    buffer_load_dword v9, v8, s[48:51], 0 offen offset:20 sc1
    s_waitcnt vmcnt(0)
    v_readfirstlane_b32 s83, v9
    s_nop 0
    s_cmp_ge_u32 s83, 129
    s_nop 2
    s_cbranch_scc1 L_waitok_12
    s_sleep 6
    s_sub_u32 s81, s81, 1
    s_cbranch_scc1 L_main_done
    s_branch L_wait_11
L_waitok_12:
    v_lshlrev_b32 v16, 4, v1
    v_add_u32 v17, 49152, v16
    v_add_u32 v18, 98304, v16
    s_mul_i32 s92, s3, 6144
    s_lshl_b32 s94, s3, 1
    s_add_u32 s94, s94, s99
    s_mul_i32 s94, s94, 18432
    s_add_u32 s94, s94, 0x0
    s_mov_b32 s95, 0
    s_barrier
    s_add_u32 m0, s92, 0
    s_add_u32 s93, s94, 0
    buffer_load_dwordx4 v16, s[52:55], s93 offen offset:0 sc1 lds
    buffer_load_dwordx4 v16, s[52:55], s93 offen offset:1024 sc1 lds
    buffer_load_dwordx4 v16, s[52:55], s93 offen offset:2048 sc1 lds
    s_add_u32 m0, s92, 3072
    s_add_u32 s93, s94, 18432
    buffer_load_dwordx4 v16, s[52:55], s93 offen offset:0 sc1 lds
    buffer_load_dwordx4 v16, s[52:55], s93 offen offset:1024 sc1 lds
    buffer_load_dwordx4 v16, s[52:55], s93 offen offset:2048 sc1 lds
    s_add_u32 m0, s92, 24576
    s_add_u32 s93, s94, 3072
    buffer_load_dwordx4 v16, s[52:55], s93 offen offset:0 sc1 lds
    buffer_load_dwordx4 v16, s[52:55], s93 offen offset:1024 sc1 lds
    buffer_load_dwordx4 v16, s[52:55], s93 offen offset:2048 sc1 lds
    s_add_u32 m0, s92, 27648
    s_add_u32 s93, s94, 21504
    buffer_load_dwordx4 v16, s[52:55], s93 offen offset:0 sc1 lds
    buffer_load_dwordx4 v16, s[52:55], s93 offen offset:1024 sc1 lds
    buffer_load_dwordx4 v16, s[52:55], s93 offen offset:2048 sc1 lds
    s_add_u32 m0, s92, 49152
    s_add_u32 s93, s94, 6144
    buffer_load_dwordx4 v16, s[52:55], s93 offen offset:0 sc1 lds
    buffer_load_dwordx4 v16, s[52:55], s93 offen offset:1024 sc1 lds
    buffer_load_dwordx4 v16, s[52:55], s93 offen offset:2048 sc1 lds
    s_add_u32 m0, s92, 52224
    s_add_u32 s93, s94, 24576
    buffer_load_dwordx4 v16, s[52:55], s93 offen offset:0 sc1 lds
    buffer_load_dwordx4 v16, s[52:55], s93 offen offset:1024 sc1 lds
    buffer_load_dwordx4 v16, s[52:55], s93 offen offset:2048 sc1 lds
    s_add_u32 m0, s92, 73728
    s_add_u32 s93, s94, 9216
    buffer_load_dwordx4 v16, s[52:55], s93 offen offset:0 sc1 lds
    buffer_load_dwordx4 v16, s[52:55], s93 offen offset:1024 sc1 lds
    buffer_load_dwordx4 v16, s[52:55], s93 offen offset:2048 sc1 lds
    s_add_u32 m0, s92, 76800
    s_add_u32 s93, s94, 27648
    buffer_load_dwordx4 v16, s[52:55], s93 offen offset:0 sc1 lds
    buffer_load_dwordx4 v16, s[52:55], s93 offen offset:1024 sc1 lds
    buffer_load_dwordx4 v16, s[52:55], s93 offen offset:2048 sc1 lds
    s_add_u32 m0, s92, 98304
    s_add_u32 s93, s94, 12288
    buffer_load_dwordx4 v16, s[52:55], s93 offen offset:0 sc1 lds
    buffer_load_dwordx4 v16, s[52:55], s93 offen offset:1024 sc1 lds
    buffer_load_dwordx4 v16, s[52:55], s93 offen offset:2048 sc1 lds
    s_add_u32 m0, s92, 101376
    s_add_u32 s93, s94, 30720
    buffer_load_dwordx4 v16, s[52:55], s93 offen offset:0 sc1 lds
    buffer_load_dwordx4 v16, s[52:55], s93 offen offset:1024 sc1 lds
    buffer_load_dwordx4 v16, s[52:55], s93 offen offset:2048 sc1 lds
    s_add_u32 m0, s92, 122880
    s_add_u32 s93, s94, 15360
    buffer_load_dwordx4 v16, s[52:55], s93 offen offset:0 sc1 lds
    buffer_load_dwordx4 v16, s[52:55], s93 offen offset:1024 sc1 lds
    buffer_load_dwordx4 v16, s[52:55], s93 offen offset:2048 sc1 lds
    s_add_u32 m0, s92, 125952
    s_add_u32 s93, s94, 33792
    buffer_load_dwordx4 v16, s[52:55], s93 offen offset:0 sc1 lds
    buffer_load_dwordx4 v16, s[52:55], s93 offen offset:1024 sc1 lds
    buffer_load_dwordx4 v16, s[52:55], s93 offen offset:2048 sc1 lds
    s_add_u32 s94, s94, 294912
    s_waitcnt vmcnt(30)
    s_barrier
    ds_read_b128 v[96:99], v16 offset:0
    ds_read_b128 v[100:103], v16 offset:3072
    ds_read_b128 v[104:107], v16 offset:6144
    ds_read_b128 v[108:111], v16 offset:9216
    ds_read_b128 v[112:115], v16 offset:12288
    ds_read_b128 v[116:119], v16 offset:15360
    ds_read_b128 v[120:123], v16 offset:18432
    ds_read_b128 v[124:127], v16 offset:21504
    s_waitcnt lgkmcnt(0)
L_g1_qkvm:
    v_mfma_f32_16x16x32_bf16 v[160:163], a[0:3], v[96:99], 0
    ds_read_b128 v[128:131], v16 offset:1024
    v_mfma_f32_16x16x32_bf16 v[164:167], a[4:7], v[96:99], 0
    v_mfma_f32_16x16x32_bf16 v[168:171], v[96:99], a[8:11], 0
    ds_read_b128 v[132:135], v16 offset:4096
    v_mfma_f32_16x16x32_bf16 v[172:175], a[0:3], v[100:103], 0
    v_mfma_f32_16x16x32_bf16 v[176:179], a[4:7], v[100:103], 0
    ds_read_b128 v[136:139], v16 offset:7168
    v_mfma_f32_16x16x32_bf16 v[180:183], v[100:103], a[8:11], 0
    v_mfma_f32_16x16x32_bf16 v[184:187], a[0:3], v[104:107], 0
    ds_read_b128 v[140:143], v16 offset:10240
    v_mfma_f32_16x16x32_bf16 v[188:191], a[4:7], v[104:107], 0
    v_mfma_f32_16x16x32_bf16 v[192:195], v[104:107], a[8:11], 0
    ds_read_b128 v[144:147], v16 offset:13312
    v_mfma_f32_16x16x32_bf16 v[196:199], a[0:3], v[108:111], 0
    v_mfma_f32_16x16x32_bf16 v[200:203], a[4:7], v[108:111], 0
    ds_read_b128 v[148:151], v16 offset:16384
    v_mfma_f32_16x16x32_bf16 v[204:207], v[108:111], a[8:11], 0
    v_mfma_f32_16x16x32_bf16 v[208:211], a[0:3], v[112:115], 0
    ds_read_b128 v[152:155], v16 offset:19456
    v_mfma_f32_16x16x32_bf16 v[212:215], a[4:7], v[112:115], 0
    v_mfma_f32_16x16x32_bf16 v[216:219], v[112:115], a[8:11], 0
    ds_read_b128 v[156:159], v16 offset:22528
    v_mfma_f32_16x16x32_bf16 v[220:223], a[0:3], v[116:119], 0
    v_mfma_f32_16x16x32_bf16 v[224:227], a[4:7], v[116:119], 0
    v_mfma_f32_16x16x32_bf16 v[228:231], v[116:119], a[8:11], 0
    v_mfma_f32_16x16x32_bf16 v[232:235], a[0:3], v[120:123], 0
    v_mfma_f32_16x16x32_bf16 v[236:239], a[4:7], v[120:123], 0
    v_mfma_f32_16x16x32_bf16 v[240:243], v[120:123], a[8:11], 0
    v_mfma_f32_16x16x32_bf16 v[244:247], a[0:3], v[124:127], 0
    v_mfma_f32_16x16x32_bf16 v[248:251], a[4:7], v[124:127], 0
    v_mfma_f32_16x16x32_bf16 v[252:255], v[124:127], a[8:11], 0
    s_waitcnt lgkmcnt(7)
    v_mfma_f32_16x16x32_bf16 v[160:163], a[12:15], v[128:131], v[160:163]
    ds_read_b128 v[96:99], v16 offset:2048
    v_mfma_f32_16x16x32_bf16 v[164:167], a[16:19], v[128:131], v[164:167]
    v_mfma_f32_16x16x32_bf16 v[168:171], v[128:131], a[20:23], v[168:171]
    ds_read_b128 v[100:103], v16 offset:5120
    s_waitcnt lgkmcnt(8)
    v_mfma_f32_16x16x32_bf16 v[172:175], a[12:15], v[132:135], v[172:175]
    v_mfma_f32_16x16x32_bf16 v[176:179], a[16:19], v[132:135], v[176:179]
    ds_read_b128 v[104:107], v16 offset:8192
    v_mfma_f32_16x16x32_bf16 v[180:183], v[132:135], a[20:23], v[180:183]
    s_waitcnt lgkmcnt(8)
    v_mfma_f32_16x16x32_bf16 v[184:187], a[12:15], v[136:139], v[184:187]
    ds_read_b128 v[108:111], v16 offset:11264
    v_mfma_f32_16x16x32_bf16 v[188:191], a[16:19], v[136:139], v[188:191]
    v_mfma_f32_16x16x32_bf16 v[192:195], v[136:139], a[20:23], v[192:195]
    ds_read_b128 v[112:115], v16 offset:14336
    s_waitcnt lgkmcnt(9)
    v_mfma_f32_16x16x32_bf16 v[196:199], a[12:15], v[140:143], v[196:199]
    v_mfma_f32_16x16x32_bf16 v[200:203], a[16:19], v[140:143], v[200:203]
    ds_read_b128 v[116:119], v16 offset:17408
    v_mfma_f32_16x16x32_bf16 v[204:207], v[140:143], a[20:23], v[204:207]
    s_waitcnt lgkmcnt(9)
    v_mfma_f32_16x16x32_bf16 v[208:211], a[12:15], v[144:147], v[208:211]
    ds_read_b128 v[120:123], v16 offset:20480
    v_mfma_f32_16x16x32_bf16 v[212:215], a[16:19], v[144:147], v[212:215]
    v_mfma_f32_16x16x32_bf16 v[216:219], v[144:147], a[20:23], v[216:219]
    ds_read_b128 v[124:127], v16 offset:23552
    s_waitcnt lgkmcnt(10)
    v_mfma_f32_16x16x32_bf16 v[220:223], a[12:15], v[148:151], v[220:223]
    v_mfma_f32_16x16x32_bf16 v[224:227], a[16:19], v[148:151], v[224:227]
    v_mfma_f32_16x16x32_bf16 v[228:231], v[148:151], a[20:23], v[228:231]
    s_waitcnt lgkmcnt(9)
    v_mfma_f32_16x16x32_bf16 v[232:235], a[12:15], v[152:155], v[232:235]
    v_mfma_f32_16x16x32_bf16 v[236:239], a[16:19], v[152:155], v[236:239]
    v_mfma_f32_16x16x32_bf16 v[240:243], v[152:155], a[20:23], v[240:243]
    s_waitcnt lgkmcnt(8)
    v_mfma_f32_16x16x32_bf16 v[244:247], a[12:15], v[156:159], v[244:247]
    v_mfma_f32_16x16x32_bf16 v[248:251], a[16:19], v[156:159], v[248:251]
    v_mfma_f32_16x16x32_bf16 v[252:255], v[156:159], a[20:23], v[252:255]
    s_waitcnt lgkmcnt(0)
    s_waitcnt vmcnt(24)
    s_cmp_lg_u32 s95, 1
    s_cbranch_scc1 L_g1_qkvm_e
    s_waitcnt vmcnt(0)
L_g1_qkvm_e:
    s_barrier
    v_mfma_f32_16x16x32_bf16 v[160:163], a[24:27], v[96:99], v[160:163]
    s_cmp_lg_u32 s95, 1
    s_cbranch_scc1 L_sq_13
    s_lshl_b32 s83, s95, 3
    s_and_b32 s82, s5, 1
    s_lshl_b32 s82, s82, 2
    s_add_u32 s83, s83, s82
    v_mov_b32 v21, 0
    v_mov_b32 v22, 1
    s_cmp_lg_u32 s3, 0
    s_cbranch_scc1 L_sig_14
    s_mov_b64 exec, 1
    buffer_atomic_add v22, v21, s[48:51], s83 offen offset:24
    s_mov_b64 exec, -1
L_sig_14:
L_sq_13:
    v_mfma_f32_16x16x32_bf16 v[164:167], a[28:31], v[96:99], v[164:167]
    v_mfma_f32_16x16x32_bf16 v[168:171], v[96:99], a[32:35], v[168:171]
    s_add_u32 m0, s92, 0
    s_add_u32 s93, s94, 0
    buffer_load_dwordx4 v16, s[52:55], s93 offen offset:0 sc1 lds
    buffer_load_dwordx4 v16, s[52:55], s93 offen offset:1024 sc1 lds
    buffer_load_dwordx4 v16, s[52:55], s93 offen offset:2048 sc1 lds
    s_add_u32 m0, s92, 3072
    s_add_u32 s93, s94, 18432
    buffer_load_dwordx4 v16, s[52:55], s93 offen offset:0 sc1 lds
    buffer_load_dwordx4 v16, s[52:55], s93 offen offset:1024 sc1 lds
    buffer_load_dwordx4 v16, s[52:55], s93 offen offset:2048 sc1 lds
    v_mfma_f32_16x16x32_bf16 v[172:175], a[24:27], v[100:103], v[172:175]
    v_mfma_f32_16x16x32_bf16 v[176:179], a[28:31], v[100:103], v[176:179]
    ds_read_b128 v[128:131], v16 offset:24576
    v_mfma_f32_16x16x32_bf16 v[180:183], v[100:103], a[32:35], v[180:183]
    v_mfma_f32_16x16x32_bf16 v[184:187], a[24:27], v[104:107], v[184:187]
    ds_read_b128 v[132:135], v16 offset:27648
    v_mfma_f32_16x16x32_bf16 v[188:191], a[28:31], v[104:107], v[188:191]
    v_mfma_f32_16x16x32_bf16 v[192:195], v[104:107], a[32:35], v[192:195]
    ds_read_b128 v[136:139], v16 offset:30720
    v_mfma_f32_16x16x32_bf16 v[196:199], a[24:27], v[108:111], v[196:199]
    v_mfma_f32_16x16x32_bf16 v[200:203], a[28:31], v[108:111], v[200:203]
    ds_read_b128 v[140:143], v16 offset:33792
    v_mfma_f32_16x16x32_bf16 v[204:207], v[108:111], a[32:35], v[204:207]
    v_mfma_f32_16x16x32_bf16 v[208:211], a[24:27], v[112:115], v[208:211]
    ds_read_b128 v[144:147], v16 offset:36864
    v_mfma_f32_16x16x32_bf16 v[212:215], a[28:31], v[112:115], v[212:215]
    v_mfma_f32_16x16x32_bf16 v[216:219], v[112:115], a[32:35], v[216:219]
    ds_read_b128 v[148:151], v16 offset:39936
    v_mfma_f32_16x16x32_bf16 v[220:223], a[24:27], v[116:119], v[220:223]
    v_mfma_f32_16x16x32_bf16 v[224:227], a[28:31], v[116:119], v[224:227]
    ds_read_b128 v[152:155], v16 offset:43008
    v_mfma_f32_16x16x32_bf16 v[228:231], v[116:119], a[32:35], v[228:231]
    v_mfma_f32_16x16x32_bf16 v[232:235], a[24:27], v[120:123], v[232:235]
    ds_read_b128 v[156:159], v16 offset:46080
    v_mfma_f32_16x16x32_bf16 v[236:239], a[28:31], v[120:123], v[236:239]
    v_mfma_f32_16x16x32_bf16 v[240:243], v[120:123], a[32:35], v[240:243]
    v_mfma_f32_16x16x32_bf16 v[244:247], a[24:27], v[124:127], v[244:247]
    v_mfma_f32_16x16x32_bf16 v[248:251], a[28:31], v[124:127], v[248:251]
    v_mfma_f32_16x16x32_bf16 v[252:255], v[124:127], a[32:35], v[252:255]
    s_waitcnt lgkmcnt(7)
    v_mfma_f32_16x16x32_bf16 v[160:163], a[36:39], v[128:131], v[160:163]
    ds_read_b128 v[96:99], v16 offset:25600
    v_mfma_f32_16x16x32_bf16 v[164:167], a[40:43], v[128:131], v[164:167]
    v_mfma_f32_16x16x32_bf16 v[168:171], v[128:131], a[44:47], v[168:171]
    ds_read_b128 v[100:103], v16 offset:28672
    s_waitcnt lgkmcnt(8)
    v_mfma_f32_16x16x32_bf16 v[172:175], a[36:39], v[132:135], v[172:175]
    v_mfma_f32_16x16x32_bf16 v[176:179], a[40:43], v[132:135], v[176:179]
    ds_read_b128 v[104:107], v16 offset:31744
    v_mfma_f32_16x16x32_bf16 v[180:183], v[132:135], a[44:47], v[180:183]
    s_waitcnt lgkmcnt(8)
    v_mfma_f32_16x16x32_bf16 v[184:187], a[36:39], v[136:139], v[184:187]
    ds_read_b128 v[108:111], v16 offset:34816
    v_mfma_f32_16x16x32_bf16 v[188:191], a[40:43], v[136:139], v[188:191]
    v_mfma_f32_16x16x32_bf16 v[192:195], v[136:139], a[44:47], v[192:195]
    ds_read_b128 v[112:115], v16 offset:37888
    s_waitcnt lgkmcnt(9)
    v_mfma_f32_16x16x32_bf16 v[196:199], a[36:39], v[140:143], v[196:199]
    v_mfma_f32_16x16x32_bf16 v[200:203], a[40:43], v[140:143], v[200:203]
    ds_read_b128 v[116:119], v16 offset:40960
    v_mfma_f32_16x16x32_bf16 v[204:207], v[140:143], a[44:47], v[204:207]
    s_waitcnt lgkmcnt(9)
    v_mfma_f32_16x16x32_bf16 v[208:211], a[36:39], v[144:147], v[208:211]
    ds_read_b128 v[120:123], v16 offset:44032
    v_mfma_f32_16x16x32_bf16 v[212:215], a[40:43], v[144:147], v[212:215]
    v_mfma_f32_16x16x32_bf16 v[216:219], v[144:147], a[44:47], v[216:219]
    ds_read_b128 v[124:127], v16 offset:47104
    s_waitcnt lgkmcnt(10)
    v_mfma_f32_16x16x32_bf16 v[220:223], a[36:39], v[148:151], v[220:223]
    v_mfma_f32_16x16x32_bf16 v[224:227], a[40:43], v[148:151], v[224:227]
    v_mfma_f32_16x16x32_bf16 v[228:231], v[148:151], a[44:47], v[228:231]
    s_waitcnt lgkmcnt(9)
    v_mfma_f32_16x16x32_bf16 v[232:235], a[36:39], v[152:155], v[232:235]
    v_mfma_f32_16x16x32_bf16 v[236:239], a[40:43], v[152:155], v[236:239]
    v_mfma_f32_16x16x32_bf16 v[240:243], v[152:155], a[44:47], v[240:243]
    s_waitcnt lgkmcnt(8)
    v_mfma_f32_16x16x32_bf16 v[244:247], a[36:39], v[156:159], v[244:247]
    v_mfma_f32_16x16x32_bf16 v[248:251], a[40:43], v[156:159], v[248:251]
    v_mfma_f32_16x16x32_bf16 v[252:255], v[156:159], a[44:47], v[252:255]
    s_waitcnt lgkmcnt(7)
    v_mfma_f32_16x16x32_bf16 v[160:163], a[48:51], v[96:99], v[160:163]
    ds_read_b128 v[128:131], v16 offset:26624
    v_mfma_f32_16x16x32_bf16 v[164:167], a[52:55], v[96:99], v[164:167]
    v_mfma_f32_16x16x32_bf16 v[168:171], v[96:99], a[56:59], v[168:171]
    ds_read_b128 v[132:135], v16 offset:29696
    s_waitcnt lgkmcnt(8)
    v_mfma_f32_16x16x32_bf16 v[172:175], a[48:51], v[100:103], v[172:175]
    v_mfma_f32_16x16x32_bf16 v[176:179], a[52:55], v[100:103], v[176:179]
    ds_read_b128 v[136:139], v16 offset:32768
    v_mfma_f32_16x16x32_bf16 v[180:183], v[100:103], a[56:59], v[180:183]
    s_waitcnt lgkmcnt(8)
    v_mfma_f32_16x16x32_bf16 v[184:187], a[48:51], v[104:107], v[184:187]
    ds_read_b128 v[140:143], v16 offset:35840
    v_mfma_f32_16x16x32_bf16 v[188:191], a[52:55], v[104:107], v[188:191]
    v_mfma_f32_16x16x32_bf16 v[192:195], v[104:107], a[56:59], v[192:195]
    ds_read_b128 v[144:147], v16 offset:38912
    s_waitcnt lgkmcnt(9)
    v_mfma_f32_16x16x32_bf16 v[196:199], a[48:51], v[108:111], v[196:199]
    v_mfma_f32_16x16x32_bf16 v[200:203], a[52:55], v[108:111], v[200:203]
    ds_read_b128 v[148:151], v16 offset:41984
    v_mfma_f32_16x16x32_bf16 v[204:207], v[108:111], a[56:59], v[204:207]
    s_waitcnt lgkmcnt(9)
    v_mfma_f32_16x16x32_bf16 v[208:211], a[48:51], v[112:115], v[208:211]
    ds_read_b128 v[152:155], v16 offset:45056
    v_mfma_f32_16x16x32_bf16 v[212:215], a[52:55], v[112:115], v[212:215]
    v_mfma_f32_16x16x32_bf16 v[216:219], v[112:115], a[56:59], v[216:219]
    ds_read_b128 v[156:159], v16 offset:48128
    s_waitcnt lgkmcnt(10)
    v_mfma_f32_16x16x32_bf16 v[220:223], a[48:51], v[116:119], v[220:223]
    v_mfma_f32_16x16x32_bf16 v[224:227], a[52:55], v[116:119], v[224:227]
    v_mfma_f32_16x16x32_bf16 v[228:231], v[116:119], a[56:59], v[228:231]
    s_waitcnt lgkmcnt(9)
    v_mfma_f32_16x16x32_bf16 v[232:235], a[48:51], v[120:123], v[232:235]
    v_mfma_f32_16x16x32_bf16 v[236:239], a[52:55], v[120:123], v[236:239]
    v_mfma_f32_16x16x32_bf16 v[240:243], v[120:123], a[56:59], v[240:243]
    s_waitcnt lgkmcnt(8)
    v_mfma_f32_16x16x32_bf16 v[244:247], a[48:51], v[124:127], v[244:247]
    v_mfma_f32_16x16x32_bf16 v[248:251], a[52:55], v[124:127], v[248:251]
    v_mfma_f32_16x16x32_bf16 v[252:255], v[124:127], a[56:59], v[252:255]
    s_waitcnt lgkmcnt(0)
    s_waitcnt vmcnt(6)
    s_barrier
    v_mfma_f32_16x16x32_bf16 v[160:163], a[60:63], v[128:131], v[160:163]
    s_cmp_lt_u32 s95, 2
    s_cbranch_scc1 L_sq_15
    s_lshl_b32 s83, s95, 3
    s_and_b32 s82, s5, 1
    s_lshl_b32 s82, s82, 2
    s_add_u32 s83, s83, s82
    v_mov_b32 v21, 0
    v_mov_b32 v22, 1
    s_cmp_lg_u32 s3, 0
    s_cbranch_scc1 L_sig_16
    s_mov_b64 exec, 1
    buffer_atomic_add v22, v21, s[48:51], s83 offen offset:24
    s_mov_b64 exec, -1
L_sig_16:
L_sq_15:
    v_mfma_f32_16x16x32_bf16 v[164:167], a[64:67], v[128:131], v[164:167]
    v_mfma_f32_16x16x32_bf16 v[168:171], v[128:131], a[68:71], v[168:171]
    s_add_u32 m0, s92, 24576
    s_add_u32 s93, s94, 3072
    buffer_load_dwordx4 v16, s[52:55], s93 offen offset:0 sc1 lds
    buffer_load_dwordx4 v16, s[52:55], s93 offen offset:1024 sc1 lds
    buffer_load_dwordx4 v16, s[52:55], s93 offen offset:2048 sc1 lds
    s_add_u32 m0, s92, 27648
    s_add_u32 s93, s94, 21504
    buffer_load_dwordx4 v16, s[52:55], s93 offen offset:0 sc1 lds
    buffer_load_dwordx4 v16, s[52:55], s93 offen offset:1024 sc1 lds
    buffer_load_dwordx4 v16, s[52:55], s93 offen offset:2048 sc1 lds
    v_mfma_f32_16x16x32_bf16 v[172:175], a[60:63], v[132:135], v[172:175]
    v_mfma_f32_16x16x32_bf16 v[176:179], a[64:67], v[132:135], v[176:179]
    ds_read_b128 v[96:99], v17 offset:0
    v_mfma_f32_16x16x32_bf16 v[180:183], v[132:135], a[68:71], v[180:183]
    v_mfma_f32_16x16x32_bf16 v[184:187], a[60:63], v[136:139], v[184:187]
    ds_read_b128 v[100:103], v17 offset:3072
    v_mfma_f32_16x16x32_bf16 v[188:191], a[64:67], v[136:139], v[188:191]
    v_mfma_f32_16x16x32_bf16 v[192:195], v[136:139], a[68:71], v[192:195]
    ds_read_b128 v[104:107], v17 offset:6144
    v_mfma_f32_16x16x32_bf16 v[196:199], a[60:63], v[140:143], v[196:199]
    v_mfma_f32_16x16x32_bf16 v[200:203], a[64:67], v[140:143], v[200:203]
    ds_read_b128 v[108:111], v17 offset:9216
    v_mfma_f32_16x16x32_bf16 v[204:207], v[140:143], a[68:71], v[204:207]
    v_mfma_f32_16x16x32_bf16 v[208:211], a[60:63], v[144:147], v[208:211]
    ds_read_b128 v[112:115], v17 offset:12288
    v_mfma_f32_16x16x32_bf16 v[212:215], a[64:67], v[144:147], v[212:215]
    v_mfma_f32_16x16x32_bf16 v[216:219], v[144:147], a[68:71], v[216:219]
    ds_read_b128 v[116:119], v17 offset:15360
    v_mfma_f32_16x16x32_bf16 v[220:223], a[60:63], v[148:151], v[220:223]
    v_mfma_f32_16x16x32_bf16 v[224:227], a[64:67], v[148:151], v[224:227]
    ds_read_b128 v[120:123], v17 offset:18432
    v_mfma_f32_16x16x32_bf16 v[228:231], v[148:151], a[68:71], v[228:231]
    v_mfma_f32_16x16x32_bf16 v[232:235], a[60:63], v[152:155], v[232:235]
    ds_read_b128 v[124:127], v17 offset:21504
    v_mfma_f32_16x16x32_bf16 v[236:239], a[64:67], v[152:155], v[236:239]
    v_mfma_f32_16x16x32_bf16 v[240:243], v[152:155], a[68:71], v[240:243]
    v_mfma_f32_16x16x32_bf16 v[244:247], a[60:63], v[156:159], v[244:247]
    v_mfma_f32_16x16x32_bf16 v[248:251], a[64:67], v[156:159], v[248:251]
    v_mfma_f32_16x16x32_bf16 v[252:255], v[156:159], a[68:71], v[252:255]
    s_waitcnt lgkmcnt(7)
    v_mfma_f32_16x16x32_bf16 v[160:163], a[72:75], v[96:99], v[160:163]
    ds_read_b128 v[128:131], v17 offset:1024
    v_mfma_f32_16x16x32_bf16 v[164:167], a[76:79], v[96:99], v[164:167]
    v_mfma_f32_16x16x32_bf16 v[168:171], v[96:99], a[80:83], v[168:171]
    ds_read_b128 v[132:135], v17 offset:4096
    s_waitcnt lgkmcnt(8)
    v_mfma_f32_16x16x32_bf16 v[172:175], a[72:75], v[100:103], v[172:175]
    v_mfma_f32_16x16x32_bf16 v[176:179], a[76:79], v[100:103], v[176:179]
    ds_read_b128 v[136:139], v17 offset:7168
    v_mfma_f32_16x16x32_bf16 v[180:183], v[100:103], a[80:83], v[180:183]
    s_waitcnt lgkmcnt(8)
    v_mfma_f32_16x16x32_bf16 v[184:187], a[72:75], v[104:107], v[184:187]
    ds_read_b128 v[140:143], v17 offset:10240
    v_mfma_f32_16x16x32_bf16 v[188:191], a[76:79], v[104:107], v[188:191]
    v_mfma_f32_16x16x32_bf16 v[192:195], v[104:107], a[80:83], v[192:195]
    ds_read_b128 v[144:147], v17 offset:13312
    s_waitcnt lgkmcnt(9)
    v_mfma_f32_16x16x32_bf16 v[196:199], a[72:75], v[108:111], v[196:199]
    v_mfma_f32_16x16x32_bf16 v[200:203], a[76:79], v[108:111], v[200:203]
    ds_read_b128 v[148:151], v17 offset:16384
    v_mfma_f32_16x16x32_bf16 v[204:207], v[108:111], a[80:83], v[204:207]
    s_waitcnt lgkmcnt(9)
    v_mfma_f32_16x16x32_bf16 v[208:211], a[72:75], v[112:115], v[208:211]
    ds_read_b128 v[152:155], v17 offset:19456
    v_mfma_f32_16x16x32_bf16 v[212:215], a[76:79], v[112:115], v[212:215]
    v_mfma_f32_16x16x32_bf16 v[216:219], v[112:115], a[80:83], v[216:219]
    ds_read_b128 v[156:159], v17 offset:22528
    s_waitcnt lgkmcnt(10)
    v_mfma_f32_16x16x32_bf16 v[220:223], a[72:75], v[116:119], v[220:223]
    v_mfma_f32_16x16x32_bf16 v[224:227], a[76:79], v[116:119], v[224:227]
    v_mfma_f32_16x16x32_bf16 v[228:231], v[116:119], a[80:83], v[228:231]
    s_waitcnt lgkmcnt(9)
    v_mfma_f32_16x16x32_bf16 v[232:235], a[72:75], v[120:123], v[232:235]
    v_mfma_f32_16x16x32_bf16 v[236:239], a[76:79], v[120:123], v[236:239]
    v_mfma_f32_16x16x32_bf16 v[240:243], v[120:123], a[80:83], v[240:243]
    s_waitcnt lgkmcnt(8)
    v_mfma_f32_16x16x32_bf16 v[244:247], a[72:75], v[124:127], v[244:247]
    v_mfma_f32_16x16x32_bf16 v[248:251], a[76:79], v[124:127], v[248:251]
    v_mfma_f32_16x16x32_bf16 v[252:255], v[124:127], a[80:83], v[252:255]
    s_waitcnt lgkmcnt(7)
    v_mfma_f32_16x16x32_bf16 v[160:163], a[84:87], v[128:131], v[160:163]
    ds_read_b128 v[96:99], v17 offset:2048
    v_mfma_f32_16x16x32_bf16 v[164:167], a[88:91], v[128:131], v[164:167]
    v_mfma_f32_16x16x32_bf16 v[168:171], v[128:131], a[92:95], v[168:171]
    ds_read_b128 v[100:103], v17 offset:5120
    s_waitcnt lgkmcnt(8)
    v_mfma_f32_16x16x32_bf16 v[172:175], a[84:87], v[132:135], v[172:175]
    v_mfma_f32_16x16x32_bf16 v[176:179], a[88:91], v[132:135], v[176:179]
    ds_read_b128 v[104:107], v17 offset:8192
    v_mfma_f32_16x16x32_bf16 v[180:183], v[132:135], a[92:95], v[180:183]
    s_waitcnt lgkmcnt(8)
    v_mfma_f32_16x16x32_bf16 v[184:187], a[84:87], v[136:139], v[184:187]
    ds_read_b128 v[108:111], v17 offset:11264
    v_mfma_f32_16x16x32_bf16 v[188:191], a[88:91], v[136:139], v[188:191]
    v_mfma_f32_16x16x32_bf16 v[192:195], v[136:139], a[92:95], v[192:195]
    ds_read_b128 v[112:115], v17 offset:14336
    s_waitcnt lgkmcnt(9)
    v_mfma_f32_16x16x32_bf16 v[196:199], a[84:87], v[140:143], v[196:199]
    v_mfma_f32_16x16x32_bf16 v[200:203], a[88:91], v[140:143], v[200:203]
    ds_read_b128 v[116:119], v17 offset:17408
    v_mfma_f32_16x16x32_bf16 v[204:207], v[140:143], a[92:95], v[204:207]
    s_waitcnt lgkmcnt(9)
    v_mfma_f32_16x16x32_bf16 v[208:211], a[84:87], v[144:147], v[208:211]
    ds_read_b128 v[120:123], v17 offset:20480
    v_mfma_f32_16x16x32_bf16 v[212:215], a[88:91], v[144:147], v[212:215]
    v_mfma_f32_16x16x32_bf16 v[216:219], v[144:147], a[92:95], v[216:219]
    ds_read_b128 v[124:127], v17 offset:23552
    s_waitcnt lgkmcnt(10)
    v_mfma_f32_16x16x32_bf16 v[220:223], a[84:87], v[148:151], v[220:223]
    v_mfma_f32_16x16x32_bf16 v[224:227], a[88:91], v[148:151], v[224:227]
    v_mfma_f32_16x16x32_bf16 v[228:231], v[148:151], a[92:95], v[228:231]
    s_waitcnt lgkmcnt(9)
    v_mfma_f32_16x16x32_bf16 v[232:235], a[84:87], v[152:155], v[232:235]
    v_mfma_f32_16x16x32_bf16 v[236:239], a[88:91], v[152:155], v[236:239]
    v_mfma_f32_16x16x32_bf16 v[240:243], v[152:155], a[92:95], v[240:243]
    s_waitcnt lgkmcnt(8)
    v_mfma_f32_16x16x32_bf16 v[244:247], a[84:87], v[156:159], v[244:247]
    v_mfma_f32_16x16x32_bf16 v[248:251], a[88:91], v[156:159], v[248:251]
    v_mfma_f32_16x16x32_bf16 v[252:255], v[156:159], a[92:95], v[252:255]
    s_waitcnt lgkmcnt(0)
    s_waitcnt vmcnt(24)
    s_barrier
    v_mfma_f32_16x16x32_bf16 v[160:163], a[96:99], v[96:99], v[160:163]
    s_add_u32 m0, s92, 49152
    s_add_u32 s93, s94, 6144
    buffer_load_dwordx4 v16, s[52:55], s93 offen offset:0 sc1 lds
    buffer_load_dwordx4 v16, s[52:55], s93 offen offset:1024 sc1 lds
    buffer_load_dwordx4 v16, s[52:55], s93 offen offset:2048 sc1 lds
    s_add_u32 m0, s92, 52224
    s_add_u32 s93, s94, 24576
    buffer_load_dwordx4 v16, s[52:55], s93 offen offset:0 sc1 lds
    buffer_load_dwordx4 v16, s[52:55], s93 offen offset:1024 sc1 lds
    buffer_load_dwordx4 v16, s[52:55], s93 offen offset:2048 sc1 lds
    v_mfma_f32_16x16x32_bf16 v[164:167], a[100:103], v[96:99], v[164:167]
    v_mfma_f32_16x16x32_bf16 v[168:171], v[96:99], a[104:107], v[168:171]
    ds_read_b128 v[128:131], v17 offset:24576
    v_mfma_f32_16x16x32_bf16 v[172:175], a[96:99], v[100:103], v[172:175]
    v_mfma_f32_16x16x32_bf16 v[176:179], a[100:103], v[100:103], v[176:179]
    ds_read_b128 v[132:135], v17 offset:27648
    v_mfma_f32_16x16x32_bf16 v[180:183], v[100:103], a[104:107], v[180:183]
    v_mfma_f32_16x16x32_bf16 v[184:187], a[96:99], v[104:107], v[184:187]
    ds_read_b128 v[136:139], v17 offset:30720
    v_mfma_f32_16x16x32_bf16 v[188:191], a[100:103], v[104:107], v[188:191]
    v_mfma_f32_16x16x32_bf16 v[192:195], v[104:107], a[104:107], v[192:195]
    ds_read_b128 v[140:143], v17 offset:33792
    v_mfma_f32_16x16x32_bf16 v[196:199], a[96:99], v[108:111], v[196:199]
    v_mfma_f32_16x16x32_bf16 v[200:203], a[100:103], v[108:111], v[200:203]
    ds_read_b128 v[144:147], v17 offset:36864
    v_mfma_f32_16x16x32_bf16 v[204:207], v[108:111], a[104:107], v[204:207]
    v_mfma_f32_16x16x32_bf16 v[208:211], a[96:99], v[112:115], v[208:211]
    ds_read_b128 v[148:151], v17 offset:39936
    v_mfma_f32_16x16x32_bf16 v[212:215], a[100:103], v[112:115], v[212:215]
    v_mfma_f32_16x16x32_bf16 v[216:219], v[112:115], a[104:107], v[216:219]
    ds_read_b128 v[152:155], v17 offset:43008
    v_mfma_f32_16x16x32_bf16 v[220:223], a[96:99], v[116:119], v[220:223]
    v_mfma_f32_16x16x32_bf16 v[224:227], a[100:103], v[116:119], v[224:227]
    ds_read_b128 v[156:159], v17 offset:46080
    v_mfma_f32_16x16x32_bf16 v[228:231], v[116:119], a[104:107], v[228:231]
    v_mfma_f32_16x16x32_bf16 v[232:235], a[96:99], v[120:123], v[232:235]
    v_mfma_f32_16x16x32_bf16 v[236:239], a[100:103], v[120:123], v[236:239]
    v_mfma_f32_16x16x32_bf16 v[240:243], v[120:123], a[104:107], v[240:243]
    v_mfma_f32_16x16x32_bf16 v[244:247], a[96:99], v[124:127], v[244:247]
    v_mfma_f32_16x16x32_bf16 v[248:251], a[100:103], v[124:127], v[248:251]
    v_mfma_f32_16x16x32_bf16 v[252:255], v[124:127], a[104:107], v[252:255]
    s_waitcnt lgkmcnt(7)
    v_mfma_f32_16x16x32_bf16 v[160:163], a[108:111], v[128:131], v[160:163]
    ds_read_b128 v[96:99], v17 offset:25600
    v_mfma_f32_16x16x32_bf16 v[164:167], a[112:115], v[128:131], v[164:167]
    v_mfma_f32_16x16x32_bf16 v[168:171], v[128:131], a[116:119], v[168:171]
    ds_read_b128 v[100:103], v17 offset:28672
    s_waitcnt lgkmcnt(8)
    v_mfma_f32_16x16x32_bf16 v[172:175], a[108:111], v[132:135], v[172:175]
    v_mfma_f32_16x16x32_bf16 v[176:179], a[112:115], v[132:135], v[176:179]
    ds_read_b128 v[104:107], v17 offset:31744
    v_mfma_f32_16x16x32_bf16 v[180:183], v[132:135], a[116:119], v[180:183]
    s_waitcnt lgkmcnt(8)
    v_mfma_f32_16x16x32_bf16 v[184:187], a[108:111], v[136:139], v[184:187]
    ds_read_b128 v[108:111], v17 offset:34816
    v_mfma_f32_16x16x32_bf16 v[188:191], a[112:115], v[136:139], v[188:191]
    v_mfma_f32_16x16x32_bf16 v[192:195], v[136:139], a[116:119], v[192:195]
    ds_read_b128 v[112:115], v17 offset:37888
    s_waitcnt lgkmcnt(9)
    v_mfma_f32_16x16x32_bf16 v[196:199], a[108:111], v[140:143], v[196:199]
    v_mfma_f32_16x16x32_bf16 v[200:203], a[112:115], v[140:143], v[200:203]
    ds_read_b128 v[116:119], v17 offset:40960
    v_mfma_f32_16x16x32_bf16 v[204:207], v[140:143], a[116:119], v[204:207]
    s_waitcnt lgkmcnt(9)
    v_mfma_f32_16x16x32_bf16 v[208:211], a[108:111], v[144:147], v[208:211]
    ds_read_b128 v[120:123], v17 offset:44032
    v_mfma_f32_16x16x32_bf16 v[212:215], a[112:115], v[144:147], v[212:215]
    v_mfma_f32_16x16x32_bf16 v[216:219], v[144:147], a[116:119], v[216:219]
    ds_read_b128 v[124:127], v17 offset:47104
    s_waitcnt lgkmcnt(10)
    v_mfma_f32_16x16x32_bf16 v[220:223], a[108:111], v[148:151], v[220:223]
    v_mfma_f32_16x16x32_bf16 v[224:227], a[112:115], v[148:151], v[224:227]
    v_mfma_f32_16x16x32_bf16 v[228:231], v[148:151], a[116:119], v[228:231]
    s_waitcnt lgkmcnt(9)
    v_mfma_f32_16x16x32_bf16 v[232:235], a[108:111], v[152:155], v[232:235]
    v_mfma_f32_16x16x32_bf16 v[236:239], a[112:115], v[152:155], v[236:239]
    v_mfma_f32_16x16x32_bf16 v[240:243], v[152:155], a[116:119], v[240:243]
    s_waitcnt lgkmcnt(8)
    v_mfma_f32_16x16x32_bf16 v[244:247], a[108:111], v[156:159], v[244:247]
    v_mfma_f32_16x16x32_bf16 v[248:251], a[112:115], v[156:159], v[248:251]
    v_mfma_f32_16x16x32_bf16 v[252:255], v[156:159], a[116:119], v[252:255]
    s_waitcnt lgkmcnt(7)
    v_mfma_f32_16x16x32_bf16 v[160:163], a[120:123], v[96:99], v[160:163]
    ds_read_b128 v[128:131], v17 offset:26624
    v_mfma_f32_16x16x32_bf16 v[164:167], a[124:127], v[96:99], v[164:167]
    v_mfma_f32_16x16x32_bf16 v[168:171], v[96:99], a[128:131], v[168:171]
    ds_read_b128 v[132:135], v17 offset:29696
    s_waitcnt lgkmcnt(8)
    v_mfma_f32_16x16x32_bf16 v[172:175], a[120:123], v[100:103], v[172:175]
    v_mfma_f32_16x16x32_bf16 v[176:179], a[124:127], v[100:103], v[176:179]
    ds_read_b128 v[136:139], v17 offset:32768
    v_mfma_f32_16x16x32_bf16 v[180:183], v[100:103], a[128:131], v[180:183]
    s_waitcnt lgkmcnt(8)
    v_mfma_f32_16x16x32_bf16 v[184:187], a[120:123], v[104:107], v[184:187]
    ds_read_b128 v[140:143], v17 offset:35840
    v_mfma_f32_16x16x32_bf16 v[188:191], a[124:127], v[104:107], v[188:191]
    v_mfma_f32_16x16x32_bf16 v[192:195], v[104:107], a[128:131], v[192:195]
    ds_read_b128 v[144:147], v17 offset:38912
    s_waitcnt lgkmcnt(9)
    v_mfma_f32_16x16x32_bf16 v[196:199], a[120:123], v[108:111], v[196:199]
    v_mfma_f32_16x16x32_bf16 v[200:203], a[124:127], v[108:111], v[200:203]
    ds_read_b128 v[148:151], v17 offset:41984
    v_mfma_f32_16x16x32_bf16 v[204:207], v[108:111], a[128:131], v[204:207]
    s_waitcnt lgkmcnt(9)
    v_mfma_f32_16x16x32_bf16 v[208:211], a[120:123], v[112:115], v[208:211]
    ds_read_b128 v[152:155], v17 offset:45056
    v_mfma_f32_16x16x32_bf16 v[212:215], a[124:127], v[112:115], v[212:215]
    v_mfma_f32_16x16x32_bf16 v[216:219], v[112:115], a[128:131], v[216:219]
    ds_read_b128 v[156:159], v17 offset:48128
    s_waitcnt lgkmcnt(10)
    v_mfma_f32_16x16x32_bf16 v[220:223], a[120:123], v[116:119], v[220:223]
    v_mfma_f32_16x16x32_bf16 v[224:227], a[124:127], v[116:119], v[224:227]
    v_mfma_f32_16x16x32_bf16 v[228:231], v[116:119], a[128:131], v[228:231]
    s_waitcnt lgkmcnt(9)
    v_mfma_f32_16x16x32_bf16 v[232:235], a[120:123], v[120:123], v[232:235]
    v_mfma_f32_16x16x32_bf16 v[236:239], a[124:127], v[120:123], v[236:239]
    v_mfma_f32_16x16x32_bf16 v[240:243], v[120:123], a[128:131], v[240:243]
    s_waitcnt lgkmcnt(8)
    v_mfma_f32_16x16x32_bf16 v[244:247], a[120:123], v[124:127], v[244:247]
    v_mfma_f32_16x16x32_bf16 v[248:251], a[124:127], v[124:127], v[248:251]
    v_mfma_f32_16x16x32_bf16 v[252:255], v[124:127], a[128:131], v[252:255]
    s_waitcnt lgkmcnt(0)
    s_waitcnt vmcnt(24)
    s_barrier
    v_mfma_f32_16x16x32_bf16 v[160:163], a[132:135], v[128:131], v[160:163]
    s_add_u32 m0, s92, 73728
    s_add_u32 s93, s94, 9216
    buffer_load_dwordx4 v16, s[52:55], s93 offen offset:0 sc1 lds
    buffer_load_dwordx4 v16, s[52:55], s93 offen offset:1024 sc1 lds
    buffer_load_dwordx4 v16, s[52:55], s93 offen offset:2048 sc1 lds
    s_add_u32 m0, s92, 76800
    s_add_u32 s93, s94, 27648
    buffer_load_dwordx4 v16, s[52:55], s93 offen offset:0 sc1 lds
    buffer_load_dwordx4 v16, s[52:55], s93 offen offset:1024 sc1 lds
    buffer_load_dwordx4 v16, s[52:55], s93 offen offset:2048 sc1 lds
    v_mfma_f32_16x16x32_bf16 v[164:167], a[136:139], v[128:131], v[164:167]
    v_mfma_f32_16x16x32_bf16 v[168:171], v[128:131], a[140:143], v[168:171]
    ds_read_b128 v[96:99], v18 offset:0
    v_mfma_f32_16x16x32_bf16 v[172:175], a[132:135], v[132:135], v[172:175]
    v_mfma_f32_16x16x32_bf16 v[176:179], a[136:139], v[132:135], v[176:179]
    ds_read_b128 v[100:103], v18 offset:3072
    v_mfma_f32_16x16x32_bf16 v[180:183], v[132:135], a[140:143], v[180:183]
    v_mfma_f32_16x16x32_bf16 v[184:187], a[132:135], v[136:139], v[184:187]
    ds_read_b128 v[104:107], v18 offset:6144
    v_mfma_f32_16x16x32_bf16 v[188:191], a[136:139], v[136:139], v[188:191]
    v_mfma_f32_16x16x32_bf16 v[192:195], v[136:139], a[140:143], v[192:195]
    ds_read_b128 v[108:111], v18 offset:9216
    v_mfma_f32_16x16x32_bf16 v[196:199], a[132:135], v[140:143], v[196:199]
    v_mfma_f32_16x16x32_bf16 v[200:203], a[136:139], v[140:143], v[200:203]
    ds_read_b128 v[112:115], v18 offset:12288
    v_mfma_f32_16x16x32_bf16 v[204:207], v[140:143], a[140:143], v[204:207]
    v_mfma_f32_16x16x32_bf16 v[208:211], a[132:135], v[144:147], v[208:211]
    ds_read_b128 v[116:119], v18 offset:15360
    v_mfma_f32_16x16x32_bf16 v[212:215], a[136:139], v[144:147], v[212:215]
    v_mfma_f32_16x16x32_bf16 v[216:219], v[144:147], a[140:143], v[216:219]
    ds_read_b128 v[120:123], v18 offset:18432
    v_mfma_f32_16x16x32_bf16 v[220:223], a[132:135], v[148:151], v[220:223]
    v_mfma_f32_16x16x32_bf16 v[224:227], a[136:139], v[148:151], v[224:227]
    ds_read_b128 v[124:127], v18 offset:21504
    v_mfma_f32_16x16x32_bf16 v[228:231], v[148:151], a[140:143], v[228:231]
    v_mfma_f32_16x16x32_bf16 v[232:235], a[132:135], v[152:155], v[232:235]
    v_mfma_f32_16x16x32_bf16 v[236:239], a[136:139], v[152:155], v[236:239]
    v_mfma_f32_16x16x32_bf16 v[240:243], v[152:155], a[140:143], v[240:243]
    v_mfma_f32_16x16x32_bf16 v[244:247], a[132:135], v[156:159], v[244:247]
    v_mfma_f32_16x16x32_bf16 v[248:251], a[136:139], v[156:159], v[248:251]
    v_mfma_f32_16x16x32_bf16 v[252:255], v[156:159], a[140:143], v[252:255]
    s_waitcnt lgkmcnt(7)
    v_mfma_f32_16x16x32_bf16 v[160:163], a[144:147], v[96:99], v[160:163]
    ds_read_b128 v[128:131], v18 offset:1024
    v_mfma_f32_16x16x32_bf16 v[164:167], a[148:151], v[96:99], v[164:167]
    v_mfma_f32_16x16x32_bf16 v[168:171], v[96:99], a[152:155], v[168:171]
    ds_read_b128 v[132:135], v18 offset:4096
    s_waitcnt lgkmcnt(8)
    v_mfma_f32_16x16x32_bf16 v[172:175], a[144:147], v[100:103], v[172:175]
    v_mfma_f32_16x16x32_bf16 v[176:179], a[148:151], v[100:103], v[176:179]
    ds_read_b128 v[136:139], v18 offset:7168
    v_mfma_f32_16x16x32_bf16 v[180:183], v[100:103], a[152:155], v[180:183]
    s_waitcnt lgkmcnt(8)
    v_mfma_f32_16x16x32_bf16 v[184:187], a[144:147], v[104:107], v[184:187]
    ds_read_b128 v[140:143], v18 offset:10240
    v_mfma_f32_16x16x32_bf16 v[188:191], a[148:151], v[104:107], v[188:191]
    v_mfma_f32_16x16x32_bf16 v[192:195], v[104:107], a[152:155], v[192:195]
    ds_read_b128 v[144:147], v18 offset:13312
    s_waitcnt lgkmcnt(9)
    v_mfma_f32_16x16x32_bf16 v[196:199], a[144:147], v[108:111], v[196:199]
    v_mfma_f32_16x16x32_bf16 v[200:203], a[148:151], v[108:111], v[200:203]
    ds_read_b128 v[148:151], v18 offset:16384
    v_mfma_f32_16x16x32_bf16 v[204:207], v[108:111], a[152:155], v[204:207]
    s_waitcnt lgkmcnt(9)
    v_mfma_f32_16x16x32_bf16 v[208:211], a[144:147], v[112:115], v[208:211]
    ds_read_b128 v[152:155], v18 offset:19456
    v_mfma_f32_16x16x32_bf16 v[212:215], a[148:151], v[112:115], v[212:215]
    v_mfma_f32_16x16x32_bf16 v[216:219], v[112:115], a[152:155], v[216:219]
    ds_read_b128 v[156:159], v18 offset:22528
    s_waitcnt lgkmcnt(10)
    v_mfma_f32_16x16x32_bf16 v[220:223], a[144:147], v[116:119], v[220:223]
    v_mfma_f32_16x16x32_bf16 v[224:227], a[148:151], v[116:119], v[224:227]
    v_mfma_f32_16x16x32_bf16 v[228:231], v[116:119], a[152:155], v[228:231]
    s_waitcnt lgkmcnt(9)
    v_mfma_f32_16x16x32_bf16 v[232:235], a[144:147], v[120:123], v[232:235]
    v_mfma_f32_16x16x32_bf16 v[236:239], a[148:151], v[120:123], v[236:239]
    v_mfma_f32_16x16x32_bf16 v[240:243], v[120:123], a[152:155], v[240:243]
    s_waitcnt lgkmcnt(8)
    v_mfma_f32_16x16x32_bf16 v[244:247], a[144:147], v[124:127], v[244:247]
    v_mfma_f32_16x16x32_bf16 v[248:251], a[148:151], v[124:127], v[248:251]
    v_mfma_f32_16x16x32_bf16 v[252:255], v[124:127], a[152:155], v[252:255]
    s_waitcnt lgkmcnt(7)
    v_mfma_f32_16x16x32_bf16 v[160:163], a[156:159], v[128:131], v[160:163]
    ds_read_b128 v[96:99], v18 offset:2048
    v_mfma_f32_16x16x32_bf16 v[164:167], a[160:163], v[128:131], v[164:167]
    v_mfma_f32_16x16x32_bf16 v[168:171], v[128:131], a[164:167], v[168:171]
    ds_read_b128 v[100:103], v18 offset:5120
    s_waitcnt lgkmcnt(8)
    v_mfma_f32_16x16x32_bf16 v[172:175], a[156:159], v[132:135], v[172:175]
    v_mfma_f32_16x16x32_bf16 v[176:179], a[160:163], v[132:135], v[176:179]
    ds_read_b128 v[104:107], v18 offset:8192
    v_mfma_f32_16x16x32_bf16 v[180:183], v[132:135], a[164:167], v[180:183]
    s_waitcnt lgkmcnt(8)
    v_mfma_f32_16x16x32_bf16 v[184:187], a[156:159], v[136:139], v[184:187]
    ds_read_b128 v[108:111], v18 offset:11264
    v_mfma_f32_16x16x32_bf16 v[188:191], a[160:163], v[136:139], v[188:191]
    v_mfma_f32_16x16x32_bf16 v[192:195], v[136:139], a[164:167], v[192:195]
    ds_read_b128 v[112:115], v18 offset:14336
    s_waitcnt lgkmcnt(9)
    v_mfma_f32_16x16x32_bf16 v[196:199], a[156:159], v[140:143], v[196:199]
    v_mfma_f32_16x16x32_bf16 v[200:203], a[160:163], v[140:143], v[200:203]
    ds_read_b128 v[116:119], v18 offset:17408
    v_mfma_f32_16x16x32_bf16 v[204:207], v[140:143], a[164:167], v[204:207]
    s_waitcnt lgkmcnt(9)
    v_mfma_f32_16x16x32_bf16 v[208:211], a[156:159], v[144:147], v[208:211]
    ds_read_b128 v[120:123], v18 offset:20480
    v_mfma_f32_16x16x32_bf16 v[212:215], a[160:163], v[144:147], v[212:215]
    v_mfma_f32_16x16x32_bf16 v[216:219], v[144:147], a[164:167], v[216:219]
    ds_read_b128 v[124:127], v18 offset:23552
    s_waitcnt lgkmcnt(10)
    v_mfma_f32_16x16x32_bf16 v[220:223], a[156:159], v[148:151], v[220:223]
    v_mfma_f32_16x16x32_bf16 v[224:227], a[160:163], v[148:151], v[224:227]
    v_mfma_f32_16x16x32_bf16 v[228:231], v[148:151], a[164:167], v[228:231]
    s_waitcnt lgkmcnt(9)
    v_mfma_f32_16x16x32_bf16 v[232:235], a[156:159], v[152:155], v[232:235]
    v_mfma_f32_16x16x32_bf16 v[236:239], a[160:163], v[152:155], v[236:239]
    v_mfma_f32_16x16x32_bf16 v[240:243], v[152:155], a[164:167], v[240:243]
    s_waitcnt lgkmcnt(8)
    v_mfma_f32_16x16x32_bf16 v[244:247], a[156:159], v[156:159], v[244:247]
    v_mfma_f32_16x16x32_bf16 v[248:251], a[160:163], v[156:159], v[248:251]
    v_mfma_f32_16x16x32_bf16 v[252:255], v[156:159], a[164:167], v[252:255]
    s_waitcnt lgkmcnt(0)
    s_waitcnt vmcnt(24)
    s_barrier
    v_mfma_f32_16x16x32_bf16 v[160:163], a[168:171], v[96:99], v[160:163]
    s_add_u32 m0, s92, 98304
    s_add_u32 s93, s94, 12288
    buffer_load_dwordx4 v16, s[52:55], s93 offen offset:0 sc1 lds
    buffer_load_dwordx4 v16, s[52:55], s93 offen offset:1024 sc1 lds
    buffer_load_dwordx4 v16, s[52:55], s93 offen offset:2048 sc1 lds
    s_add_u32 m0, s92, 101376
    s_add_u32 s93, s94, 30720
    buffer_load_dwordx4 v16, s[52:55], s93 offen offset:0 sc1 lds
    buffer_load_dwordx4 v16, s[52:55], s93 offen offset:1024 sc1 lds
    buffer_load_dwordx4 v16, s[52:55], s93 offen offset:2048 sc1 lds
    v_mfma_f32_16x16x32_bf16 v[164:167], a[172:175], v[96:99], v[164:167]
    v_mfma_f32_16x16x32_bf16 v[168:171], v[96:99], a[176:179], v[168:171]
    ds_read_b128 v[128:131], v18 offset:24576
    v_mfma_f32_16x16x32_bf16 v[172:175], a[168:171], v[100:103], v[172:175]
    v_mfma_f32_16x16x32_bf16 v[176:179], a[172:175], v[100:103], v[176:179]
    ds_read_b128 v[132:135], v18 offset:27648
    v_mfma_f32_16x16x32_bf16 v[180:183], v[100:103], a[176:179], v[180:183]
    v_mfma_f32_16x16x32_bf16 v[184:187], a[168:171], v[104:107], v[184:187]
    ds_read_b128 v[136:139], v18 offset:30720
    v_mfma_f32_16x16x32_bf16 v[188:191], a[172:175], v[104:107], v[188:191]
    v_mfma_f32_16x16x32_bf16 v[192:195], v[104:107], a[176:179], v[192:195]
    ds_read_b128 v[140:143], v18 offset:33792
    v_mfma_f32_16x16x32_bf16 v[196:199], a[168:171], v[108:111], v[196:199]
    v_mfma_f32_16x16x32_bf16 v[200:203], a[172:175], v[108:111], v[200:203]
    ds_read_b128 v[144:147], v18 offset:36864
    v_mfma_f32_16x16x32_bf16 v[204:207], v[108:111], a[176:179], v[204:207]
    v_mfma_f32_16x16x32_bf16 v[208:211], a[168:171], v[112:115], v[208:211]
    ds_read_b128 v[148:151], v18 offset:39936
    v_mfma_f32_16x16x32_bf16 v[212:215], a[172:175], v[112:115], v[212:215]
    v_mfma_f32_16x16x32_bf16 v[216:219], v[112:115], a[176:179], v[216:219]
    ds_read_b128 v[152:155], v18 offset:43008
    v_mfma_f32_16x16x32_bf16 v[220:223], a[168:171], v[116:119], v[220:223]
    v_mfma_f32_16x16x32_bf16 v[224:227], a[172:175], v[116:119], v[224:227]
    ds_read_b128 v[156:159], v18 offset:46080
    v_mfma_f32_16x16x32_bf16 v[228:231], v[116:119], a[176:179], v[228:231]
    v_mfma_f32_16x16x32_bf16 v[232:235], a[168:171], v[120:123], v[232:235]
    v_mfma_f32_16x16x32_bf16 v[236:239], a[172:175], v[120:123], v[236:239]
    v_mfma_f32_16x16x32_bf16 v[240:243], v[120:123], a[176:179], v[240:243]
    v_mfma_f32_16x16x32_bf16 v[244:247], a[168:171], v[124:127], v[244:247]
    v_mfma_f32_16x16x32_bf16 v[248:251], a[172:175], v[124:127], v[248:251]
    v_mfma_f32_16x16x32_bf16 v[252:255], v[124:127], a[176:179], v[252:255]
    s_waitcnt lgkmcnt(7)
    v_mfma_f32_16x16x32_bf16 v[160:163], a[180:183], v[128:131], v[160:163]
    ds_read_b128 v[96:99], v18 offset:25600
    v_mfma_f32_16x16x32_bf16 v[164:167], a[184:187], v[128:131], v[164:167]
    v_mfma_f32_16x16x32_bf16 v[168:171], v[128:131], a[188:191], v[168:171]
    ds_read_b128 v[100:103], v18 offset:28672
    s_waitcnt lgkmcnt(8)
    v_mfma_f32_16x16x32_bf16 v[172:175], a[180:183], v[132:135], v[172:175]
    v_mfma_f32_16x16x32_bf16 v[176:179], a[184:187], v[132:135], v[176:179]
    ds_read_b128 v[104:107], v18 offset:31744
    v_mfma_f32_16x16x32_bf16 v[180:183], v[132:135], a[188:191], v[180:183]
    s_waitcnt lgkmcnt(8)
    v_mfma_f32_16x16x32_bf16 v[184:187], a[180:183], v[136:139], v[184:187]
    ds_read_b128 v[108:111], v18 offset:34816
    v_mfma_f32_16x16x32_bf16 v[188:191], a[184:187], v[136:139], v[188:191]
    v_mfma_f32_16x16x32_bf16 v[192:195], v[136:139], a[188:191], v[192:195]
    ds_read_b128 v[112:115], v18 offset:37888
    s_waitcnt lgkmcnt(9)
    v_mfma_f32_16x16x32_bf16 v[196:199], a[180:183], v[140:143], v[196:199]
    v_mfma_f32_16x16x32_bf16 v[200:203], a[184:187], v[140:143], v[200:203]
    ds_read_b128 v[116:119], v18 offset:40960
    v_mfma_f32_16x16x32_bf16 v[204:207], v[140:143], a[188:191], v[204:207]
    s_waitcnt lgkmcnt(9)
    v_mfma_f32_16x16x32_bf16 v[208:211], a[180:183], v[144:147], v[208:211]
    ds_read_b128 v[120:123], v18 offset:44032
    v_mfma_f32_16x16x32_bf16 v[212:215], a[184:187], v[144:147], v[212:215]
    v_mfma_f32_16x16x32_bf16 v[216:219], v[144:147], a[188:191], v[216:219]
    ds_read_b128 v[124:127], v18 offset:47104
    s_waitcnt lgkmcnt(10)
    v_mfma_f32_16x16x32_bf16 v[220:223], a[180:183], v[148:151], v[220:223]
    v_mfma_f32_16x16x32_bf16 v[224:227], a[184:187], v[148:151], v[224:227]
    v_mfma_f32_16x16x32_bf16 v[228:231], v[148:151], a[188:191], v[228:231]
    s_waitcnt lgkmcnt(9)
    v_mfma_f32_16x16x32_bf16 v[232:235], a[180:183], v[152:155], v[232:235]
    v_mfma_f32_16x16x32_bf16 v[236:239], a[184:187], v[152:155], v[236:239]
    v_mfma_f32_16x16x32_bf16 v[240:243], v[152:155], a[188:191], v[240:243]
    s_waitcnt lgkmcnt(8)
    v_mfma_f32_16x16x32_bf16 v[244:247], a[180:183], v[156:159], v[244:247]
    v_mfma_f32_16x16x32_bf16 v[248:251], a[184:187], v[156:159], v[248:251]
    v_mfma_f32_16x16x32_bf16 v[252:255], v[156:159], a[188:191], v[252:255]
    s_waitcnt lgkmcnt(7)
    v_mfma_f32_16x16x32_bf16 v[160:163], a[192:195], v[96:99], v[160:163]
    ds_read_b128 v[128:131], v18 offset:26624
    v_mfma_f32_16x16x32_bf16 v[164:167], a[196:199], v[96:99], v[164:167]
    v_mfma_f32_16x16x32_bf16 v[168:171], v[96:99], a[200:203], v[168:171]
    ds_read_b128 v[132:135], v18 offset:29696
    s_waitcnt lgkmcnt(8)
    v_mfma_f32_16x16x32_bf16 v[172:175], a[192:195], v[100:103], v[172:175]
    v_mfma_f32_16x16x32_bf16 v[176:179], a[196:199], v[100:103], v[176:179]
    ds_read_b128 v[136:139], v18 offset:32768
    v_mfma_f32_16x16x32_bf16 v[180:183], v[100:103], a[200:203], v[180:183]
    s_waitcnt lgkmcnt(8)
    v_mfma_f32_16x16x32_bf16 v[184:187], a[192:195], v[104:107], v[184:187]
    ds_read_b128 v[140:143], v18 offset:35840
    v_mfma_f32_16x16x32_bf16 v[188:191], a[196:199], v[104:107], v[188:191]
    v_mfma_f32_16x16x32_bf16 v[192:195], v[104:107], a[200:203], v[192:195]
    ds_read_b128 v[144:147], v18 offset:38912
    s_waitcnt lgkmcnt(9)
    v_mfma_f32_16x16x32_bf16 v[196:199], a[192:195], v[108:111], v[196:199]
    v_mfma_f32_16x16x32_bf16 v[200:203], a[196:199], v[108:111], v[200:203]
    ds_read_b128 v[148:151], v18 offset:41984
    v_mfma_f32_16x16x32_bf16 v[204:207], v[108:111], a[200:203], v[204:207]
    s_waitcnt lgkmcnt(9)
    v_mfma_f32_16x16x32_bf16 v[208:211], a[192:195], v[112:115], v[208:211]
    ds_read_b128 v[152:155], v18 offset:45056
    v_mfma_f32_16x16x32_bf16 v[212:215], a[196:199], v[112:115], v[212:215]
    v_mfma_f32_16x16x32_bf16 v[216:219], v[112:115], a[200:203], v[216:219]
    ds_read_b128 v[156:159], v18 offset:48128
    s_waitcnt lgkmcnt(10)
    v_mfma_f32_16x16x32_bf16 v[220:223], a[192:195], v[116:119], v[220:223]
    v_mfma_f32_16x16x32_bf16 v[224:227], a[196:199], v[116:119], v[224:227]
    v_mfma_f32_16x16x32_bf16 v[228:231], v[116:119], a[200:203], v[228:231]
    s_waitcnt lgkmcnt(9)
    v_mfma_f32_16x16x32_bf16 v[232:235], a[192:195], v[120:123], v[232:235]
    v_mfma_f32_16x16x32_bf16 v[236:239], a[196:199], v[120:123], v[236:239]
    v_mfma_f32_16x16x32_bf16 v[240:243], v[120:123], a[200:203], v[240:243]
    s_waitcnt lgkmcnt(8)
    v_mfma_f32_16x16x32_bf16 v[244:247], a[192:195], v[124:127], v[244:247]
    v_mfma_f32_16x16x32_bf16 v[248:251], a[196:199], v[124:127], v[248:251]
    v_mfma_f32_16x16x32_bf16 v[252:255], v[124:127], a[200:203], v[252:255]
    s_waitcnt lgkmcnt(0)
    s_waitcnt vmcnt(24)
    s_barrier
    v_mfma_f32_16x16x32_bf16 v[160:163], a[204:207], v[128:131], v[160:163]
    s_add_u32 m0, s92, 122880
    s_add_u32 s93, s94, 15360
    buffer_load_dwordx4 v16, s[52:55], s93 offen offset:0 sc1 lds
    buffer_load_dwordx4 v16, s[52:55], s93 offen offset:1024 sc1 lds
    buffer_load_dwordx4 v16, s[52:55], s93 offen offset:2048 sc1 lds
    s_add_u32 m0, s92, 125952
    s_add_u32 s93, s94, 33792
    buffer_load_dwordx4 v16, s[52:55], s93 offen offset:0 sc1 lds
    buffer_load_dwordx4 v16, s[52:55], s93 offen offset:1024 sc1 lds
    buffer_load_dwordx4 v16, s[52:55], s93 offen offset:2048 sc1 lds
    v_mfma_f32_16x16x32_bf16 v[164:167], a[208:211], v[128:131], v[164:167]
    v_mfma_f32_16x16x32_bf16 v[168:171], v[128:131], a[212:215], v[168:171]
    ds_read_b128 v[96:99], v16 offset:0
    v_mfma_f32_16x16x32_bf16 v[172:175], a[204:207], v[132:135], v[172:175]
    v_mfma_f32_16x16x32_bf16 v[176:179], a[208:211], v[132:135], v[176:179]
    ds_read_b128 v[100:103], v16 offset:3072
    v_mfma_f32_16x16x32_bf16 v[180:183], v[132:135], a[212:215], v[180:183]
    v_mfma_f32_16x16x32_bf16 v[184:187], a[204:207], v[136:139], v[184:187]
    ds_read_b128 v[104:107], v16 offset:6144
    v_mfma_f32_16x16x32_bf16 v[188:191], a[208:211], v[136:139], v[188:191]
    v_mfma_f32_16x16x32_bf16 v[192:195], v[136:139], a[212:215], v[192:195]
    ds_read_b128 v[108:111], v16 offset:9216
    v_mfma_f32_16x16x32_bf16 v[196:199], a[204:207], v[140:143], v[196:199]
    v_mfma_f32_16x16x32_bf16 v[200:203], a[208:211], v[140:143], v[200:203]
    ds_read_b128 v[112:115], v16 offset:12288
    v_mfma_f32_16x16x32_bf16 v[204:207], v[140:143], a[212:215], v[204:207]
    v_mfma_f32_16x16x32_bf16 v[208:211], a[204:207], v[144:147], v[208:211]
    ds_read_b128 v[116:119], v16 offset:15360
    v_mfma_f32_16x16x32_bf16 v[212:215], a[208:211], v[144:147], v[212:215]
    v_mfma_f32_16x16x32_bf16 v[216:219], v[144:147], a[212:215], v[216:219]
    ds_read_b128 v[120:123], v16 offset:18432
    v_mfma_f32_16x16x32_bf16 v[220:223], a[204:207], v[148:151], v[220:223]
    v_mfma_f32_16x16x32_bf16 v[224:227], a[208:211], v[148:151], v[224:227]
    ds_read_b128 v[124:127], v16 offset:21504
    v_mfma_f32_16x16x32_bf16 v[228:231], v[148:151], a[212:215], v[228:231]
    v_mfma_f32_16x16x32_bf16 v[232:235], a[204:207], v[152:155], v[232:235]
    v_mfma_f32_16x16x32_bf16 v[236:239], a[208:211], v[152:155], v[236:239]
    v_mfma_f32_16x16x32_bf16 v[240:243], v[152:155], a[212:215], v[240:243]
    v_mfma_f32_16x16x32_bf16 v[244:247], a[204:207], v[156:159], v[244:247]
    v_mfma_f32_16x16x32_bf16 v[248:251], a[208:211], v[156:159], v[248:251]
    v_mfma_f32_16x16x32_bf16 v[252:255], v[156:159], a[212:215], v[252:255]
    v_cvt_pk_bf16_f32 v32, v160, v161
    v_cvt_pk_bf16_f32 v33, v162, v163
    v_cvt_pk_bf16_f32 v34, v164, v165
    v_cvt_pk_bf16_f32 v35, v166, v167
    s_add_u32 s93, s96, 0
    buffer_store_dwordx4 v[32:35], v16, s[52:55], s93 offen sc1
    v_cvt_pk_bf16_f32 v36, v172, v173
    v_cvt_pk_bf16_f32 v37, v174, v175
    v_cvt_pk_bf16_f32 v38, v176, v177
    v_cvt_pk_bf16_f32 v39, v178, v179
    s_add_u32 s93, s96, 4096
    buffer_store_dwordx4 v[36:39], v16, s[52:55], s93 offen sc1
    v_cvt_pk_bf16_f32 v40, v184, v185
    v_cvt_pk_bf16_f32 v41, v186, v187
    v_cvt_pk_bf16_f32 v42, v188, v189
    v_cvt_pk_bf16_f32 v43, v190, v191
    s_add_u32 s93, s96, 262144
    buffer_store_dwordx4 v[40:43], v16, s[52:55], s93 offen sc1
    v_cvt_pk_bf16_f32 v44, v196, v197
    v_cvt_pk_bf16_f32 v45, v198, v199
    v_cvt_pk_bf16_f32 v46, v200, v201
    v_cvt_pk_bf16_f32 v47, v202, v203
    s_add_u32 s93, s96, 266240
    buffer_store_dwordx4 v[44:47], v16, s[52:55], s93 offen sc1
    v_cvt_pk_bf16_f32 v32, v208, v209
    v_cvt_pk_bf16_f32 v33, v210, v211
    v_cvt_pk_bf16_f32 v34, v212, v213
    v_cvt_pk_bf16_f32 v35, v214, v215
    s_add_u32 s93, s96, 524288
    buffer_store_dwordx4 v[32:35], v16, s[52:55], s93 offen sc1
    v_cvt_pk_bf16_f32 v36, v220, v221
    v_cvt_pk_bf16_f32 v37, v222, v223
    v_cvt_pk_bf16_f32 v38, v224, v225
    v_cvt_pk_bf16_f32 v39, v226, v227
    s_add_u32 s93, s96, 528384
    buffer_store_dwordx4 v[36:39], v16, s[52:55], s93 offen sc1
    v_cvt_pk_bf16_f32 v40, v232, v233
    v_cvt_pk_bf16_f32 v41, v234, v235
    v_cvt_pk_bf16_f32 v42, v236, v237
    v_cvt_pk_bf16_f32 v43, v238, v239
    s_add_u32 s93, s96, 786432
    buffer_store_dwordx4 v[40:43], v16, s[52:55], s93 offen sc1
    v_cvt_pk_bf16_f32 v44, v244, v245
    v_cvt_pk_bf16_f32 v45, v246, v247
    v_cvt_pk_bf16_f32 v46, v248, v249
    v_cvt_pk_bf16_f32 v47, v250, v251
    s_add_u32 s93, s96, 790528
    buffer_store_dwordx4 v[44:47], v16, s[52:55], s93 offen sc1
    v_cvt_pk_bf16_f32 v48, v168, v169
    v_cvt_pk_bf16_f32 v49, v170, v171
    v_cvt_pk_bf16_f32 v50, v180, v181
    v_cvt_pk_bf16_f32 v51, v182, v183
    s_add_u32 s93, s97, 0
    buffer_store_dwordx4 v[48:51], v16, s[52:55], s93 offen sc1
    v_cvt_pk_bf16_f32 v52, v192, v193
    v_cvt_pk_bf16_f32 v53, v194, v195
    v_cvt_pk_bf16_f32 v54, v204, v205
    v_cvt_pk_bf16_f32 v55, v206, v207
    s_add_u32 s93, s97, 262144
    buffer_store_dwordx4 v[52:55], v16, s[52:55], s93 offen sc1
    v_cvt_pk_bf16_f32 v56, v216, v217
    v_cvt_pk_bf16_f32 v57, v218, v219
    v_cvt_pk_bf16_f32 v58, v228, v229
    v_cvt_pk_bf16_f32 v59, v230, v231
    s_add_u32 s93, s97, 524288
    buffer_store_dwordx4 v[56:59], v16, s[52:55], s93 offen sc1
    v_cvt_pk_bf16_f32 v60, v240, v241
    v_cvt_pk_bf16_f32 v61, v242, v243
    v_cvt_pk_bf16_f32 v62, v252, v253
    v_cvt_pk_bf16_f32 v63, v254, v255
    s_add_u32 s93, s97, 786432
    buffer_store_dwordx4 v[60:63], v16, s[52:55], s93 offen sc1
    s_add_u32 s96, s96, 2097152
    s_add_u32 s97, s97, 2097152
    s_add_u32 s94, s94, 294912
    s_cmp_ge_u32 s95, 6
    s_cselect_b32 s93, 294912, 0
    s_sub_u32 s94, s94, s93
    s_add_u32 s95, s95, 1
    s_cmp_lt_u32 s95, 8
    s_waitcnt lgkmcnt(0)
    s_cbranch_scc1 L_g1_qkvm
    s_waitcnt vmcnt(0)
    s_barrier
    s_lshl_b32 s83, s95, 3
    s_and_b32 s82, s5, 1
    s_lshl_b32 s82, s82, 2
    s_add_u32 s83, s83, s82
    v_mov_b32 v21, 0
    v_mov_b32 v22, 1
    s_cmp_lg_u32 s3, 0
    s_cbranch_scc1 L_sig_18
    s_mov_b64 exec, 1
    buffer_atomic_add v22, v21, s[48:51], s83 offen offset:24
    s_mov_b64 exec, -1
L_sig_18:
    s_branch L_m_p3q
L_g1glu_m:
    s_cmp_lg_u32 s5, 223
    s_cbranch_scc1 L_m_g1
    v_lshlrev_b32 v8, 4, v0
    v_mov_b32 v12, 0
    v_mov_b32 v13, 0
    v_mov_b32 v14, 0
    v_mov_b32 v15, 0
    s_mov_b32 s84, 0x8300000
    buffer_store_dwordx4 v[12:15], v8, s[52:55], s84 offen sc1
    s_add_u32 s84, s84, 4096
    buffer_store_dwordx4 v[12:15], v8, s[52:55], s84 offen sc1
    s_add_u32 s84, s84, 4096
    buffer_store_dwordx4 v[12:15], v8, s[52:55], s84 offen sc1
    s_add_u32 s84, s84, 4096
    buffer_store_dwordx4 v[12:15], v8, s[52:55], s84 offen sc1
    s_add_u32 s84, s84, 4096
    buffer_store_dwordx4 v[12:15], v8, s[52:55], s84 offen sc1
    s_add_u32 s84, s84, 4096
    buffer_store_dwordx4 v[12:15], v8, s[52:55], s84 offen sc1
    s_add_u32 s84, s84, 4096
    s_waitcnt vmcnt(0)
    s_barrier
    v_mov_b32 v8, 0
    v_mov_b32 v9, 1
    s_cmp_lg_u32 s3, 0
    s_cbranch_scc1 L_sig_19
    s_mov_b64 exec, 1
    buffer_atomic_add v9, v8, s[48:51], 0 offen offset:20
    s_mov_b64 exec, -1
L_sig_19:
L_m_g1:
    s_sub_u32 s100, s5, 128
    s_lshr_b32 s100, s100, 1
    s_mul_i32 s85, s100, 192
    s_mul_i32 s87, s3, 18432
    s_mul_i32 s86, s3, 192
    s_mov_b32 s84, 5462
    s_mov_b32 s88, 18432
    v_add_u32 v2, s86, v1
    v_add_u32 v2, 0, v2
    v_mul_u32_u24 v3, s84, v2
    v_lshrrev_b32 v3, 16, v3
    v_mul_u32_u24 v10, 12, v3
    v_sub_u32 v2, v2, v10
    v_mul_u32_u24 v4, 9216, v3
    v_lshl_add_u32 v4, v2, 4, v4
    v_mul_u32_u24 v10, 11, v2
    v_lshrrev_b32 v10, 5, v10
    v_mul_u32_u24 v11, 96, v3
    v_mad_u32_u24 v11, s88, v10, v11
    v_mul_u32_u24 v10, 3, v10
    v_sub_u32 v2, v2, v10
    v_lshl_add_u32 v11, v2, 5, v11
    v_add_u32 v2, s86, v1
    v_add_u32 v2, 64, v2
    v_mul_u32_u24 v3, s84, v2
    v_lshrrev_b32 v3, 16, v3
    v_mul_u32_u24 v10, 12, v3
    v_sub_u32 v2, v2, v10
    v_mul_u32_u24 v5, 9216, v3
    v_lshl_add_u32 v5, v2, 4, v5
    v_mul_u32_u24 v10, 11, v2
    v_lshrrev_b32 v10, 5, v10
    v_mul_u32_u24 v12, 96, v3
    v_mad_u32_u24 v12, s88, v10, v12
    v_mul_u32_u24 v10, 3, v10
    v_sub_u32 v2, v2, v10
    v_lshl_add_u32 v12, v2, 5, v12
    v_add_u32 v2, s86, v1
    v_add_u32 v2, 128, v2
    v_mul_u32_u24 v3, s84, v2
    v_lshrrev_b32 v3, 16, v3
    v_mul_u32_u24 v10, 12, v3
    v_sub_u32 v2, v2, v10
    v_mul_u32_u24 v6, 9216, v3
    v_lshl_add_u32 v6, v2, 4, v6
    v_mul_u32_u24 v10, 11, v2
    v_lshrrev_b32 v10, 5, v10
    v_mul_u32_u24 v13, 96, v3
    v_mad_u32_u24 v13, s88, v10, v13
    v_mul_u32_u24 v10, 3, v10
    v_sub_u32 v2, v2, v10
    v_lshl_add_u32 v13, v2, 5, v13
    buffer_load_dwordx4 a[0:3], v4, s[32:35], s85 offen
    buffer_load_dwordx4 a[12:15], v4, s[36:39], s85 offen
    buffer_load_dwordx4 a[4:7], v5, s[32:35], s85 offen
    buffer_load_dwordx4 a[16:19], v5, s[36:39], s85 offen
    buffer_load_dwordx4 a[8:11], v6, s[32:35], s85 offen
    buffer_load_dwordx4 a[20:23], v6, s[36:39], s85 offen
    s_add_u32 s85, s85, 589824
    buffer_load_dwordx4 a[24:27], v4, s[32:35], s85 offen
    buffer_load_dwordx4 a[36:39], v4, s[36:39], s85 offen
    buffer_load_dwordx4 a[28:31], v5, s[32:35], s85 offen
    buffer_load_dwordx4 a[40:43], v5, s[36:39], s85 offen
    buffer_load_dwordx4 a[32:35], v6, s[32:35], s85 offen
    buffer_load_dwordx4 a[44:47], v6, s[36:39], s85 offen
    s_add_u32 s85, s85, 589824
    buffer_load_dwordx4 a[48:51], v4, s[32:35], s85 offen
    buffer_load_dwordx4 a[60:63], v4, s[36:39], s85 offen
    buffer_load_dwordx4 a[52:55], v5, s[32:35], s85 offen
    buffer_load_dwordx4 a[64:67], v5, s[36:39], s85 offen
    buffer_load_dwordx4 a[56:59], v6, s[32:35], s85 offen
    buffer_load_dwordx4 a[68:71], v6, s[36:39], s85 offen
    s_add_u32 s85, s85, 589824
    buffer_load_dwordx4 a[72:75], v4, s[32:35], s85 offen
    buffer_load_dwordx4 a[84:87], v4, s[36:39], s85 offen
    buffer_load_dwordx4 a[76:79], v5, s[32:35], s85 offen
    buffer_load_dwordx4 a[88:91], v5, s[36:39], s85 offen
    buffer_load_dwordx4 a[80:83], v6, s[32:35], s85 offen
    buffer_load_dwordx4 a[92:95], v6, s[36:39], s85 offen
    s_add_u32 s85, s85, 589824
    buffer_load_dwordx4 a[96:99], v4, s[32:35], s85 offen
    buffer_load_dwordx4 a[108:111], v4, s[36:39], s85 offen
    buffer_load_dwordx4 a[100:103], v5, s[32:35], s85 offen
    buffer_load_dwordx4 a[112:115], v5, s[36:39], s85 offen
    buffer_load_dwordx4 a[104:107], v6, s[32:35], s85 offen
    buffer_load_dwordx4 a[116:119], v6, s[36:39], s85 offen
    s_add_u32 s85, s85, 589824
    buffer_load_dwordx4 a[120:123], v4, s[32:35], s85 offen
    buffer_load_dwordx4 a[132:135], v4, s[36:39], s85 offen
    buffer_load_dwordx4 a[124:127], v5, s[32:35], s85 offen
    buffer_load_dwordx4 a[136:139], v5, s[36:39], s85 offen
    buffer_load_dwordx4 a[128:131], v6, s[32:35], s85 offen
    buffer_load_dwordx4 a[140:143], v6, s[36:39], s85 offen
    s_add_u32 s85, s85, 589824
    buffer_load_dwordx4 a[144:147], v4, s[32:35], s85 offen
    buffer_load_dwordx4 a[156:159], v4, s[36:39], s85 offen
    buffer_load_dwordx4 a[148:151], v5, s[32:35], s85 offen
    buffer_load_dwordx4 a[160:163], v5, s[36:39], s85 offen
    buffer_load_dwordx4 a[152:155], v6, s[32:35], s85 offen
    buffer_load_dwordx4 a[164:167], v6, s[36:39], s85 offen
    s_add_u32 s85, s85, 589824
    buffer_load_dwordx4 a[168:171], v4, s[32:35], s85 offen
    buffer_load_dwordx4 a[180:183], v4, s[36:39], s85 offen
    buffer_load_dwordx4 a[172:175], v5, s[32:35], s85 offen
    buffer_load_dwordx4 a[184:187], v5, s[36:39], s85 offen
    buffer_load_dwordx4 a[176:179], v6, s[32:35], s85 offen
    buffer_load_dwordx4 a[188:191], v6, s[36:39], s85 offen
    s_add_u32 s85, s85, 589824
    buffer_load_dwordx4 a[192:195], v4, s[32:35], s85 offen
    buffer_load_dwordx4 a[204:207], v4, s[36:39], s85 offen
    buffer_load_dwordx4 a[196:199], v5, s[32:35], s85 offen
    buffer_load_dwordx4 a[208:211], v5, s[36:39], s85 offen
    buffer_load_dwordx4 a[200:203], v6, s[32:35], s85 offen
    buffer_load_dwordx4 a[212:215], v6, s[36:39], s85 offen
    s_add_u32 s85, s85, 589824
    v_lshrrev_b32 v2, 4, v1
    v_bfe_u32 v3, v1, 2, 2
    v_lshl_add_u32 v2, v2, 3, v3
    v_mul_u32_u24 v8, 96, v2
    v_and_b32 v3, 3, v1
    v_lshl_add_u32 v8, v3, 3, v8
    v_add_u32 v8, s87, v8
    v_add_u32 v9, 0, v11
    s_waitcnt vmcnt(53)
    ds_write2_b32 v9, a0, a1 offset0:0 offset1:2
    ds_write2_b32 v9, a2, a3 offset0:4 offset1:6
    s_waitcnt vmcnt(52)
    ds_write2_b32 v9, a12, a13 offset0:1 offset1:3
    ds_write2_b32 v9, a14, a15 offset0:5 offset1:7
    v_add_u32 v9, 0, v12
    s_waitcnt vmcnt(51)
    ds_write2_b32 v9, a4, a5 offset0:0 offset1:2
    ds_write2_b32 v9, a6, a7 offset0:4 offset1:6
    s_waitcnt vmcnt(50)
    ds_write2_b32 v9, a16, a17 offset0:1 offset1:3
    ds_write2_b32 v9, a18, a19 offset0:5 offset1:7
    v_add_u32 v9, 0, v13
    s_waitcnt vmcnt(49)
    ds_write2_b32 v9, a8, a9 offset0:0 offset1:2
    ds_write2_b32 v9, a10, a11 offset0:4 offset1:6
    s_waitcnt vmcnt(48)
    ds_write2_b32 v9, a20, a21 offset0:1 offset1:3
    ds_write2_b32 v9, a22, a23 offset0:5 offset1:7
    v_add_u32 v9, 6144, v11
    s_waitcnt vmcnt(47)
    ds_write2_b32 v9, a24, a25 offset0:0 offset1:2
    ds_write2_b32 v9, a26, a27 offset0:4 offset1:6
    s_waitcnt vmcnt(46)
    ds_write2_b32 v9, a36, a37 offset0:1 offset1:3
    ds_write2_b32 v9, a38, a39 offset0:5 offset1:7
    v_add_u32 v9, 6144, v12
    s_waitcnt vmcnt(45)
    ds_write2_b32 v9, a28, a29 offset0:0 offset1:2
    ds_write2_b32 v9, a30, a31 offset0:4 offset1:6
    s_waitcnt vmcnt(44)
    ds_write2_b32 v9, a40, a41 offset0:1 offset1:3
    ds_write2_b32 v9, a42, a43 offset0:5 offset1:7
    v_add_u32 v9, 6144, v13
    s_waitcnt vmcnt(43)
    ds_write2_b32 v9, a32, a33 offset0:0 offset1:2
    ds_write2_b32 v9, a34, a35 offset0:4 offset1:6
    s_waitcnt vmcnt(42)
    ds_write2_b32 v9, a44, a45 offset0:1 offset1:3
    ds_write2_b32 v9, a46, a47 offset0:5 offset1:7
    v_add_u32 v9, 12288, v11
    s_waitcnt vmcnt(41)
    ds_write2_b32 v9, a48, a49 offset0:0 offset1:2
    ds_write2_b32 v9, a50, a51 offset0:4 offset1:6
    s_waitcnt vmcnt(40)
    ds_write2_b32 v9, a60, a61 offset0:1 offset1:3
    ds_write2_b32 v9, a62, a63 offset0:5 offset1:7
    v_add_u32 v9, 12288, v12
    s_waitcnt vmcnt(39)
    ds_write2_b32 v9, a52, a53 offset0:0 offset1:2
    ds_write2_b32 v9, a54, a55 offset0:4 offset1:6
    s_waitcnt vmcnt(38)
    ds_write2_b32 v9, a64, a65 offset0:1 offset1:3
    ds_write2_b32 v9, a66, a67 offset0:5 offset1:7
    v_add_u32 v9, 12288, v13
    s_waitcnt vmcnt(37)
    ds_write2_b32 v9, a56, a57 offset0:0 offset1:2
    ds_write2_b32 v9, a58, a59 offset0:4 offset1:6
    s_waitcnt vmcnt(36)
    ds_write2_b32 v9, a68, a69 offset0:1 offset1:3
    ds_write2_b32 v9, a70, a71 offset0:5 offset1:7
    s_waitcnt lgkmcnt(0)
    s_barrier
    ds_read_b64_tr_b16 a[0:1], v8 offset:0
    ds_read_b64_tr_b16 a[2:3], v8 offset:384
    ds_read_b64_tr_b16 a[4:5], v8 offset:32
    ds_read_b64_tr_b16 a[6:7], v8 offset:416
    ds_read_b64_tr_b16 a[8:9], v8 offset:64
    ds_read_b64_tr_b16 a[10:11], v8 offset:448
    ds_read_b64_tr_b16 a[12:13], v8 offset:3072
    ds_read_b64_tr_b16 a[14:15], v8 offset:3456
    ds_read_b64_tr_b16 a[16:17], v8 offset:3104
    ds_read_b64_tr_b16 a[18:19], v8 offset:3488
    ds_read_b64_tr_b16 a[20:21], v8 offset:3136
    ds_read_b64_tr_b16 a[22:23], v8 offset:3520
    ds_read_b64_tr_b16 a[24:25], v8 offset:6144
    ds_read_b64_tr_b16 a[26:27], v8 offset:6528
    ds_read_b64_tr_b16 a[28:29], v8 offset:6176
    ds_read_b64_tr_b16 a[30:31], v8 offset:6560
    ds_read_b64_tr_b16 a[32:33], v8 offset:6208
    ds_read_b64_tr_b16 a[34:35], v8 offset:6592
    ds_read_b64_tr_b16 a[36:37], v8 offset:9216
    ds_read_b64_tr_b16 a[38:39], v8 offset:9600
    ds_read_b64_tr_b16 a[40:41], v8 offset:9248
    ds_read_b64_tr_b16 a[42:43], v8 offset:9632
    ds_read_b64_tr_b16 a[44:45], v8 offset:9280
    ds_read_b64_tr_b16 a[46:47], v8 offset:9664
    ds_read_b64_tr_b16 a[48:49], v8 offset:12288
    ds_read_b64_tr_b16 a[50:51], v8 offset:12672
    ds_read_b64_tr_b16 a[52:53], v8 offset:12320
    ds_read_b64_tr_b16 a[54:55], v8 offset:12704
    ds_read_b64_tr_b16 a[56:57], v8 offset:12352
    ds_read_b64_tr_b16 a[58:59], v8 offset:12736
    ds_read_b64_tr_b16 a[60:61], v8 offset:15360
    ds_read_b64_tr_b16 a[62:63], v8 offset:15744
    ds_read_b64_tr_b16 a[64:65], v8 offset:15392
    ds_read_b64_tr_b16 a[66:67], v8 offset:15776
    ds_read_b64_tr_b16 a[68:69], v8 offset:15424
    ds_read_b64_tr_b16 a[70:71], v8 offset:15808
    s_waitcnt lgkmcnt(0)
    s_barrier
    v_add_u32 v9, 0, v11
    s_waitcnt vmcnt(35)
    ds_write2_b32 v9, a72, a73 offset0:0 offset1:2
    ds_write2_b32 v9, a74, a75 offset0:4 offset1:6
    s_waitcnt vmcnt(34)
    ds_write2_b32 v9, a84, a85 offset0:1 offset1:3
    ds_write2_b32 v9, a86, a87 offset0:5 offset1:7
    v_add_u32 v9, 0, v12
    s_waitcnt vmcnt(33)
    ds_write2_b32 v9, a76, a77 offset0:0 offset1:2
    ds_write2_b32 v9, a78, a79 offset0:4 offset1:6
    s_waitcnt vmcnt(32)
    ds_write2_b32 v9, a88, a89 offset0:1 offset1:3
    ds_write2_b32 v9, a90, a91 offset0:5 offset1:7
    v_add_u32 v9, 0, v13
    s_waitcnt vmcnt(31)
    ds_write2_b32 v9, a80, a81 offset0:0 offset1:2
    ds_write2_b32 v9, a82, a83 offset0:4 offset1:6
    s_waitcnt vmcnt(30)
    ds_write2_b32 v9, a92, a93 offset0:1 offset1:3
    ds_write2_b32 v9, a94, a95 offset0:5 offset1:7
    v_add_u32 v9, 6144, v11
    s_waitcnt vmcnt(29)
    ds_write2_b32 v9, a96, a97 offset0:0 offset1:2
    ds_write2_b32 v9, a98, a99 offset0:4 offset1:6
    s_waitcnt vmcnt(28)
    ds_write2_b32 v9, a108, a109 offset0:1 offset1:3
    ds_write2_b32 v9, a110, a111 offset0:5 offset1:7
    v_add_u32 v9, 6144, v12
    s_waitcnt vmcnt(27)
    ds_write2_b32 v9, a100, a101 offset0:0 offset1:2
    ds_write2_b32 v9, a102, a103 offset0:4 offset1:6
    s_waitcnt vmcnt(26)
    ds_write2_b32 v9, a112, a113 offset0:1 offset1:3
    ds_write2_b32 v9, a114, a115 offset0:5 offset1:7
    v_add_u32 v9, 6144, v13
    s_waitcnt vmcnt(25)
    ds_write2_b32 v9, a104, a105 offset0:0 offset1:2
    ds_write2_b32 v9, a106, a107 offset0:4 offset1:6
    s_waitcnt vmcnt(24)
    ds_write2_b32 v9, a116, a117 offset0:1 offset1:3
    ds_write2_b32 v9, a118, a119 offset0:5 offset1:7
    v_add_u32 v9, 12288, v11
    s_waitcnt vmcnt(23)
    ds_write2_b32 v9, a120, a121 offset0:0 offset1:2
    ds_write2_b32 v9, a122, a123 offset0:4 offset1:6
    s_waitcnt vmcnt(22)
    ds_write2_b32 v9, a132, a133 offset0:1 offset1:3
    ds_write2_b32 v9, a134, a135 offset0:5 offset1:7
    v_add_u32 v9, 12288, v12
    s_waitcnt vmcnt(21)
    ds_write2_b32 v9, a124, a125 offset0:0 offset1:2
    ds_write2_b32 v9, a126, a127 offset0:4 offset1:6
    s_waitcnt vmcnt(20)
    ds_write2_b32 v9, a136, a137 offset0:1 offset1:3
    ds_write2_b32 v9, a138, a139 offset0:5 offset1:7
    v_add_u32 v9, 12288, v13
    s_waitcnt vmcnt(19)
    ds_write2_b32 v9, a128, a129 offset0:0 offset1:2
    ds_write2_b32 v9, a130, a131 offset0:4 offset1:6
    s_waitcnt vmcnt(18)
    ds_write2_b32 v9, a140, a141 offset0:1 offset1:3
    ds_write2_b32 v9, a142, a143 offset0:5 offset1:7
    s_waitcnt lgkmcnt(0)
    s_barrier
    ds_read_b64_tr_b16 a[72:73], v8 offset:0
    ds_read_b64_tr_b16 a[74:75], v8 offset:384
    ds_read_b64_tr_b16 a[76:77], v8 offset:32
    ds_read_b64_tr_b16 a[78:79], v8 offset:416
    ds_read_b64_tr_b16 a[80:81], v8 offset:64
    ds_read_b64_tr_b16 a[82:83], v8 offset:448
    ds_read_b64_tr_b16 a[84:85], v8 offset:3072
    ds_read_b64_tr_b16 a[86:87], v8 offset:3456
    ds_read_b64_tr_b16 a[88:89], v8 offset:3104
    ds_read_b64_tr_b16 a[90:91], v8 offset:3488
    ds_read_b64_tr_b16 a[92:93], v8 offset:3136
    ds_read_b64_tr_b16 a[94:95], v8 offset:3520
    ds_read_b64_tr_b16 a[96:97], v8 offset:6144
    ds_read_b64_tr_b16 a[98:99], v8 offset:6528
    ds_read_b64_tr_b16 a[100:101], v8 offset:6176
    ds_read_b64_tr_b16 a[102:103], v8 offset:6560
    ds_read_b64_tr_b16 a[104:105], v8 offset:6208
    ds_read_b64_tr_b16 a[106:107], v8 offset:6592
    ds_read_b64_tr_b16 a[108:109], v8 offset:9216
    ds_read_b64_tr_b16 a[110:111], v8 offset:9600
    ds_read_b64_tr_b16 a[112:113], v8 offset:9248
    ds_read_b64_tr_b16 a[114:115], v8 offset:9632
    ds_read_b64_tr_b16 a[116:117], v8 offset:9280
    ds_read_b64_tr_b16 a[118:119], v8 offset:9664
    ds_read_b64_tr_b16 a[120:121], v8 offset:12288
    ds_read_b64_tr_b16 a[122:123], v8 offset:12672
    ds_read_b64_tr_b16 a[124:125], v8 offset:12320
    ds_read_b64_tr_b16 a[126:127], v8 offset:12704
    ds_read_b64_tr_b16 a[128:129], v8 offset:12352
    ds_read_b64_tr_b16 a[130:131], v8 offset:12736
    ds_read_b64_tr_b16 a[132:133], v8 offset:15360
    ds_read_b64_tr_b16 a[134:135], v8 offset:15744
    ds_read_b64_tr_b16 a[136:137], v8 offset:15392
    ds_read_b64_tr_b16 a[138:139], v8 offset:15776
    ds_read_b64_tr_b16 a[140:141], v8 offset:15424
    ds_read_b64_tr_b16 a[142:143], v8 offset:15808
    s_waitcnt lgkmcnt(0)
    s_barrier
    v_add_u32 v9, 0, v11
    s_waitcnt vmcnt(17)
    ds_write2_b32 v9, a144, a145 offset0:0 offset1:2
    ds_write2_b32 v9, a146, a147 offset0:4 offset1:6
    s_waitcnt vmcnt(16)
    ds_write2_b32 v9, a156, a157 offset0:1 offset1:3
    ds_write2_b32 v9, a158, a159 offset0:5 offset1:7
    v_add_u32 v9, 0, v12
    s_waitcnt vmcnt(15)
    ds_write2_b32 v9, a148, a149 offset0:0 offset1:2
    ds_write2_b32 v9, a150, a151 offset0:4 offset1:6
    s_waitcnt vmcnt(14)
    ds_write2_b32 v9, a160, a161 offset0:1 offset1:3
    ds_write2_b32 v9, a162, a163 offset0:5 offset1:7
    v_add_u32 v9, 0, v13
    s_waitcnt vmcnt(13)
    ds_write2_b32 v9, a152, a153 offset0:0 offset1:2
    ds_write2_b32 v9, a154, a155 offset0:4 offset1:6
    s_waitcnt vmcnt(12)
    ds_write2_b32 v9, a164, a165 offset0:1 offset1:3
    ds_write2_b32 v9, a166, a167 offset0:5 offset1:7
    v_add_u32 v9, 6144, v11
    s_waitcnt vmcnt(11)
    ds_write2_b32 v9, a168, a169 offset0:0 offset1:2
    ds_write2_b32 v9, a170, a171 offset0:4 offset1:6
    s_waitcnt vmcnt(10)
    ds_write2_b32 v9, a180, a181 offset0:1 offset1:3
    ds_write2_b32 v9, a182, a183 offset0:5 offset1:7
    v_add_u32 v9, 6144, v12
    s_waitcnt vmcnt(9)
    ds_write2_b32 v9, a172, a173 offset0:0 offset1:2
    ds_write2_b32 v9, a174, a175 offset0:4 offset1:6
    s_waitcnt vmcnt(8)
    ds_write2_b32 v9, a184, a185 offset0:1 offset1:3
    ds_write2_b32 v9, a186, a187 offset0:5 offset1:7
    v_add_u32 v9, 6144, v13
    s_waitcnt vmcnt(7)
    ds_write2_b32 v9, a176, a177 offset0:0 offset1:2
    ds_write2_b32 v9, a178, a179 offset0:4 offset1:6
    s_waitcnt vmcnt(6)
    ds_write2_b32 v9, a188, a189 offset0:1 offset1:3
    ds_write2_b32 v9, a190, a191 offset0:5 offset1:7
    v_add_u32 v9, 12288, v11
    s_waitcnt vmcnt(5)
    ds_write2_b32 v9, a192, a193 offset0:0 offset1:2
    ds_write2_b32 v9, a194, a195 offset0:4 offset1:6
    s_waitcnt vmcnt(4)
    ds_write2_b32 v9, a204, a205 offset0:1 offset1:3
    ds_write2_b32 v9, a206, a207 offset0:5 offset1:7
    v_add_u32 v9, 12288, v12
    s_waitcnt vmcnt(3)
    ds_write2_b32 v9, a196, a197 offset0:0 offset1:2
    ds_write2_b32 v9, a198, a199 offset0:4 offset1:6
    s_waitcnt vmcnt(2)
    ds_write2_b32 v9, a208, a209 offset0:1 offset1:3
    ds_write2_b32 v9, a210, a211 offset0:5 offset1:7
    v_add_u32 v9, 12288, v13
    s_waitcnt vmcnt(1)
    ds_write2_b32 v9, a200, a201 offset0:0 offset1:2
    ds_write2_b32 v9, a202, a203 offset0:4 offset1:6
    s_waitcnt vmcnt(0)
    ds_write2_b32 v9, a212, a213 offset0:1 offset1:3
    ds_write2_b32 v9, a214, a215 offset0:5 offset1:7
    s_waitcnt lgkmcnt(0)
    s_barrier
    ds_read_b64_tr_b16 a[144:145], v8 offset:0
    ds_read_b64_tr_b16 a[146:147], v8 offset:384
    ds_read_b64_tr_b16 a[148:149], v8 offset:32
    ds_read_b64_tr_b16 a[150:151], v8 offset:416
    ds_read_b64_tr_b16 a[152:153], v8 offset:64
    ds_read_b64_tr_b16 a[154:155], v8 offset:448
    ds_read_b64_tr_b16 a[156:157], v8 offset:3072
    ds_read_b64_tr_b16 a[158:159], v8 offset:3456
    ds_read_b64_tr_b16 a[160:161], v8 offset:3104
    ds_read_b64_tr_b16 a[162:163], v8 offset:3488
    ds_read_b64_tr_b16 a[164:165], v8 offset:3136
    ds_read_b64_tr_b16 a[166:167], v8 offset:3520
    ds_read_b64_tr_b16 a[168:169], v8 offset:6144
    ds_read_b64_tr_b16 a[170:171], v8 offset:6528
    ds_read_b64_tr_b16 a[172:173], v8 offset:6176
    ds_read_b64_tr_b16 a[174:175], v8 offset:6560
    ds_read_b64_tr_b16 a[176:177], v8 offset:6208
    ds_read_b64_tr_b16 a[178:179], v8 offset:6592
    ds_read_b64_tr_b16 a[180:181], v8 offset:9216
    ds_read_b64_tr_b16 a[182:183], v8 offset:9600
    ds_read_b64_tr_b16 a[184:185], v8 offset:9248
    ds_read_b64_tr_b16 a[186:187], v8 offset:9632
    ds_read_b64_tr_b16 a[188:189], v8 offset:9280
    ds_read_b64_tr_b16 a[190:191], v8 offset:9664
    ds_read_b64_tr_b16 a[192:193], v8 offset:12288
    ds_read_b64_tr_b16 a[194:195], v8 offset:12672
    ds_read_b64_tr_b16 a[196:197], v8 offset:12320
    ds_read_b64_tr_b16 a[198:199], v8 offset:12704
    ds_read_b64_tr_b16 a[200:201], v8 offset:12352
    ds_read_b64_tr_b16 a[202:203], v8 offset:12736
    ds_read_b64_tr_b16 a[204:205], v8 offset:15360
    ds_read_b64_tr_b16 a[206:207], v8 offset:15744
    ds_read_b64_tr_b16 a[208:209], v8 offset:15392
    ds_read_b64_tr_b16 a[210:211], v8 offset:15776
    ds_read_b64_tr_b16 a[212:213], v8 offset:15424
    ds_read_b64_tr_b16 a[214:215], v8 offset:15808
    s_waitcnt lgkmcnt(0)
    s_mul_i32 s96, s99, 48
    s_add_u32 s96, s96, s100
    s_mul_i32 s96, s96, 3072
    s_mul_i32 s85, s3, 12
    s_add_u32 s96, s96, s85
    s_add_u32 s96, s96, 0x4000000
    v_mul_u32_u24 v19, 48, v1
    s_mov_b32 s98, 0xbdd2d3e8
    v_mov_b32 v20, 0xc0135761
    v_mov_b32 v8, 0
    s_nop 1
L_wait_20:
    buffer_load_dword v9, v8, s[48:51], 0 offen offset:20 sc1
    s_waitcnt vmcnt(0)
    v_readfirstlane_b32 s83, v9
    s_nop 0
    s_cmp_ge_u32 s83, 129
    s_nop 2
    s_cbranch_scc1 L_waitok_21
    s_sleep 6
    s_sub_u32 s81, s81, 1
    s_cbranch_scc1 L_main_done
    s_branch L_wait_20
L_waitok_21:
    v_lshlrev_b32 v16, 4, v1
    v_add_u32 v17, 49152, v16
    v_add_u32 v18, 98304, v16
    s_mul_i32 s92, s3, 6144
    s_lshl_b32 s94, s3, 1
    s_add_u32 s94, s94, s99
    s_mul_i32 s94, s94, 18432
    s_add_u32 s94, s94, 0x0
    s_mov_b32 s95, 0
    s_barrier
    s_add_u32 m0, s92, 0
    s_add_u32 s93, s94, 0
    buffer_load_dwordx4 v16, s[52:55], s93 offen offset:0 sc1 lds
    buffer_load_dwordx4 v16, s[52:55], s93 offen offset:1024 sc1 lds
    buffer_load_dwordx4 v16, s[52:55], s93 offen offset:2048 sc1 lds
    s_add_u32 m0, s92, 3072
    s_add_u32 s93, s94, 18432
    buffer_load_dwordx4 v16, s[52:55], s93 offen offset:0 sc1 lds
    buffer_load_dwordx4 v16, s[52:55], s93 offen offset:1024 sc1 lds
    buffer_load_dwordx4 v16, s[52:55], s93 offen offset:2048 sc1 lds
    s_add_u32 m0, s92, 24576
    s_add_u32 s93, s94, 3072
    buffer_load_dwordx4 v16, s[52:55], s93 offen offset:0 sc1 lds
    buffer_load_dwordx4 v16, s[52:55], s93 offen offset:1024 sc1 lds
    buffer_load_dwordx4 v16, s[52:55], s93 offen offset:2048 sc1 lds
    s_add_u32 m0, s92, 27648
    s_add_u32 s93, s94, 21504
    buffer_load_dwordx4 v16, s[52:55], s93 offen offset:0 sc1 lds
    buffer_load_dwordx4 v16, s[52:55], s93 offen offset:1024 sc1 lds
    buffer_load_dwordx4 v16, s[52:55], s93 offen offset:2048 sc1 lds
    s_add_u32 m0, s92, 49152
    s_add_u32 s93, s94, 6144
    buffer_load_dwordx4 v16, s[52:55], s93 offen offset:0 sc1 lds
    buffer_load_dwordx4 v16, s[52:55], s93 offen offset:1024 sc1 lds
    buffer_load_dwordx4 v16, s[52:55], s93 offen offset:2048 sc1 lds
    s_add_u32 m0, s92, 52224
    s_add_u32 s93, s94, 24576
    buffer_load_dwordx4 v16, s[52:55], s93 offen offset:0 sc1 lds
    buffer_load_dwordx4 v16, s[52:55], s93 offen offset:1024 sc1 lds
    buffer_load_dwordx4 v16, s[52:55], s93 offen offset:2048 sc1 lds
    s_add_u32 m0, s92, 73728
    s_add_u32 s93, s94, 9216
    buffer_load_dwordx4 v16, s[52:55], s93 offen offset:0 sc1 lds
    buffer_load_dwordx4 v16, s[52:55], s93 offen offset:1024 sc1 lds
    buffer_load_dwordx4 v16, s[52:55], s93 offen offset:2048 sc1 lds
    s_add_u32 m0, s92, 76800
    s_add_u32 s93, s94, 27648
    buffer_load_dwordx4 v16, s[52:55], s93 offen offset:0 sc1 lds
    buffer_load_dwordx4 v16, s[52:55], s93 offen offset:1024 sc1 lds
    buffer_load_dwordx4 v16, s[52:55], s93 offen offset:2048 sc1 lds
    s_add_u32 m0, s92, 98304
    s_add_u32 s93, s94, 12288
    buffer_load_dwordx4 v16, s[52:55], s93 offen offset:0 sc1 lds
    buffer_load_dwordx4 v16, s[52:55], s93 offen offset:1024 sc1 lds
    buffer_load_dwordx4 v16, s[52:55], s93 offen offset:2048 sc1 lds
    s_add_u32 m0, s92, 101376
    s_add_u32 s93, s94, 30720
    buffer_load_dwordx4 v16, s[52:55], s93 offen offset:0 sc1 lds
    buffer_load_dwordx4 v16, s[52:55], s93 offen offset:1024 sc1 lds
    buffer_load_dwordx4 v16, s[52:55], s93 offen offset:2048 sc1 lds
    s_add_u32 m0, s92, 122880
    s_add_u32 s93, s94, 15360
    buffer_load_dwordx4 v16, s[52:55], s93 offen offset:0 sc1 lds
    buffer_load_dwordx4 v16, s[52:55], s93 offen offset:1024 sc1 lds
    buffer_load_dwordx4 v16, s[52:55], s93 offen offset:2048 sc1 lds
    s_add_u32 m0, s92, 125952
    s_add_u32 s93, s94, 33792
    buffer_load_dwordx4 v16, s[52:55], s93 offen offset:0 sc1 lds
    buffer_load_dwordx4 v16, s[52:55], s93 offen offset:1024 sc1 lds
    buffer_load_dwordx4 v16, s[52:55], s93 offen offset:2048 sc1 lds
    s_add_u32 s94, s94, 294912
    s_waitcnt vmcnt(30)
    s_barrier
    ds_read_b128 v[96:99], v16 offset:0
    ds_read_b128 v[100:103], v16 offset:3072
    ds_read_b128 v[104:107], v16 offset:6144
    ds_read_b128 v[108:111], v16 offset:9216
    ds_read_b128 v[112:115], v16 offset:12288
    ds_read_b128 v[116:119], v16 offset:15360
    ds_read_b128 v[120:123], v16 offset:18432
    ds_read_b128 v[124:127], v16 offset:21504
    s_waitcnt lgkmcnt(0)
L_g1_glum:
    v_mfma_f32_16x16x32_bf16 v[160:163], a[0:3], v[96:99], 0
    ds_read_b128 v[128:131], v16 offset:1024
    v_mfma_f32_16x16x32_bf16 v[164:167], a[4:7], v[96:99], 0
    v_mfma_f32_16x16x32_bf16 v[168:171], a[8:11], v[96:99], 0
    ds_read_b128 v[132:135], v16 offset:4096
    v_mfma_f32_16x16x32_bf16 v[172:175], a[0:3], v[100:103], 0
    v_mfma_f32_16x16x32_bf16 v[176:179], a[4:7], v[100:103], 0
    ds_read_b128 v[136:139], v16 offset:7168
    v_mfma_f32_16x16x32_bf16 v[180:183], a[8:11], v[100:103], 0
    v_mfma_f32_16x16x32_bf16 v[184:187], a[0:3], v[104:107], 0
    ds_read_b128 v[140:143], v16 offset:10240
    v_mfma_f32_16x16x32_bf16 v[188:191], a[4:7], v[104:107], 0
    v_mfma_f32_16x16x32_bf16 v[192:195], a[8:11], v[104:107], 0
    ds_read_b128 v[144:147], v16 offset:13312
    v_mfma_f32_16x16x32_bf16 v[196:199], a[0:3], v[108:111], 0
    v_mfma_f32_16x16x32_bf16 v[200:203], a[4:7], v[108:111], 0
    ds_read_b128 v[148:151], v16 offset:16384
    v_mfma_f32_16x16x32_bf16 v[204:207], a[8:11], v[108:111], 0
    v_mfma_f32_16x16x32_bf16 v[208:211], a[0:3], v[112:115], 0
    ds_read_b128 v[152:155], v16 offset:19456
    v_mfma_f32_16x16x32_bf16 v[212:215], a[4:7], v[112:115], 0
    v_mfma_f32_16x16x32_bf16 v[216:219], a[8:11], v[112:115], 0
    ds_read_b128 v[156:159], v16 offset:22528
    v_mfma_f32_16x16x32_bf16 v[220:223], a[0:3], v[116:119], 0
    v_mfma_f32_16x16x32_bf16 v[224:227], a[4:7], v[116:119], 0
    v_mfma_f32_16x16x32_bf16 v[228:231], a[8:11], v[116:119], 0
    v_mfma_f32_16x16x32_bf16 v[232:235], a[0:3], v[120:123], 0
    v_mfma_f32_16x16x32_bf16 v[236:239], a[4:7], v[120:123], 0
    v_mfma_f32_16x16x32_bf16 v[240:243], a[8:11], v[120:123], 0
    v_mfma_f32_16x16x32_bf16 v[244:247], a[0:3], v[124:127], 0
    v_mfma_f32_16x16x32_bf16 v[248:251], a[4:7], v[124:127], 0
    v_mfma_f32_16x16x32_bf16 v[252:255], a[8:11], v[124:127], 0
    s_waitcnt lgkmcnt(7)
    v_mfma_f32_16x16x32_bf16 v[160:163], a[12:15], v[128:131], v[160:163]
    ds_read_b128 v[96:99], v16 offset:2048
    v_mfma_f32_16x16x32_bf16 v[164:167], a[16:19], v[128:131], v[164:167]
    v_mfma_f32_16x16x32_bf16 v[168:171], a[20:23], v[128:131], v[168:171]
    ds_read_b128 v[100:103], v16 offset:5120
    s_waitcnt lgkmcnt(8)
    v_mfma_f32_16x16x32_bf16 v[172:175], a[12:15], v[132:135], v[172:175]
    v_mfma_f32_16x16x32_bf16 v[176:179], a[16:19], v[132:135], v[176:179]
    ds_read_b128 v[104:107], v16 offset:8192
    v_mfma_f32_16x16x32_bf16 v[180:183], a[20:23], v[132:135], v[180:183]
    s_waitcnt lgkmcnt(8)
    v_mfma_f32_16x16x32_bf16 v[184:187], a[12:15], v[136:139], v[184:187]
    ds_read_b128 v[108:111], v16 offset:11264
    v_mfma_f32_16x16x32_bf16 v[188:191], a[16:19], v[136:139], v[188:191]
    v_mfma_f32_16x16x32_bf16 v[192:195], a[20:23], v[136:139], v[192:195]
    ds_read_b128 v[112:115], v16 offset:14336
    s_waitcnt lgkmcnt(9)
    v_mfma_f32_16x16x32_bf16 v[196:199], a[12:15], v[140:143], v[196:199]
    v_mfma_f32_16x16x32_bf16 v[200:203], a[16:19], v[140:143], v[200:203]
    ds_read_b128 v[116:119], v16 offset:17408
    v_mfma_f32_16x16x32_bf16 v[204:207], a[20:23], v[140:143], v[204:207]
    s_waitcnt lgkmcnt(9)
    v_mfma_f32_16x16x32_bf16 v[208:211], a[12:15], v[144:147], v[208:211]
    ds_read_b128 v[120:123], v16 offset:20480
    v_mfma_f32_16x16x32_bf16 v[212:215], a[16:19], v[144:147], v[212:215]
    v_mfma_f32_16x16x32_bf16 v[216:219], a[20:23], v[144:147], v[216:219]
    ds_read_b128 v[124:127], v16 offset:23552
    s_waitcnt lgkmcnt(10)
    v_mfma_f32_16x16x32_bf16 v[220:223], a[12:15], v[148:151], v[220:223]
    v_mfma_f32_16x16x32_bf16 v[224:227], a[16:19], v[148:151], v[224:227]
    v_mfma_f32_16x16x32_bf16 v[228:231], a[20:23], v[148:151], v[228:231]
    s_waitcnt lgkmcnt(9)
    v_mfma_f32_16x16x32_bf16 v[232:235], a[12:15], v[152:155], v[232:235]
    v_mfma_f32_16x16x32_bf16 v[236:239], a[16:19], v[152:155], v[236:239]
    v_mfma_f32_16x16x32_bf16 v[240:243], a[20:23], v[152:155], v[240:243]
    s_waitcnt lgkmcnt(8)
    v_mfma_f32_16x16x32_bf16 v[244:247], a[12:15], v[156:159], v[244:247]
    v_mfma_f32_16x16x32_bf16 v[248:251], a[16:19], v[156:159], v[248:251]
    v_mfma_f32_16x16x32_bf16 v[252:255], a[20:23], v[156:159], v[252:255]
    s_waitcnt lgkmcnt(0)
    s_waitcnt vmcnt(24)
    s_cmp_lg_u32 s95, 1
    s_cbranch_scc1 L_g1_glum_e
    s_waitcnt vmcnt(0)
L_g1_glum_e:
    s_barrier
    v_mfma_f32_16x16x32_bf16 v[160:163], a[24:27], v[96:99], v[160:163]
    s_cmp_lg_u32 s95, 1
    s_cbranch_scc1 L_sg_22
    s_lshl_b32 s83, s95, 8
    s_and_b32 s82, s5, 1
    s_lshl_b32 s82, s82, 7
    s_add_u32 s83, s83, s82
    s_mul_i32 s82, s100, 43
    s_lshr_b32 s82, s82, 9
    s_lshl_b32 s82, s82, 5
    s_add_u32 s83, s83, s82
    s_add_u32 s83, s83, 0x82fff00
    v_mov_b32 v21, 0
    v_mov_b32 v22, 1
    s_cmp_lg_u32 s3, 0
    s_cbranch_scc1 L_sig_23
    s_mov_b64 exec, 1
    buffer_atomic_add v22, v21, s[52:55], s83 offen offset:0
    s_mov_b64 exec, -1
L_sig_23:
L_sg_22:
    v_mfma_f32_16x16x32_bf16 v[164:167], a[28:31], v[96:99], v[164:167]
    v_mfma_f32_16x16x32_bf16 v[168:171], a[32:35], v[96:99], v[168:171]
    s_add_u32 m0, s92, 0
    s_add_u32 s93, s94, 0
    buffer_load_dwordx4 v16, s[52:55], s93 offen offset:0 sc1 lds
    buffer_load_dwordx4 v16, s[52:55], s93 offen offset:1024 sc1 lds
    buffer_load_dwordx4 v16, s[52:55], s93 offen offset:2048 sc1 lds
    s_add_u32 m0, s92, 3072
    s_add_u32 s93, s94, 18432
    buffer_load_dwordx4 v16, s[52:55], s93 offen offset:0 sc1 lds
    buffer_load_dwordx4 v16, s[52:55], s93 offen offset:1024 sc1 lds
    buffer_load_dwordx4 v16, s[52:55], s93 offen offset:2048 sc1 lds
    v_mfma_f32_16x16x32_bf16 v[172:175], a[24:27], v[100:103], v[172:175]
    v_mfma_f32_16x16x32_bf16 v[176:179], a[28:31], v[100:103], v[176:179]
    ds_read_b128 v[128:131], v16 offset:24576
    v_mfma_f32_16x16x32_bf16 v[180:183], a[32:35], v[100:103], v[180:183]
    v_mfma_f32_16x16x32_bf16 v[184:187], a[24:27], v[104:107], v[184:187]
    ds_read_b128 v[132:135], v16 offset:27648
    v_mfma_f32_16x16x32_bf16 v[188:191], a[28:31], v[104:107], v[188:191]
    v_mfma_f32_16x16x32_bf16 v[192:195], a[32:35], v[104:107], v[192:195]
    ds_read_b128 v[136:139], v16 offset:30720
    v_mfma_f32_16x16x32_bf16 v[196:199], a[24:27], v[108:111], v[196:199]
    v_mfma_f32_16x16x32_bf16 v[200:203], a[28:31], v[108:111], v[200:203]
    ds_read_b128 v[140:143], v16 offset:33792
    v_mfma_f32_16x16x32_bf16 v[204:207], a[32:35], v[108:111], v[204:207]
    v_mfma_f32_16x16x32_bf16 v[208:211], a[24:27], v[112:115], v[208:211]
    ds_read_b128 v[144:147], v16 offset:36864
    v_mfma_f32_16x16x32_bf16 v[212:215], a[28:31], v[112:115], v[212:215]
    v_mfma_f32_16x16x32_bf16 v[216:219], a[32:35], v[112:115], v[216:219]
    ds_read_b128 v[148:151], v16 offset:39936
    v_mfma_f32_16x16x32_bf16 v[220:223], a[24:27], v[116:119], v[220:223]
    v_mfma_f32_16x16x32_bf16 v[224:227], a[28:31], v[116:119], v[224:227]
    ds_read_b128 v[152:155], v16 offset:43008
    v_mfma_f32_16x16x32_bf16 v[228:231], a[32:35], v[116:119], v[228:231]
    v_mfma_f32_16x16x32_bf16 v[232:235], a[24:27], v[120:123], v[232:235]
    ds_read_b128 v[156:159], v16 offset:46080
    v_mfma_f32_16x16x32_bf16 v[236:239], a[28:31], v[120:123], v[236:239]
    v_mfma_f32_16x16x32_bf16 v[240:243], a[32:35], v[120:123], v[240:243]
    v_mfma_f32_16x16x32_bf16 v[244:247], a[24:27], v[124:127], v[244:247]
    v_mfma_f32_16x16x32_bf16 v[248:251], a[28:31], v[124:127], v[248:251]
    v_mfma_f32_16x16x32_bf16 v[252:255], a[32:35], v[124:127], v[252:255]
    s_waitcnt lgkmcnt(7)
    v_mfma_f32_16x16x32_bf16 v[160:163], a[36:39], v[128:131], v[160:163]
    ds_read_b128 v[96:99], v16 offset:25600
    v_mfma_f32_16x16x32_bf16 v[164:167], a[40:43], v[128:131], v[164:167]
    v_mfma_f32_16x16x32_bf16 v[168:171], a[44:47], v[128:131], v[168:171]
    ds_read_b128 v[100:103], v16 offset:28672
    s_waitcnt lgkmcnt(8)
    v_mfma_f32_16x16x32_bf16 v[172:175], a[36:39], v[132:135], v[172:175]
    v_mfma_f32_16x16x32_bf16 v[176:179], a[40:43], v[132:135], v[176:179]
    ds_read_b128 v[104:107], v16 offset:31744
    v_mfma_f32_16x16x32_bf16 v[180:183], a[44:47], v[132:135], v[180:183]
    s_waitcnt lgkmcnt(8)
    v_mfma_f32_16x16x32_bf16 v[184:187], a[36:39], v[136:139], v[184:187]
    ds_read_b128 v[108:111], v16 offset:34816
    v_mfma_f32_16x16x32_bf16 v[188:191], a[40:43], v[136:139], v[188:191]
    v_mfma_f32_16x16x32_bf16 v[192:195], a[44:47], v[136:139], v[192:195]
    ds_read_b128 v[112:115], v16 offset:37888
    s_waitcnt lgkmcnt(9)
    v_mfma_f32_16x16x32_bf16 v[196:199], a[36:39], v[140:143], v[196:199]
    v_mfma_f32_16x16x32_bf16 v[200:203], a[40:43], v[140:143], v[200:203]
    ds_read_b128 v[116:119], v16 offset:40960
    v_mfma_f32_16x16x32_bf16 v[204:207], a[44:47], v[140:143], v[204:207]
    s_waitcnt lgkmcnt(9)
    v_mfma_f32_16x16x32_bf16 v[208:211], a[36:39], v[144:147], v[208:211]
    ds_read_b128 v[120:123], v16 offset:44032
    v_mfma_f32_16x16x32_bf16 v[212:215], a[40:43], v[144:147], v[212:215]
    v_mfma_f32_16x16x32_bf16 v[216:219], a[44:47], v[144:147], v[216:219]
    ds_read_b128 v[124:127], v16 offset:47104
    s_waitcnt lgkmcnt(10)
    v_mfma_f32_16x16x32_bf16 v[220:223], a[36:39], v[148:151], v[220:223]
    v_mfma_f32_16x16x32_bf16 v[224:227], a[40:43], v[148:151], v[224:227]
    v_mfma_f32_16x16x32_bf16 v[228:231], a[44:47], v[148:151], v[228:231]
    s_waitcnt lgkmcnt(9)
    v_mfma_f32_16x16x32_bf16 v[232:235], a[36:39], v[152:155], v[232:235]
    v_mfma_f32_16x16x32_bf16 v[236:239], a[40:43], v[152:155], v[236:239]
    v_mfma_f32_16x16x32_bf16 v[240:243], a[44:47], v[152:155], v[240:243]
    s_waitcnt lgkmcnt(8)
    v_mfma_f32_16x16x32_bf16 v[244:247], a[36:39], v[156:159], v[244:247]
    v_mfma_f32_16x16x32_bf16 v[248:251], a[40:43], v[156:159], v[248:251]
    v_mfma_f32_16x16x32_bf16 v[252:255], a[44:47], v[156:159], v[252:255]
    s_waitcnt lgkmcnt(7)
    v_mfma_f32_16x16x32_bf16 v[160:163], a[48:51], v[96:99], v[160:163]
    ds_read_b128 v[128:131], v16 offset:26624
    v_mfma_f32_16x16x32_bf16 v[164:167], a[52:55], v[96:99], v[164:167]
    v_mfma_f32_16x16x32_bf16 v[168:171], a[56:59], v[96:99], v[168:171]
    ds_read_b128 v[132:135], v16 offset:29696
    s_waitcnt lgkmcnt(8)
    v_mfma_f32_16x16x32_bf16 v[172:175], a[48:51], v[100:103], v[172:175]
    v_mfma_f32_16x16x32_bf16 v[176:179], a[52:55], v[100:103], v[176:179]
    ds_read_b128 v[136:139], v16 offset:32768
    v_mfma_f32_16x16x32_bf16 v[180:183], a[56:59], v[100:103], v[180:183]
    s_waitcnt lgkmcnt(8)
    v_mfma_f32_16x16x32_bf16 v[184:187], a[48:51], v[104:107], v[184:187]
    ds_read_b128 v[140:143], v16 offset:35840
    v_mfma_f32_16x16x32_bf16 v[188:191], a[52:55], v[104:107], v[188:191]
    v_mfma_f32_16x16x32_bf16 v[192:195], a[56:59], v[104:107], v[192:195]
    ds_read_b128 v[144:147], v16 offset:38912
    s_waitcnt lgkmcnt(9)
    v_mfma_f32_16x16x32_bf16 v[196:199], a[48:51], v[108:111], v[196:199]
    v_mfma_f32_16x16x32_bf16 v[200:203], a[52:55], v[108:111], v[200:203]
    ds_read_b128 v[148:151], v16 offset:41984
    v_mfma_f32_16x16x32_bf16 v[204:207], a[56:59], v[108:111], v[204:207]
    s_waitcnt lgkmcnt(9)
    v_mfma_f32_16x16x32_bf16 v[208:211], a[48:51], v[112:115], v[208:211]
    ds_read_b128 v[152:155], v16 offset:45056
    v_mfma_f32_16x16x32_bf16 v[212:215], a[52:55], v[112:115], v[212:215]
    v_mfma_f32_16x16x32_bf16 v[216:219], a[56:59], v[112:115], v[216:219]
    ds_read_b128 v[156:159], v16 offset:48128
    s_waitcnt lgkmcnt(10)
    v_mfma_f32_16x16x32_bf16 v[220:223], a[48:51], v[116:119], v[220:223]
    v_mfma_f32_16x16x32_bf16 v[224:227], a[52:55], v[116:119], v[224:227]
    v_mfma_f32_16x16x32_bf16 v[228:231], a[56:59], v[116:119], v[228:231]
    s_waitcnt lgkmcnt(9)
    v_mfma_f32_16x16x32_bf16 v[232:235], a[48:51], v[120:123], v[232:235]
    v_mfma_f32_16x16x32_bf16 v[236:239], a[52:55], v[120:123], v[236:239]
    v_mfma_f32_16x16x32_bf16 v[240:243], a[56:59], v[120:123], v[240:243]
    s_waitcnt lgkmcnt(8)
    v_mfma_f32_16x16x32_bf16 v[244:247], a[48:51], v[124:127], v[244:247]
    v_mfma_f32_16x16x32_bf16 v[248:251], a[52:55], v[124:127], v[248:251]
    v_mfma_f32_16x16x32_bf16 v[252:255], a[56:59], v[124:127], v[252:255]
    s_waitcnt lgkmcnt(0)
    s_waitcnt vmcnt(6)
    s_barrier
    v_mfma_f32_16x16x32_bf16 v[160:163], a[60:63], v[128:131], v[160:163]
    s_cmp_lt_u32 s95, 2
    s_cbranch_scc1 L_sg_24
    s_lshl_b32 s83, s95, 8
    s_and_b32 s82, s5, 1
    s_lshl_b32 s82, s82, 7
    s_add_u32 s83, s83, s82
    s_mul_i32 s82, s100, 43
    s_lshr_b32 s82, s82, 9
    s_lshl_b32 s82, s82, 5
    s_add_u32 s83, s83, s82
    s_add_u32 s83, s83, 0x82fff00
    v_mov_b32 v21, 0
    v_mov_b32 v22, 1
    s_cmp_lg_u32 s3, 0
    s_cbranch_scc1 L_sig_25
    s_mov_b64 exec, 1
    buffer_atomic_add v22, v21, s[52:55], s83 offen offset:0
    s_mov_b64 exec, -1
L_sig_25:
L_sg_24:
    v_mfma_f32_16x16x32_bf16 v[164:167], a[64:67], v[128:131], v[164:167]
    v_mfma_f32_16x16x32_bf16 v[168:171], a[68:71], v[128:131], v[168:171]
    s_add_u32 m0, s92, 24576
    s_add_u32 s93, s94, 3072
    buffer_load_dwordx4 v16, s[52:55], s93 offen offset:0 sc1 lds
    buffer_load_dwordx4 v16, s[52:55], s93 offen offset:1024 sc1 lds
    buffer_load_dwordx4 v16, s[52:55], s93 offen offset:2048 sc1 lds
    s_add_u32 m0, s92, 27648
    s_add_u32 s93, s94, 21504
    buffer_load_dwordx4 v16, s[52:55], s93 offen offset:0 sc1 lds
    buffer_load_dwordx4 v16, s[52:55], s93 offen offset:1024 sc1 lds
    buffer_load_dwordx4 v16, s[52:55], s93 offen offset:2048 sc1 lds
    v_mfma_f32_16x16x32_bf16 v[172:175], a[60:63], v[132:135], v[172:175]
    v_mfma_f32_16x16x32_bf16 v[176:179], a[64:67], v[132:135], v[176:179]
    ds_read_b128 v[96:99], v17 offset:0
    v_mfma_f32_16x16x32_bf16 v[180:183], a[68:71], v[132:135], v[180:183]
    v_mfma_f32_16x16x32_bf16 v[184:187], a[60:63], v[136:139], v[184:187]
    ds_read_b128 v[100:103], v17 offset:3072
    v_mfma_f32_16x16x32_bf16 v[188:191], a[64:67], v[136:139], v[188:191]
    v_mfma_f32_16x16x32_bf16 v[192:195], a[68:71], v[136:139], v[192:195]
    ds_read_b128 v[104:107], v17 offset:6144
    v_mfma_f32_16x16x32_bf16 v[196:199], a[60:63], v[140:143], v[196:199]
    v_mfma_f32_16x16x32_bf16 v[200:203], a[64:67], v[140:143], v[200:203]
    ds_read_b128 v[108:111], v17 offset:9216
    v_mfma_f32_16x16x32_bf16 v[204:207], a[68:71], v[140:143], v[204:207]
    v_mfma_f32_16x16x32_bf16 v[208:211], a[60:63], v[144:147], v[208:211]
    ds_read_b128 v[112:115], v17 offset:12288
    v_mfma_f32_16x16x32_bf16 v[212:215], a[64:67], v[144:147], v[212:215]
    v_mfma_f32_16x16x32_bf16 v[216:219], a[68:71], v[144:147], v[216:219]
    ds_read_b128 v[116:119], v17 offset:15360
    v_mfma_f32_16x16x32_bf16 v[220:223], a[60:63], v[148:151], v[220:223]
    v_mfma_f32_16x16x32_bf16 v[224:227], a[64:67], v[148:151], v[224:227]
    ds_read_b128 v[120:123], v17 offset:18432
    v_mfma_f32_16x16x32_bf16 v[228:231], a[68:71], v[148:151], v[228:231]
    v_mfma_f32_16x16x32_bf16 v[232:235], a[60:63], v[152:155], v[232:235]
    ds_read_b128 v[124:127], v17 offset:21504
    v_mfma_f32_16x16x32_bf16 v[236:239], a[64:67], v[152:155], v[236:239]
    v_mfma_f32_16x16x32_bf16 v[240:243], a[68:71], v[152:155], v[240:243]
    v_mfma_f32_16x16x32_bf16 v[244:247], a[60:63], v[156:159], v[244:247]
    v_mfma_f32_16x16x32_bf16 v[248:251], a[64:67], v[156:159], v[248:251]
    v_mfma_f32_16x16x32_bf16 v[252:255], a[68:71], v[156:159], v[252:255]
    s_waitcnt lgkmcnt(7)
    v_mfma_f32_16x16x32_bf16 v[160:163], a[72:75], v[96:99], v[160:163]
    ds_read_b128 v[128:131], v17 offset:1024
    v_mfma_f32_16x16x32_bf16 v[164:167], a[76:79], v[96:99], v[164:167]
    v_mfma_f32_16x16x32_bf16 v[168:171], a[80:83], v[96:99], v[168:171]
    ds_read_b128 v[132:135], v17 offset:4096
    s_waitcnt lgkmcnt(8)
    v_mfma_f32_16x16x32_bf16 v[172:175], a[72:75], v[100:103], v[172:175]
    v_mfma_f32_16x16x32_bf16 v[176:179], a[76:79], v[100:103], v[176:179]
    ds_read_b128 v[136:139], v17 offset:7168
    v_mfma_f32_16x16x32_bf16 v[180:183], a[80:83], v[100:103], v[180:183]
    s_waitcnt lgkmcnt(8)
    v_mfma_f32_16x16x32_bf16 v[184:187], a[72:75], v[104:107], v[184:187]
    ds_read_b128 v[140:143], v17 offset:10240
    v_mfma_f32_16x16x32_bf16 v[188:191], a[76:79], v[104:107], v[188:191]
    v_mfma_f32_16x16x32_bf16 v[192:195], a[80:83], v[104:107], v[192:195]
    ds_read_b128 v[144:147], v17 offset:13312
    s_waitcnt lgkmcnt(9)
    v_mfma_f32_16x16x32_bf16 v[196:199], a[72:75], v[108:111], v[196:199]
    v_mfma_f32_16x16x32_bf16 v[200:203], a[76:79], v[108:111], v[200:203]
    ds_read_b128 v[148:151], v17 offset:16384
    v_mfma_f32_16x16x32_bf16 v[204:207], a[80:83], v[108:111], v[204:207]
    s_waitcnt lgkmcnt(9)
    v_mfma_f32_16x16x32_bf16 v[208:211], a[72:75], v[112:115], v[208:211]
    ds_read_b128 v[152:155], v17 offset:19456
    v_mfma_f32_16x16x32_bf16 v[212:215], a[76:79], v[112:115], v[212:215]
    v_mfma_f32_16x16x32_bf16 v[216:219], a[80:83], v[112:115], v[216:219]
    ds_read_b128 v[156:159], v17 offset:22528
    s_waitcnt lgkmcnt(10)
    v_mfma_f32_16x16x32_bf16 v[220:223], a[72:75], v[116:119], v[220:223]
    v_mfma_f32_16x16x32_bf16 v[224:227], a[76:79], v[116:119], v[224:227]
    v_mfma_f32_16x16x32_bf16 v[228:231], a[80:83], v[116:119], v[228:231]
    s_waitcnt lgkmcnt(9)
    v_mfma_f32_16x16x32_bf16 v[232:235], a[72:75], v[120:123], v[232:235]
    v_mfma_f32_16x16x32_bf16 v[236:239], a[76:79], v[120:123], v[236:239]
    v_mfma_f32_16x16x32_bf16 v[240:243], a[80:83], v[120:123], v[240:243]
    s_waitcnt lgkmcnt(8)
    v_mfma_f32_16x16x32_bf16 v[244:247], a[72:75], v[124:127], v[244:247]
    v_mfma_f32_16x16x32_bf16 v[248:251], a[76:79], v[124:127], v[248:251]
    v_mfma_f32_16x16x32_bf16 v[252:255], a[80:83], v[124:127], v[252:255]
    s_waitcnt lgkmcnt(7)
    v_mfma_f32_16x16x32_bf16 v[160:163], a[84:87], v[128:131], v[160:163]
    ds_read_b128 v[96:99], v17 offset:2048
    v_mfma_f32_16x16x32_bf16 v[164:167], a[88:91], v[128:131], v[164:167]
    v_mfma_f32_16x16x32_bf16 v[168:171], a[92:95], v[128:131], v[168:171]
    ds_read_b128 v[100:103], v17 offset:5120
    s_waitcnt lgkmcnt(8)
    v_mfma_f32_16x16x32_bf16 v[172:175], a[84:87], v[132:135], v[172:175]
    v_mfma_f32_16x16x32_bf16 v[176:179], a[88:91], v[132:135], v[176:179]
    ds_read_b128 v[104:107], v17 offset:8192
    v_mfma_f32_16x16x32_bf16 v[180:183], a[92:95], v[132:135], v[180:183]
    s_waitcnt lgkmcnt(8)
    v_mfma_f32_16x16x32_bf16 v[184:187], a[84:87], v[136:139], v[184:187]
    ds_read_b128 v[108:111], v17 offset:11264
    v_mfma_f32_16x16x32_bf16 v[188:191], a[88:91], v[136:139], v[188:191]
    v_mfma_f32_16x16x32_bf16 v[192:195], a[92:95], v[136:139], v[192:195]
    ds_read_b128 v[112:115], v17 offset:14336
    s_waitcnt lgkmcnt(9)
    v_mfma_f32_16x16x32_bf16 v[196:199], a[84:87], v[140:143], v[196:199]
    v_mfma_f32_16x16x32_bf16 v[200:203], a[88:91], v[140:143], v[200:203]
    ds_read_b128 v[116:119], v17 offset:17408
    v_mfma_f32_16x16x32_bf16 v[204:207], a[92:95], v[140:143], v[204:207]
    s_waitcnt lgkmcnt(9)
    v_mfma_f32_16x16x32_bf16 v[208:211], a[84:87], v[144:147], v[208:211]
    ds_read_b128 v[120:123], v17 offset:20480
    v_mfma_f32_16x16x32_bf16 v[212:215], a[88:91], v[144:147], v[212:215]
    v_mfma_f32_16x16x32_bf16 v[216:219], a[92:95], v[144:147], v[216:219]
    ds_read_b128 v[124:127], v17 offset:23552
    s_waitcnt lgkmcnt(10)
    v_mfma_f32_16x16x32_bf16 v[220:223], a[84:87], v[148:151], v[220:223]
    v_mfma_f32_16x16x32_bf16 v[224:227], a[88:91], v[148:151], v[224:227]
    v_mfma_f32_16x16x32_bf16 v[228:231], a[92:95], v[148:151], v[228:231]
    s_waitcnt lgkmcnt(9)
    v_mfma_f32_16x16x32_bf16 v[232:235], a[84:87], v[152:155], v[232:235]
    v_mfma_f32_16x16x32_bf16 v[236:239], a[88:91], v[152:155], v[236:239]
    v_mfma_f32_16x16x32_bf16 v[240:243], a[92:95], v[152:155], v[240:243]
    s_waitcnt lgkmcnt(8)
    v_mfma_f32_16x16x32_bf16 v[244:247], a[84:87], v[156:159], v[244:247]
    v_mfma_f32_16x16x32_bf16 v[248:251], a[88:91], v[156:159], v[248:251]
    v_mfma_f32_16x16x32_bf16 v[252:255], a[92:95], v[156:159], v[252:255]
    s_waitcnt lgkmcnt(0)
    s_waitcnt vmcnt(24)
    s_barrier
    v_mfma_f32_16x16x32_bf16 v[160:163], a[96:99], v[96:99], v[160:163]
    s_add_u32 m0, s92, 49152
    s_add_u32 s93, s94, 6144
    buffer_load_dwordx4 v16, s[52:55], s93 offen offset:0 sc1 lds
    buffer_load_dwordx4 v16, s[52:55], s93 offen offset:1024 sc1 lds
    buffer_load_dwordx4 v16, s[52:55], s93 offen offset:2048 sc1 lds
    s_add_u32 m0, s92, 52224
    s_add_u32 s93, s94, 24576
    buffer_load_dwordx4 v16, s[52:55], s93 offen offset:0 sc1 lds
    buffer_load_dwordx4 v16, s[52:55], s93 offen offset:1024 sc1 lds
    buffer_load_dwordx4 v16, s[52:55], s93 offen offset:2048 sc1 lds
    v_mfma_f32_16x16x32_bf16 v[164:167], a[100:103], v[96:99], v[164:167]
    v_mfma_f32_16x16x32_bf16 v[168:171], a[104:107], v[96:99], v[168:171]
    ds_read_b128 v[128:131], v17 offset:24576
    v_mfma_f32_16x16x32_bf16 v[172:175], a[96:99], v[100:103], v[172:175]
    v_mfma_f32_16x16x32_bf16 v[176:179], a[100:103], v[100:103], v[176:179]
    ds_read_b128 v[132:135], v17 offset:27648
    v_mfma_f32_16x16x32_bf16 v[180:183], a[104:107], v[100:103], v[180:183]
    v_mfma_f32_16x16x32_bf16 v[184:187], a[96:99], v[104:107], v[184:187]
    ds_read_b128 v[136:139], v17 offset:30720
    v_mfma_f32_16x16x32_bf16 v[188:191], a[100:103], v[104:107], v[188:191]
    v_mfma_f32_16x16x32_bf16 v[192:195], a[104:107], v[104:107], v[192:195]
    ds_read_b128 v[140:143], v17 offset:33792
    v_mfma_f32_16x16x32_bf16 v[196:199], a[96:99], v[108:111], v[196:199]
    v_mfma_f32_16x16x32_bf16 v[200:203], a[100:103], v[108:111], v[200:203]
    ds_read_b128 v[144:147], v17 offset:36864
    v_mfma_f32_16x16x32_bf16 v[204:207], a[104:107], v[108:111], v[204:207]
    v_mfma_f32_16x16x32_bf16 v[208:211], a[96:99], v[112:115], v[208:211]
    ds_read_b128 v[148:151], v17 offset:39936
    v_mfma_f32_16x16x32_bf16 v[212:215], a[100:103], v[112:115], v[212:215]
    v_mfma_f32_16x16x32_bf16 v[216:219], a[104:107], v[112:115], v[216:219]
    ds_read_b128 v[152:155], v17 offset:43008
    v_mfma_f32_16x16x32_bf16 v[220:223], a[96:99], v[116:119], v[220:223]
    v_mfma_f32_16x16x32_bf16 v[224:227], a[100:103], v[116:119], v[224:227]
    ds_read_b128 v[156:159], v17 offset:46080
    v_mfma_f32_16x16x32_bf16 v[228:231], a[104:107], v[116:119], v[228:231]
    v_mfma_f32_16x16x32_bf16 v[232:235], a[96:99], v[120:123], v[232:235]
    v_mfma_f32_16x16x32_bf16 v[236:239], a[100:103], v[120:123], v[236:239]
    v_mfma_f32_16x16x32_bf16 v[240:243], a[104:107], v[120:123], v[240:243]
    v_mfma_f32_16x16x32_bf16 v[244:247], a[96:99], v[124:127], v[244:247]
    v_mfma_f32_16x16x32_bf16 v[248:251], a[100:103], v[124:127], v[248:251]
    v_mfma_f32_16x16x32_bf16 v[252:255], a[104:107], v[124:127], v[252:255]
    s_waitcnt lgkmcnt(7)
    v_mfma_f32_16x16x32_bf16 v[160:163], a[108:111], v[128:131], v[160:163]
    ds_read_b128 v[96:99], v17 offset:25600
    v_mfma_f32_16x16x32_bf16 v[164:167], a[112:115], v[128:131], v[164:167]
    v_mfma_f32_16x16x32_bf16 v[168:171], a[116:119], v[128:131], v[168:171]
    ds_read_b128 v[100:103], v17 offset:28672
    s_waitcnt lgkmcnt(8)
    v_mfma_f32_16x16x32_bf16 v[172:175], a[108:111], v[132:135], v[172:175]
    v_mfma_f32_16x16x32_bf16 v[176:179], a[112:115], v[132:135], v[176:179]
    ds_read_b128 v[104:107], v17 offset:31744
    v_mfma_f32_16x16x32_bf16 v[180:183], a[116:119], v[132:135], v[180:183]
    s_waitcnt lgkmcnt(8)
    v_mfma_f32_16x16x32_bf16 v[184:187], a[108:111], v[136:139], v[184:187]
    ds_read_b128 v[108:111], v17 offset:34816
    v_mfma_f32_16x16x32_bf16 v[188:191], a[112:115], v[136:139], v[188:191]
    v_mfma_f32_16x16x32_bf16 v[192:195], a[116:119], v[136:139], v[192:195]
    ds_read_b128 v[112:115], v17 offset:37888
    s_waitcnt lgkmcnt(9)
    v_mfma_f32_16x16x32_bf16 v[196:199], a[108:111], v[140:143], v[196:199]
    v_mfma_f32_16x16x32_bf16 v[200:203], a[112:115], v[140:143], v[200:203]
    ds_read_b128 v[116:119], v17 offset:40960
    v_mfma_f32_16x16x32_bf16 v[204:207], a[116:119], v[140:143], v[204:207]
    s_waitcnt lgkmcnt(9)
    v_mfma_f32_16x16x32_bf16 v[208:211], a[108:111], v[144:147], v[208:211]
    ds_read_b128 v[120:123], v17 offset:44032
    v_mfma_f32_16x16x32_bf16 v[212:215], a[112:115], v[144:147], v[212:215]
    v_mfma_f32_16x16x32_bf16 v[216:219], a[116:119], v[144:147], v[216:219]
    ds_read_b128 v[124:127], v17 offset:47104
    s_waitcnt lgkmcnt(10)
    v_mfma_f32_16x16x32_bf16 v[220:223], a[108:111], v[148:151], v[220:223]
    v_mfma_f32_16x16x32_bf16 v[224:227], a[112:115], v[148:151], v[224:227]
    v_mfma_f32_16x16x32_bf16 v[228:231], a[116:119], v[148:151], v[228:231]
    s_waitcnt lgkmcnt(9)
    v_mfma_f32_16x16x32_bf16 v[232:235], a[108:111], v[152:155], v[232:235]
    v_mfma_f32_16x16x32_bf16 v[236:239], a[112:115], v[152:155], v[236:239]
    v_mfma_f32_16x16x32_bf16 v[240:243], a[116:119], v[152:155], v[240:243]
    s_waitcnt lgkmcnt(8)
    v_mfma_f32_16x16x32_bf16 v[244:247], a[108:111], v[156:159], v[244:247]
    v_mfma_f32_16x16x32_bf16 v[248:251], a[112:115], v[156:159], v[248:251]
    v_mfma_f32_16x16x32_bf16 v[252:255], a[116:119], v[156:159], v[252:255]
    s_waitcnt lgkmcnt(7)
    v_mfma_f32_16x16x32_bf16 v[160:163], a[120:123], v[96:99], v[160:163]
    ds_read_b128 v[128:131], v17 offset:26624
    v_mfma_f32_16x16x32_bf16 v[164:167], a[124:127], v[96:99], v[164:167]
    v_mfma_f32_16x16x32_bf16 v[168:171], a[128:131], v[96:99], v[168:171]
    ds_read_b128 v[132:135], v17 offset:29696
    s_waitcnt lgkmcnt(8)
    v_mfma_f32_16x16x32_bf16 v[172:175], a[120:123], v[100:103], v[172:175]
    v_mfma_f32_16x16x32_bf16 v[176:179], a[124:127], v[100:103], v[176:179]
    ds_read_b128 v[136:139], v17 offset:32768
    v_mfma_f32_16x16x32_bf16 v[180:183], a[128:131], v[100:103], v[180:183]
    s_waitcnt lgkmcnt(8)
    v_mfma_f32_16x16x32_bf16 v[184:187], a[120:123], v[104:107], v[184:187]
    ds_read_b128 v[140:143], v17 offset:35840
    v_mfma_f32_16x16x32_bf16 v[188:191], a[124:127], v[104:107], v[188:191]
    v_mfma_f32_16x16x32_bf16 v[192:195], a[128:131], v[104:107], v[192:195]
    ds_read_b128 v[144:147], v17 offset:38912
    s_waitcnt lgkmcnt(9)
    v_mfma_f32_16x16x32_bf16 v[196:199], a[120:123], v[108:111], v[196:199]
    v_mfma_f32_16x16x32_bf16 v[200:203], a[124:127], v[108:111], v[200:203]
    ds_read_b128 v[148:151], v17 offset:41984
    v_mfma_f32_16x16x32_bf16 v[204:207], a[128:131], v[108:111], v[204:207]
    s_waitcnt lgkmcnt(9)
    v_mfma_f32_16x16x32_bf16 v[208:211], a[120:123], v[112:115], v[208:211]
    ds_read_b128 v[152:155], v17 offset:45056
    v_mfma_f32_16x16x32_bf16 v[212:215], a[124:127], v[112:115], v[212:215]
    v_mfma_f32_16x16x32_bf16 v[216:219], a[128:131], v[112:115], v[216:219]
    ds_read_b128 v[156:159], v17 offset:48128
    s_waitcnt lgkmcnt(10)
    v_mfma_f32_16x16x32_bf16 v[220:223], a[120:123], v[116:119], v[220:223]
    v_mfma_f32_16x16x32_bf16 v[224:227], a[124:127], v[116:119], v[224:227]
    v_mfma_f32_16x16x32_bf16 v[228:231], a[128:131], v[116:119], v[228:231]
    s_waitcnt lgkmcnt(9)
    v_mfma_f32_16x16x32_bf16 v[232:235], a[120:123], v[120:123], v[232:235]
    v_mfma_f32_16x16x32_bf16 v[236:239], a[124:127], v[120:123], v[236:239]
    v_mfma_f32_16x16x32_bf16 v[240:243], a[128:131], v[120:123], v[240:243]
    s_waitcnt lgkmcnt(8)
    v_mfma_f32_16x16x32_bf16 v[244:247], a[120:123], v[124:127], v[244:247]
    v_mfma_f32_16x16x32_bf16 v[248:251], a[124:127], v[124:127], v[248:251]
    v_mfma_f32_16x16x32_bf16 v[252:255], a[128:131], v[124:127], v[252:255]
    s_waitcnt lgkmcnt(0)
    s_waitcnt vmcnt(24)
    s_barrier
    v_mfma_f32_16x16x32_bf16 v[160:163], a[132:135], v[128:131], v[160:163]
    s_add_u32 m0, s92, 73728
    s_add_u32 s93, s94, 9216
    buffer_load_dwordx4 v16, s[52:55], s93 offen offset:0 sc1 lds
    buffer_load_dwordx4 v16, s[52:55], s93 offen offset:1024 sc1 lds
    buffer_load_dwordx4 v16, s[52:55], s93 offen offset:2048 sc1 lds
    s_add_u32 m0, s92, 76800
    s_add_u32 s93, s94, 27648
    buffer_load_dwordx4 v16, s[52:55], s93 offen offset:0 sc1 lds
    buffer_load_dwordx4 v16, s[52:55], s93 offen offset:1024 sc1 lds
    buffer_load_dwordx4 v16, s[52:55], s93 offen offset:2048 sc1 lds
    v_mfma_f32_16x16x32_bf16 v[164:167], a[136:139], v[128:131], v[164:167]
    v_mfma_f32_16x16x32_bf16 v[168:171], a[140:143], v[128:131], v[168:171]
    ds_read_b128 v[96:99], v18 offset:0
    v_mfma_f32_16x16x32_bf16 v[172:175], a[132:135], v[132:135], v[172:175]
    v_mfma_f32_16x16x32_bf16 v[176:179], a[136:139], v[132:135], v[176:179]
    ds_read_b128 v[100:103], v18 offset:3072
    v_mfma_f32_16x16x32_bf16 v[180:183], a[140:143], v[132:135], v[180:183]
    v_mfma_f32_16x16x32_bf16 v[184:187], a[132:135], v[136:139], v[184:187]
    ds_read_b128 v[104:107], v18 offset:6144
    v_mfma_f32_16x16x32_bf16 v[188:191], a[136:139], v[136:139], v[188:191]
    v_mfma_f32_16x16x32_bf16 v[192:195], a[140:143], v[136:139], v[192:195]
    ds_read_b128 v[108:111], v18 offset:9216
    v_mfma_f32_16x16x32_bf16 v[196:199], a[132:135], v[140:143], v[196:199]
    v_mfma_f32_16x16x32_bf16 v[200:203], a[136:139], v[140:143], v[200:203]
    ds_read_b128 v[112:115], v18 offset:12288
    v_mfma_f32_16x16x32_bf16 v[204:207], a[140:143], v[140:143], v[204:207]
    v_mfma_f32_16x16x32_bf16 v[208:211], a[132:135], v[144:147], v[208:211]
    ds_read_b128 v[116:119], v18 offset:15360
    v_mfma_f32_16x16x32_bf16 v[212:215], a[136:139], v[144:147], v[212:215]
    v_mfma_f32_16x16x32_bf16 v[216:219], a[140:143], v[144:147], v[216:219]
    ds_read_b128 v[120:123], v18 offset:18432
    v_mfma_f32_16x16x32_bf16 v[220:223], a[132:135], v[148:151], v[220:223]
    v_mfma_f32_16x16x32_bf16 v[224:227], a[136:139], v[148:151], v[224:227]
    ds_read_b128 v[124:127], v18 offset:21504
    v_mfma_f32_16x16x32_bf16 v[228:231], a[140:143], v[148:151], v[228:231]
    v_mfma_f32_16x16x32_bf16 v[232:235], a[132:135], v[152:155], v[232:235]
    v_mfma_f32_16x16x32_bf16 v[236:239], a[136:139], v[152:155], v[236:239]
    v_mfma_f32_16x16x32_bf16 v[240:243], a[140:143], v[152:155], v[240:243]
    v_mfma_f32_16x16x32_bf16 v[244:247], a[132:135], v[156:159], v[244:247]
    v_mfma_f32_16x16x32_bf16 v[248:251], a[136:139], v[156:159], v[248:251]
    v_mfma_f32_16x16x32_bf16 v[252:255], a[140:143], v[156:159], v[252:255]
    s_waitcnt lgkmcnt(7)
    v_mfma_f32_16x16x32_bf16 v[160:163], a[144:147], v[96:99], v[160:163]
    ds_read_b128 v[128:131], v18 offset:1024
    v_mfma_f32_16x16x32_bf16 v[164:167], a[148:151], v[96:99], v[164:167]
    v_mfma_f32_16x16x32_bf16 v[168:171], a[152:155], v[96:99], v[168:171]
    ds_read_b128 v[132:135], v18 offset:4096
    s_waitcnt lgkmcnt(8)
    v_mfma_f32_16x16x32_bf16 v[172:175], a[144:147], v[100:103], v[172:175]
    v_mfma_f32_16x16x32_bf16 v[176:179], a[148:151], v[100:103], v[176:179]
    ds_read_b128 v[136:139], v18 offset:7168
    v_mfma_f32_16x16x32_bf16 v[180:183], a[152:155], v[100:103], v[180:183]
    s_waitcnt lgkmcnt(8)
    v_mfma_f32_16x16x32_bf16 v[184:187], a[144:147], v[104:107], v[184:187]
    ds_read_b128 v[140:143], v18 offset:10240
    v_mfma_f32_16x16x32_bf16 v[188:191], a[148:151], v[104:107], v[188:191]
    v_mfma_f32_16x16x32_bf16 v[192:195], a[152:155], v[104:107], v[192:195]
    ds_read_b128 v[144:147], v18 offset:13312
    s_waitcnt lgkmcnt(9)
    v_mfma_f32_16x16x32_bf16 v[196:199], a[144:147], v[108:111], v[196:199]
    v_mfma_f32_16x16x32_bf16 v[200:203], a[148:151], v[108:111], v[200:203]
    ds_read_b128 v[148:151], v18 offset:16384
    v_mfma_f32_16x16x32_bf16 v[204:207], a[152:155], v[108:111], v[204:207]
    s_waitcnt lgkmcnt(9)
    v_mfma_f32_16x16x32_bf16 v[208:211], a[144:147], v[112:115], v[208:211]
    ds_read_b128 v[152:155], v18 offset:19456
    v_mfma_f32_16x16x32_bf16 v[212:215], a[148:151], v[112:115], v[212:215]
    v_mfma_f32_16x16x32_bf16 v[216:219], a[152:155], v[112:115], v[216:219]
    ds_read_b128 v[156:159], v18 offset:22528
    s_waitcnt lgkmcnt(10)
    v_mfma_f32_16x16x32_bf16 v[220:223], a[144:147], v[116:119], v[220:223]
    v_mfma_f32_16x16x32_bf16 v[224:227], a[148:151], v[116:119], v[224:227]
    v_mfma_f32_16x16x32_bf16 v[228:231], a[152:155], v[116:119], v[228:231]
    s_waitcnt lgkmcnt(9)
    v_mfma_f32_16x16x32_bf16 v[232:235], a[144:147], v[120:123], v[232:235]
    v_mfma_f32_16x16x32_bf16 v[236:239], a[148:151], v[120:123], v[236:239]
    v_mfma_f32_16x16x32_bf16 v[240:243], a[152:155], v[120:123], v[240:243]
    s_waitcnt lgkmcnt(8)
    v_mfma_f32_16x16x32_bf16 v[244:247], a[144:147], v[124:127], v[244:247]
    v_mfma_f32_16x16x32_bf16 v[248:251], a[148:151], v[124:127], v[248:251]
    v_mfma_f32_16x16x32_bf16 v[252:255], a[152:155], v[124:127], v[252:255]
    s_waitcnt lgkmcnt(7)
    v_mfma_f32_16x16x32_bf16 v[160:163], a[156:159], v[128:131], v[160:163]
    ds_read_b128 v[96:99], v18 offset:2048
    v_mfma_f32_16x16x32_bf16 v[164:167], a[160:163], v[128:131], v[164:167]
    v_mfma_f32_16x16x32_bf16 v[168:171], a[164:167], v[128:131], v[168:171]
    ds_read_b128 v[100:103], v18 offset:5120
    s_waitcnt lgkmcnt(8)
    v_mfma_f32_16x16x32_bf16 v[172:175], a[156:159], v[132:135], v[172:175]
    v_mfma_f32_16x16x32_bf16 v[176:179], a[160:163], v[132:135], v[176:179]
    ds_read_b128 v[104:107], v18 offset:8192
    v_mfma_f32_16x16x32_bf16 v[180:183], a[164:167], v[132:135], v[180:183]
    s_waitcnt lgkmcnt(8)
    v_mfma_f32_16x16x32_bf16 v[184:187], a[156:159], v[136:139], v[184:187]
    ds_read_b128 v[108:111], v18 offset:11264
    v_mfma_f32_16x16x32_bf16 v[188:191], a[160:163], v[136:139], v[188:191]
    v_mfma_f32_16x16x32_bf16 v[192:195], a[164:167], v[136:139], v[192:195]
    ds_read_b128 v[112:115], v18 offset:14336
    s_waitcnt lgkmcnt(9)
    v_mfma_f32_16x16x32_bf16 v[196:199], a[156:159], v[140:143], v[196:199]
    v_mfma_f32_16x16x32_bf16 v[200:203], a[160:163], v[140:143], v[200:203]
    ds_read_b128 v[116:119], v18 offset:17408
    v_mfma_f32_16x16x32_bf16 v[204:207], a[164:167], v[140:143], v[204:207]
    s_waitcnt lgkmcnt(9)
    v_mfma_f32_16x16x32_bf16 v[208:211], a[156:159], v[144:147], v[208:211]
    ds_read_b128 v[120:123], v18 offset:20480
    v_mfma_f32_16x16x32_bf16 v[212:215], a[160:163], v[144:147], v[212:215]
    v_mfma_f32_16x16x32_bf16 v[216:219], a[164:167], v[144:147], v[216:219]
    ds_read_b128 v[124:127], v18 offset:23552
    s_waitcnt lgkmcnt(10)
    v_mfma_f32_16x16x32_bf16 v[220:223], a[156:159], v[148:151], v[220:223]
    v_mfma_f32_16x16x32_bf16 v[224:227], a[160:163], v[148:151], v[224:227]
    v_mfma_f32_16x16x32_bf16 v[228:231], a[164:167], v[148:151], v[228:231]
    s_waitcnt lgkmcnt(9)
    v_mfma_f32_16x16x32_bf16 v[232:235], a[156:159], v[152:155], v[232:235]
    v_mfma_f32_16x16x32_bf16 v[236:239], a[160:163], v[152:155], v[236:239]
    v_mfma_f32_16x16x32_bf16 v[240:243], a[164:167], v[152:155], v[240:243]
    s_waitcnt lgkmcnt(8)
    v_mfma_f32_16x16x32_bf16 v[244:247], a[156:159], v[156:159], v[244:247]
    v_mfma_f32_16x16x32_bf16 v[248:251], a[160:163], v[156:159], v[248:251]
    v_mfma_f32_16x16x32_bf16 v[252:255], a[164:167], v[156:159], v[252:255]
    s_waitcnt lgkmcnt(0)
    s_waitcnt vmcnt(24)
    s_barrier
    v_mfma_f32_16x16x32_bf16 v[160:163], a[168:171], v[96:99], v[160:163]
    s_add_u32 m0, s92, 98304
    s_add_u32 s93, s94, 12288
    buffer_load_dwordx4 v16, s[52:55], s93 offen offset:0 sc1 lds
    buffer_load_dwordx4 v16, s[52:55], s93 offen offset:1024 sc1 lds
    buffer_load_dwordx4 v16, s[52:55], s93 offen offset:2048 sc1 lds
    s_add_u32 m0, s92, 101376
    s_add_u32 s93, s94, 30720
    buffer_load_dwordx4 v16, s[52:55], s93 offen offset:0 sc1 lds
    buffer_load_dwordx4 v16, s[52:55], s93 offen offset:1024 sc1 lds
    buffer_load_dwordx4 v16, s[52:55], s93 offen offset:2048 sc1 lds
    v_mfma_f32_16x16x32_bf16 v[164:167], a[172:175], v[96:99], v[164:167]
    v_mfma_f32_16x16x32_bf16 v[168:171], a[176:179], v[96:99], v[168:171]
    ds_read_b128 v[128:131], v18 offset:24576
    v_mfma_f32_16x16x32_bf16 v[172:175], a[168:171], v[100:103], v[172:175]
    v_mfma_f32_16x16x32_bf16 v[176:179], a[172:175], v[100:103], v[176:179]
    ds_read_b128 v[132:135], v18 offset:27648
    v_mfma_f32_16x16x32_bf16 v[180:183], a[176:179], v[100:103], v[180:183]
    v_mfma_f32_16x16x32_bf16 v[184:187], a[168:171], v[104:107], v[184:187]
    ds_read_b128 v[136:139], v18 offset:30720
    v_mfma_f32_16x16x32_bf16 v[188:191], a[172:175], v[104:107], v[188:191]
    v_mfma_f32_16x16x32_bf16 v[192:195], a[176:179], v[104:107], v[192:195]
    ds_read_b128 v[140:143], v18 offset:33792
    v_mfma_f32_16x16x32_bf16 v[196:199], a[168:171], v[108:111], v[196:199]
    v_mfma_f32_16x16x32_bf16 v[200:203], a[172:175], v[108:111], v[200:203]
    ds_read_b128 v[144:147], v18 offset:36864
    v_mfma_f32_16x16x32_bf16 v[204:207], a[176:179], v[108:111], v[204:207]
    v_mfma_f32_16x16x32_bf16 v[208:211], a[168:171], v[112:115], v[208:211]
    ds_read_b128 v[148:151], v18 offset:39936
    v_mfma_f32_16x16x32_bf16 v[212:215], a[172:175], v[112:115], v[212:215]
    v_mfma_f32_16x16x32_bf16 v[216:219], a[176:179], v[112:115], v[216:219]
    ds_read_b128 v[152:155], v18 offset:43008
    v_mfma_f32_16x16x32_bf16 v[220:223], a[168:171], v[116:119], v[220:223]
    v_mfma_f32_16x16x32_bf16 v[224:227], a[172:175], v[116:119], v[224:227]
    ds_read_b128 v[156:159], v18 offset:46080
    v_mfma_f32_16x16x32_bf16 v[228:231], a[176:179], v[116:119], v[228:231]
    v_mfma_f32_16x16x32_bf16 v[232:235], a[168:171], v[120:123], v[232:235]
    v_mfma_f32_16x16x32_bf16 v[236:239], a[172:175], v[120:123], v[236:239]
    v_mfma_f32_16x16x32_bf16 v[240:243], a[176:179], v[120:123], v[240:243]
    v_mfma_f32_16x16x32_bf16 v[244:247], a[168:171], v[124:127], v[244:247]
    v_mfma_f32_16x16x32_bf16 v[248:251], a[172:175], v[124:127], v[248:251]
    v_mfma_f32_16x16x32_bf16 v[252:255], a[176:179], v[124:127], v[252:255]
    s_waitcnt lgkmcnt(7)
    v_mfma_f32_16x16x32_bf16 v[160:163], a[180:183], v[128:131], v[160:163]
    ds_read_b128 v[96:99], v18 offset:25600
    v_mfma_f32_16x16x32_bf16 v[164:167], a[184:187], v[128:131], v[164:167]
    v_mfma_f32_16x16x32_bf16 v[168:171], a[188:191], v[128:131], v[168:171]
    ds_read_b128 v[100:103], v18 offset:28672
    s_waitcnt lgkmcnt(8)
    v_mfma_f32_16x16x32_bf16 v[172:175], a[180:183], v[132:135], v[172:175]
    v_mfma_f32_16x16x32_bf16 v[176:179], a[184:187], v[132:135], v[176:179]
    ds_read_b128 v[104:107], v18 offset:31744
    v_mfma_f32_16x16x32_bf16 v[180:183], a[188:191], v[132:135], v[180:183]
    s_waitcnt lgkmcnt(8)
    v_mfma_f32_16x16x32_bf16 v[184:187], a[180:183], v[136:139], v[184:187]
    ds_read_b128 v[108:111], v18 offset:34816
    v_mfma_f32_16x16x32_bf16 v[188:191], a[184:187], v[136:139], v[188:191]
    v_mfma_f32_16x16x32_bf16 v[192:195], a[188:191], v[136:139], v[192:195]
    ds_read_b128 v[112:115], v18 offset:37888
    s_waitcnt lgkmcnt(9)
    v_mfma_f32_16x16x32_bf16 v[196:199], a[180:183], v[140:143], v[196:199]
    v_mfma_f32_16x16x32_bf16 v[200:203], a[184:187], v[140:143], v[200:203]
    ds_read_b128 v[116:119], v18 offset:40960
    v_mfma_f32_16x16x32_bf16 v[204:207], a[188:191], v[140:143], v[204:207]
    s_waitcnt lgkmcnt(9)
    v_mfma_f32_16x16x32_bf16 v[208:211], a[180:183], v[144:147], v[208:211]
    ds_read_b128 v[120:123], v18 offset:44032
    v_mfma_f32_16x16x32_bf16 v[212:215], a[184:187], v[144:147], v[212:215]
    v_mfma_f32_16x16x32_bf16 v[216:219], a[188:191], v[144:147], v[216:219]
    ds_read_b128 v[124:127], v18 offset:47104
    s_waitcnt lgkmcnt(10)
    v_mfma_f32_16x16x32_bf16 v[220:223], a[180:183], v[148:151], v[220:223]
    v_mfma_f32_16x16x32_bf16 v[224:227], a[184:187], v[148:151], v[224:227]
    v_mfma_f32_16x16x32_bf16 v[228:231], a[188:191], v[148:151], v[228:231]
    s_waitcnt lgkmcnt(9)
    v_mfma_f32_16x16x32_bf16 v[232:235], a[180:183], v[152:155], v[232:235]
    v_mfma_f32_16x16x32_bf16 v[236:239], a[184:187], v[152:155], v[236:239]
    v_mfma_f32_16x16x32_bf16 v[240:243], a[188:191], v[152:155], v[240:243]
    s_waitcnt lgkmcnt(8)
    v_mfma_f32_16x16x32_bf16 v[244:247], a[180:183], v[156:159], v[244:247]
    v_mfma_f32_16x16x32_bf16 v[248:251], a[184:187], v[156:159], v[248:251]
    v_mfma_f32_16x16x32_bf16 v[252:255], a[188:191], v[156:159], v[252:255]
    s_waitcnt lgkmcnt(7)
    v_mfma_f32_16x16x32_bf16 v[160:163], a[192:195], v[96:99], v[160:163]
    ds_read_b128 v[128:131], v18 offset:26624
    v_mfma_f32_16x16x32_bf16 v[164:167], a[196:199], v[96:99], v[164:167]
    v_mfma_f32_16x16x32_bf16 v[168:171], a[200:203], v[96:99], v[168:171]
    ds_read_b128 v[132:135], v18 offset:29696
    s_waitcnt lgkmcnt(8)
    v_mfma_f32_16x16x32_bf16 v[172:175], a[192:195], v[100:103], v[172:175]
    v_mfma_f32_16x16x32_bf16 v[176:179], a[196:199], v[100:103], v[176:179]
    ds_read_b128 v[136:139], v18 offset:32768
    v_mfma_f32_16x16x32_bf16 v[180:183], a[200:203], v[100:103], v[180:183]
    s_waitcnt lgkmcnt(8)
    v_mfma_f32_16x16x32_bf16 v[184:187], a[192:195], v[104:107], v[184:187]
    ds_read_b128 v[140:143], v18 offset:35840
    v_mfma_f32_16x16x32_bf16 v[188:191], a[196:199], v[104:107], v[188:191]
    v_mfma_f32_16x16x32_bf16 v[192:195], a[200:203], v[104:107], v[192:195]
    ds_read_b128 v[144:147], v18 offset:38912
    s_waitcnt lgkmcnt(9)
    v_mfma_f32_16x16x32_bf16 v[196:199], a[192:195], v[108:111], v[196:199]
    v_mfma_f32_16x16x32_bf16 v[200:203], a[196:199], v[108:111], v[200:203]
    ds_read_b128 v[148:151], v18 offset:41984
    v_mfma_f32_16x16x32_bf16 v[204:207], a[200:203], v[108:111], v[204:207]
    s_waitcnt lgkmcnt(9)
    v_mfma_f32_16x16x32_bf16 v[208:211], a[192:195], v[112:115], v[208:211]
    ds_read_b128 v[152:155], v18 offset:45056
    v_mfma_f32_16x16x32_bf16 v[212:215], a[196:199], v[112:115], v[212:215]
    v_mfma_f32_16x16x32_bf16 v[216:219], a[200:203], v[112:115], v[216:219]
    ds_read_b128 v[156:159], v18 offset:48128
    s_waitcnt lgkmcnt(10)
    v_mfma_f32_16x16x32_bf16 v[220:223], a[192:195], v[116:119], v[220:223]
    v_mfma_f32_16x16x32_bf16 v[224:227], a[196:199], v[116:119], v[224:227]
    v_mfma_f32_16x16x32_bf16 v[228:231], a[200:203], v[116:119], v[228:231]
    s_waitcnt lgkmcnt(9)
    v_mfma_f32_16x16x32_bf16 v[232:235], a[192:195], v[120:123], v[232:235]
    v_mfma_f32_16x16x32_bf16 v[236:239], a[196:199], v[120:123], v[236:239]
    v_mfma_f32_16x16x32_bf16 v[240:243], a[200:203], v[120:123], v[240:243]
    s_waitcnt lgkmcnt(8)
    v_mfma_f32_16x16x32_bf16 v[244:247], a[192:195], v[124:127], v[244:247]
    v_mfma_f32_16x16x32_bf16 v[248:251], a[196:199], v[124:127], v[248:251]
    v_mfma_f32_16x16x32_bf16 v[252:255], a[200:203], v[124:127], v[252:255]
    s_waitcnt lgkmcnt(0)
    s_waitcnt vmcnt(24)
    s_barrier
    v_mfma_f32_16x16x32_bf16 v[160:163], a[204:207], v[128:131], v[160:163]
    s_add_u32 m0, s92, 122880
    s_add_u32 s93, s94, 15360
    buffer_load_dwordx4 v16, s[52:55], s93 offen offset:0 sc1 lds
    buffer_load_dwordx4 v16, s[52:55], s93 offen offset:1024 sc1 lds
    buffer_load_dwordx4 v16, s[52:55], s93 offen offset:2048 sc1 lds
    s_add_u32 m0, s92, 125952
    s_add_u32 s93, s94, 33792
    buffer_load_dwordx4 v16, s[52:55], s93 offen offset:0 sc1 lds
    buffer_load_dwordx4 v16, s[52:55], s93 offen offset:1024 sc1 lds
    buffer_load_dwordx4 v16, s[52:55], s93 offen offset:2048 sc1 lds
    v_mfma_f32_16x16x32_bf16 v[164:167], a[208:211], v[128:131], v[164:167]
    v_mfma_f32_16x16x32_bf16 v[168:171], a[212:215], v[128:131], v[168:171]
    ds_read_b128 v[96:99], v16 offset:0
    v_mfma_f32_16x16x32_bf16 v[172:175], a[204:207], v[132:135], v[172:175]
    v_mfma_f32_16x16x32_bf16 v[176:179], a[208:211], v[132:135], v[176:179]
    ds_read_b128 v[100:103], v16 offset:3072
    v_mfma_f32_16x16x32_bf16 v[180:183], a[212:215], v[132:135], v[180:183]
    v_mfma_f32_16x16x32_bf16 v[184:187], a[204:207], v[136:139], v[184:187]
    ds_read_b128 v[104:107], v16 offset:6144
    v_mfma_f32_16x16x32_bf16 v[188:191], a[208:211], v[136:139], v[188:191]
    v_mfma_f32_16x16x32_bf16 v[192:195], a[212:215], v[136:139], v[192:195]
    ds_read_b128 v[108:111], v16 offset:9216
    v_mfma_f32_16x16x32_bf16 v[196:199], a[204:207], v[140:143], v[196:199]
    v_mfma_f32_16x16x32_bf16 v[200:203], a[208:211], v[140:143], v[200:203]
    ds_read_b128 v[112:115], v16 offset:12288
    v_mfma_f32_16x16x32_bf16 v[204:207], a[212:215], v[140:143], v[204:207]
    v_mfma_f32_16x16x32_bf16 v[208:211], a[204:207], v[144:147], v[208:211]
    ds_read_b128 v[116:119], v16 offset:15360
    v_mfma_f32_16x16x32_bf16 v[212:215], a[208:211], v[144:147], v[212:215]
    v_mfma_f32_16x16x32_bf16 v[216:219], a[212:215], v[144:147], v[216:219]
    ds_read_b128 v[120:123], v16 offset:18432
    v_mfma_f32_16x16x32_bf16 v[220:223], a[204:207], v[148:151], v[220:223]
    v_mfma_f32_16x16x32_bf16 v[224:227], a[208:211], v[148:151], v[224:227]
    ds_read_b128 v[124:127], v16 offset:21504
    v_mfma_f32_16x16x32_bf16 v[228:231], a[212:215], v[148:151], v[228:231]
    v_mfma_f32_16x16x32_bf16 v[232:235], a[204:207], v[152:155], v[232:235]
    v_mfma_f32_16x16x32_bf16 v[236:239], a[208:211], v[152:155], v[236:239]
    v_mfma_f32_16x16x32_bf16 v[240:243], a[212:215], v[152:155], v[240:243]
    v_mfma_f32_16x16x32_bf16 v[244:247], a[204:207], v[156:159], v[244:247]
    v_mfma_f32_16x16x32_bf16 v[248:251], a[208:211], v[156:159], v[248:251]
    v_mfma_f32_16x16x32_bf16 v[252:255], a[212:215], v[156:159], v[252:255]
    v_cvt_pk_bf16_f32 v40, v160, v161
    v_cvt_pk_bf16_f32 v41, v162, v163
    v_lshlrev_b32 v42, 16, v40
    v_and_b32 v43, 0xffff0000, v40
    v_mul_f32 v44, v42, v42
    v_mul_f32 v45, v43, v43
    v_fma_f32 v44, v44, s98, v20
    v_fma_f32 v45, v45, s98, v20
    v_mul_f32 v44, v44, v42
    v_mul_f32 v45, v45, v43
    v_exp_f32 v44, v44
    v_exp_f32 v45, v45
    v_lshlrev_b32 v46, 16, v41
    v_add_f32 v44, 1.0, v44
    v_add_f32 v45, 1.0, v45
    v_rcp_f32 v44, v44
    v_rcp_f32 v45, v45
    v_and_b32 v47, 0xffff0000, v41
    v_mul_f32 v44, v44, v42
    v_mul_f32 v45, v45, v43
    v_cvt_pk_bf16_f32 v40, v44, v45
    v_lshlrev_b32 v42, 16, v40
    v_and_b32 v43, 0xffff0000, v40
    v_mul_f32 v42, v42, v46
    v_mul_f32 v43, v43, v47
    v_cvt_pk_bf16_f32 v32, v42, v43
    v_cvt_pk_bf16_f32 v48, v164, v165
    v_cvt_pk_bf16_f32 v49, v166, v167
    v_lshlrev_b32 v50, 16, v48
    v_and_b32 v51, 0xffff0000, v48
    v_mul_f32 v52, v50, v50
    v_mul_f32 v53, v51, v51
    v_fma_f32 v52, v52, s98, v20
    v_fma_f32 v53, v53, s98, v20
    v_mul_f32 v52, v52, v50
    v_mul_f32 v53, v53, v51
    v_exp_f32 v52, v52
    v_exp_f32 v53, v53
    v_lshlrev_b32 v54, 16, v49
    v_add_f32 v52, 1.0, v52
    v_add_f32 v53, 1.0, v53
    v_rcp_f32 v52, v52
    v_rcp_f32 v53, v53
    v_and_b32 v55, 0xffff0000, v49
    v_mul_f32 v52, v52, v50
    v_mul_f32 v53, v53, v51
    v_cvt_pk_bf16_f32 v48, v52, v53
    v_lshlrev_b32 v50, 16, v48
    v_and_b32 v51, 0xffff0000, v48
    v_mul_f32 v50, v50, v54
    v_mul_f32 v51, v51, v55
    v_cvt_pk_bf16_f32 v33, v50, v51
    v_cvt_pk_bf16_f32 v40, v168, v169
    v_cvt_pk_bf16_f32 v41, v170, v171
    v_lshlrev_b32 v42, 16, v40
    v_and_b32 v43, 0xffff0000, v40
    v_mul_f32 v44, v42, v42
    v_mul_f32 v45, v43, v43
    v_fma_f32 v44, v44, s98, v20
    v_fma_f32 v45, v45, s98, v20
    v_mul_f32 v44, v44, v42
    v_mul_f32 v45, v45, v43
    v_exp_f32 v44, v44
    v_exp_f32 v45, v45
    v_lshlrev_b32 v46, 16, v41
    v_add_f32 v44, 1.0, v44
    v_add_f32 v45, 1.0, v45
    v_rcp_f32 v44, v44
    v_rcp_f32 v45, v45
    v_and_b32 v47, 0xffff0000, v41
    v_mul_f32 v44, v44, v42
    v_mul_f32 v45, v45, v43
    v_cvt_pk_bf16_f32 v40, v44, v45
    v_lshlrev_b32 v42, 16, v40
    v_and_b32 v43, 0xffff0000, v40
    v_mul_f32 v42, v42, v46
    v_mul_f32 v43, v43, v47
    v_cvt_pk_bf16_f32 v34, v42, v43
    s_add_u32 s93, s96, 0
    buffer_store_dwordx3 v[32:34], v19, s[52:55], s93 offen sc1
    v_cvt_pk_bf16_f32 v40, v172, v173
    v_cvt_pk_bf16_f32 v41, v174, v175
    v_lshlrev_b32 v42, 16, v40
    v_and_b32 v43, 0xffff0000, v40
    v_mul_f32 v44, v42, v42
    v_mul_f32 v45, v43, v43
    v_fma_f32 v44, v44, s98, v20
    v_fma_f32 v45, v45, s98, v20
    v_mul_f32 v44, v44, v42
    v_mul_f32 v45, v45, v43
    v_exp_f32 v44, v44
    v_exp_f32 v45, v45
    v_lshlrev_b32 v46, 16, v41
    v_add_f32 v44, 1.0, v44
    v_add_f32 v45, 1.0, v45
    v_rcp_f32 v44, v44
    v_rcp_f32 v45, v45
    v_and_b32 v47, 0xffff0000, v41
    v_mul_f32 v44, v44, v42
    v_mul_f32 v45, v45, v43
    v_cvt_pk_bf16_f32 v40, v44, v45
    v_lshlrev_b32 v42, 16, v40
    v_and_b32 v43, 0xffff0000, v40
    v_mul_f32 v42, v42, v46
    v_mul_f32 v43, v43, v47
    v_cvt_pk_bf16_f32 v36, v42, v43
    v_cvt_pk_bf16_f32 v48, v176, v177
    v_cvt_pk_bf16_f32 v49, v178, v179
    v_lshlrev_b32 v50, 16, v48
    v_and_b32 v51, 0xffff0000, v48
    v_mul_f32 v52, v50, v50
    v_mul_f32 v53, v51, v51
    v_fma_f32 v52, v52, s98, v20
    v_fma_f32 v53, v53, s98, v20
    v_mul_f32 v52, v52, v50
    v_mul_f32 v53, v53, v51
    v_exp_f32 v52, v52
    v_exp_f32 v53, v53
    v_lshlrev_b32 v54, 16, v49
    v_add_f32 v52, 1.0, v52
    v_add_f32 v53, 1.0, v53
    v_rcp_f32 v52, v52
    v_rcp_f32 v53, v53
    v_and_b32 v55, 0xffff0000, v49
    v_mul_f32 v52, v52, v50
    v_mul_f32 v53, v53, v51
    v_cvt_pk_bf16_f32 v48, v52, v53
    v_lshlrev_b32 v50, 16, v48
    v_and_b32 v51, 0xffff0000, v48
    v_mul_f32 v50, v50, v54
    v_mul_f32 v51, v51, v55
    v_cvt_pk_bf16_f32 v37, v50, v51
    v_cvt_pk_bf16_f32 v40, v180, v181
    v_cvt_pk_bf16_f32 v41, v182, v183
    v_lshlrev_b32 v42, 16, v40
    v_and_b32 v43, 0xffff0000, v40
    v_mul_f32 v44, v42, v42
    v_mul_f32 v45, v43, v43
    v_fma_f32 v44, v44, s98, v20
    v_fma_f32 v45, v45, s98, v20
    v_mul_f32 v44, v44, v42
    v_mul_f32 v45, v45, v43
    v_exp_f32 v44, v44
    v_exp_f32 v45, v45
    v_lshlrev_b32 v46, 16, v41
    v_add_f32 v44, 1.0, v44
    v_add_f32 v45, 1.0, v45
    v_rcp_f32 v44, v44
    v_rcp_f32 v45, v45
    v_and_b32 v47, 0xffff0000, v41
    v_mul_f32 v44, v44, v42
    v_mul_f32 v45, v45, v43
    v_cvt_pk_bf16_f32 v40, v44, v45
    v_lshlrev_b32 v42, 16, v40
    v_and_b32 v43, 0xffff0000, v40
    v_mul_f32 v42, v42, v46
    v_mul_f32 v43, v43, v47
    v_cvt_pk_bf16_f32 v38, v42, v43
    s_add_u32 s93, s96, 147456
    buffer_store_dwordx3 v[36:38], v19, s[52:55], s93 offen sc1
    v_cvt_pk_bf16_f32 v40, v184, v185
    v_cvt_pk_bf16_f32 v41, v186, v187
    v_lshlrev_b32 v42, 16, v40
    v_and_b32 v43, 0xffff0000, v40
    v_mul_f32 v44, v42, v42
    v_mul_f32 v45, v43, v43
    v_fma_f32 v44, v44, s98, v20
    v_fma_f32 v45, v45, s98, v20
    v_mul_f32 v44, v44, v42
    v_mul_f32 v45, v45, v43
    v_exp_f32 v44, v44
    v_exp_f32 v45, v45
    v_lshlrev_b32 v46, 16, v41
    v_add_f32 v44, 1.0, v44
    v_add_f32 v45, 1.0, v45
    v_rcp_f32 v44, v44
    v_rcp_f32 v45, v45
    v_and_b32 v47, 0xffff0000, v41
    v_mul_f32 v44, v44, v42
    v_mul_f32 v45, v45, v43
    v_cvt_pk_bf16_f32 v40, v44, v45
    v_lshlrev_b32 v42, 16, v40
    v_and_b32 v43, 0xffff0000, v40
    v_mul_f32 v42, v42, v46
    v_mul_f32 v43, v43, v47
    v_cvt_pk_bf16_f32 v32, v42, v43
    v_cvt_pk_bf16_f32 v48, v188, v189
    v_cvt_pk_bf16_f32 v49, v190, v191
    v_lshlrev_b32 v50, 16, v48
    v_and_b32 v51, 0xffff0000, v48
    v_mul_f32 v52, v50, v50
    v_mul_f32 v53, v51, v51
    v_fma_f32 v52, v52, s98, v20
    v_fma_f32 v53, v53, s98, v20
    v_mul_f32 v52, v52, v50
    v_mul_f32 v53, v53, v51
    v_exp_f32 v52, v52
    v_exp_f32 v53, v53
    v_lshlrev_b32 v54, 16, v49
    v_add_f32 v52, 1.0, v52
    v_add_f32 v53, 1.0, v53
    v_rcp_f32 v52, v52
    v_rcp_f32 v53, v53
    v_and_b32 v55, 0xffff0000, v49
    v_mul_f32 v52, v52, v50
    v_mul_f32 v53, v53, v51
    v_cvt_pk_bf16_f32 v48, v52, v53
    v_lshlrev_b32 v50, 16, v48
    v_and_b32 v51, 0xffff0000, v48
    v_mul_f32 v50, v50, v54
    v_mul_f32 v51, v51, v55
    v_cvt_pk_bf16_f32 v33, v50, v51
    v_cvt_pk_bf16_f32 v40, v192, v193
    v_cvt_pk_bf16_f32 v41, v194, v195
    v_lshlrev_b32 v42, 16, v40
    v_and_b32 v43, 0xffff0000, v40
    v_mul_f32 v44, v42, v42
    v_mul_f32 v45, v43, v43
    v_fma_f32 v44, v44, s98, v20
    v_fma_f32 v45, v45, s98, v20
    v_mul_f32 v44, v44, v42
    v_mul_f32 v45, v45, v43
    v_exp_f32 v44, v44
    v_exp_f32 v45, v45
    v_lshlrev_b32 v46, 16, v41
    v_add_f32 v44, 1.0, v44
    v_add_f32 v45, 1.0, v45
    v_rcp_f32 v44, v44
    v_rcp_f32 v45, v45
    v_and_b32 v47, 0xffff0000, v41
    v_mul_f32 v44, v44, v42
    v_mul_f32 v45, v45, v43
    v_cvt_pk_bf16_f32 v40, v44, v45
    v_lshlrev_b32 v42, 16, v40
    v_and_b32 v43, 0xffff0000, v40
    v_mul_f32 v42, v42, v46
    v_mul_f32 v43, v43, v47
    v_cvt_pk_bf16_f32 v34, v42, v43
    s_add_u32 s93, s96, 294912
    buffer_store_dwordx3 v[32:34], v19, s[52:55], s93 offen sc1
    v_cvt_pk_bf16_f32 v40, v196, v197
    v_cvt_pk_bf16_f32 v41, v198, v199
    v_lshlrev_b32 v42, 16, v40
    v_and_b32 v43, 0xffff0000, v40
    v_mul_f32 v44, v42, v42
    v_mul_f32 v45, v43, v43
    v_fma_f32 v44, v44, s98, v20
    v_fma_f32 v45, v45, s98, v20
    v_mul_f32 v44, v44, v42
    v_mul_f32 v45, v45, v43
    v_exp_f32 v44, v44
    v_exp_f32 v45, v45
    v_lshlrev_b32 v46, 16, v41
    v_add_f32 v44, 1.0, v44
    v_add_f32 v45, 1.0, v45
    v_rcp_f32 v44, v44
    v_rcp_f32 v45, v45
    v_and_b32 v47, 0xffff0000, v41
    v_mul_f32 v44, v44, v42
    v_mul_f32 v45, v45, v43
    v_cvt_pk_bf16_f32 v40, v44, v45
    v_lshlrev_b32 v42, 16, v40
    v_and_b32 v43, 0xffff0000, v40
    v_mul_f32 v42, v42, v46
    v_mul_f32 v43, v43, v47
    v_cvt_pk_bf16_f32 v36, v42, v43
    v_cvt_pk_bf16_f32 v48, v200, v201
    v_cvt_pk_bf16_f32 v49, v202, v203
    v_lshlrev_b32 v50, 16, v48
    v_and_b32 v51, 0xffff0000, v48
    v_mul_f32 v52, v50, v50
    v_mul_f32 v53, v51, v51
    v_fma_f32 v52, v52, s98, v20
    v_fma_f32 v53, v53, s98, v20
    v_mul_f32 v52, v52, v50
    v_mul_f32 v53, v53, v51
    v_exp_f32 v52, v52
    v_exp_f32 v53, v53
    v_lshlrev_b32 v54, 16, v49
    v_add_f32 v52, 1.0, v52
    v_add_f32 v53, 1.0, v53
    v_rcp_f32 v52, v52
    v_rcp_f32 v53, v53
    v_and_b32 v55, 0xffff0000, v49
    v_mul_f32 v52, v52, v50
    v_mul_f32 v53, v53, v51
    v_cvt_pk_bf16_f32 v48, v52, v53
    v_lshlrev_b32 v50, 16, v48
    v_and_b32 v51, 0xffff0000, v48
    v_mul_f32 v50, v50, v54
    v_mul_f32 v51, v51, v55
    v_cvt_pk_bf16_f32 v37, v50, v51
    v_cvt_pk_bf16_f32 v40, v204, v205
    v_cvt_pk_bf16_f32 v41, v206, v207
    v_lshlrev_b32 v42, 16, v40
    v_and_b32 v43, 0xffff0000, v40
    v_mul_f32 v44, v42, v42
    v_mul_f32 v45, v43, v43
    v_fma_f32 v44, v44, s98, v20
    v_fma_f32 v45, v45, s98, v20
    v_mul_f32 v44, v44, v42
    v_mul_f32 v45, v45, v43
    v_exp_f32 v44, v44
    v_exp_f32 v45, v45
    v_lshlrev_b32 v46, 16, v41
    v_add_f32 v44, 1.0, v44
    v_add_f32 v45, 1.0, v45
    v_rcp_f32 v44, v44
    v_rcp_f32 v45, v45
    v_and_b32 v47, 0xffff0000, v41
    v_mul_f32 v44, v44, v42
    v_mul_f32 v45, v45, v43
    v_cvt_pk_bf16_f32 v40, v44, v45
    v_lshlrev_b32 v42, 16, v40
    v_and_b32 v43, 0xffff0000, v40
    v_mul_f32 v42, v42, v46
    v_mul_f32 v43, v43, v47
    v_cvt_pk_bf16_f32 v38, v42, v43
    s_add_u32 s93, s96, 442368
    buffer_store_dwordx3 v[36:38], v19, s[52:55], s93 offen sc1
    v_cvt_pk_bf16_f32 v40, v208, v209
    v_cvt_pk_bf16_f32 v41, v210, v211
    v_lshlrev_b32 v42, 16, v40
    v_and_b32 v43, 0xffff0000, v40
    v_mul_f32 v44, v42, v42
    v_mul_f32 v45, v43, v43
    v_fma_f32 v44, v44, s98, v20
    v_fma_f32 v45, v45, s98, v20
    v_mul_f32 v44, v44, v42
    v_mul_f32 v45, v45, v43
    v_exp_f32 v44, v44
    v_exp_f32 v45, v45
    v_lshlrev_b32 v46, 16, v41
    v_add_f32 v44, 1.0, v44
    v_add_f32 v45, 1.0, v45
    v_rcp_f32 v44, v44
    v_rcp_f32 v45, v45
    v_and_b32 v47, 0xffff0000, v41
    v_mul_f32 v44, v44, v42
    v_mul_f32 v45, v45, v43
    v_cvt_pk_bf16_f32 v40, v44, v45
    v_lshlrev_b32 v42, 16, v40
    v_and_b32 v43, 0xffff0000, v40
    v_mul_f32 v42, v42, v46
    v_mul_f32 v43, v43, v47
    v_cvt_pk_bf16_f32 v32, v42, v43
    v_cvt_pk_bf16_f32 v48, v212, v213
    v_cvt_pk_bf16_f32 v49, v214, v215
    v_lshlrev_b32 v50, 16, v48
    v_and_b32 v51, 0xffff0000, v48
    v_mul_f32 v52, v50, v50
    v_mul_f32 v53, v51, v51
    v_fma_f32 v52, v52, s98, v20
    v_fma_f32 v53, v53, s98, v20
    v_mul_f32 v52, v52, v50
    v_mul_f32 v53, v53, v51
    v_exp_f32 v52, v52
    v_exp_f32 v53, v53
    v_lshlrev_b32 v54, 16, v49
    v_add_f32 v52, 1.0, v52
    v_add_f32 v53, 1.0, v53
    v_rcp_f32 v52, v52
    v_rcp_f32 v53, v53
    v_and_b32 v55, 0xffff0000, v49
    v_mul_f32 v52, v52, v50
    v_mul_f32 v53, v53, v51
    v_cvt_pk_bf16_f32 v48, v52, v53
    v_lshlrev_b32 v50, 16, v48
    v_and_b32 v51, 0xffff0000, v48
    v_mul_f32 v50, v50, v54
    v_mul_f32 v51, v51, v55
    v_cvt_pk_bf16_f32 v33, v50, v51
    v_cvt_pk_bf16_f32 v40, v216, v217
    v_cvt_pk_bf16_f32 v41, v218, v219
    v_lshlrev_b32 v42, 16, v40
    v_and_b32 v43, 0xffff0000, v40
    v_mul_f32 v44, v42, v42
    v_mul_f32 v45, v43, v43
    v_fma_f32 v44, v44, s98, v20
    v_fma_f32 v45, v45, s98, v20
    v_mul_f32 v44, v44, v42
    v_mul_f32 v45, v45, v43
    v_exp_f32 v44, v44
    v_exp_f32 v45, v45
    v_lshlrev_b32 v46, 16, v41
    v_add_f32 v44, 1.0, v44
    v_add_f32 v45, 1.0, v45
    v_rcp_f32 v44, v44
    v_rcp_f32 v45, v45
    v_and_b32 v47, 0xffff0000, v41
    v_mul_f32 v44, v44, v42
    v_mul_f32 v45, v45, v43
    v_cvt_pk_bf16_f32 v40, v44, v45
    v_lshlrev_b32 v42, 16, v40
    v_and_b32 v43, 0xffff0000, v40
    v_mul_f32 v42, v42, v46
    v_mul_f32 v43, v43, v47
    v_cvt_pk_bf16_f32 v34, v42, v43
    s_add_u32 s93, s96, 589824
    buffer_store_dwordx3 v[32:34], v19, s[52:55], s93 offen sc1
    v_cvt_pk_bf16_f32 v40, v220, v221
    v_cvt_pk_bf16_f32 v41, v222, v223
    v_lshlrev_b32 v42, 16, v40
    v_and_b32 v43, 0xffff0000, v40
    v_mul_f32 v44, v42, v42
    v_mul_f32 v45, v43, v43
    v_fma_f32 v44, v44, s98, v20
    v_fma_f32 v45, v45, s98, v20
    v_mul_f32 v44, v44, v42
    v_mul_f32 v45, v45, v43
    v_exp_f32 v44, v44
    v_exp_f32 v45, v45
    v_lshlrev_b32 v46, 16, v41
    v_add_f32 v44, 1.0, v44
    v_add_f32 v45, 1.0, v45
    v_rcp_f32 v44, v44
    v_rcp_f32 v45, v45
    v_and_b32 v47, 0xffff0000, v41
    v_mul_f32 v44, v44, v42
    v_mul_f32 v45, v45, v43
    v_cvt_pk_bf16_f32 v40, v44, v45
    v_lshlrev_b32 v42, 16, v40
    v_and_b32 v43, 0xffff0000, v40
    v_mul_f32 v42, v42, v46
    v_mul_f32 v43, v43, v47
    v_cvt_pk_bf16_f32 v36, v42, v43
    v_cvt_pk_bf16_f32 v48, v224, v225
    v_cvt_pk_bf16_f32 v49, v226, v227
    v_lshlrev_b32 v50, 16, v48
    v_and_b32 v51, 0xffff0000, v48
    v_mul_f32 v52, v50, v50
    v_mul_f32 v53, v51, v51
    v_fma_f32 v52, v52, s98, v20
    v_fma_f32 v53, v53, s98, v20
    v_mul_f32 v52, v52, v50
    v_mul_f32 v53, v53, v51
    v_exp_f32 v52, v52
    v_exp_f32 v53, v53
    v_lshlrev_b32 v54, 16, v49
    v_add_f32 v52, 1.0, v52
    v_add_f32 v53, 1.0, v53
    v_rcp_f32 v52, v52
    v_rcp_f32 v53, v53
    v_and_b32 v55, 0xffff0000, v49
    v_mul_f32 v52, v52, v50
    v_mul_f32 v53, v53, v51
    v_cvt_pk_bf16_f32 v48, v52, v53
    v_lshlrev_b32 v50, 16, v48
    v_and_b32 v51, 0xffff0000, v48
    v_mul_f32 v50, v50, v54
    v_mul_f32 v51, v51, v55
    v_cvt_pk_bf16_f32 v37, v50, v51
    v_cvt_pk_bf16_f32 v40, v228, v229
    v_cvt_pk_bf16_f32 v41, v230, v231
    v_lshlrev_b32 v42, 16, v40
    v_and_b32 v43, 0xffff0000, v40
    v_mul_f32 v44, v42, v42
    v_mul_f32 v45, v43, v43
    v_fma_f32 v44, v44, s98, v20
    v_fma_f32 v45, v45, s98, v20
    v_mul_f32 v44, v44, v42
    v_mul_f32 v45, v45, v43
    v_exp_f32 v44, v44
    v_exp_f32 v45, v45
    v_lshlrev_b32 v46, 16, v41
    v_add_f32 v44, 1.0, v44
    v_add_f32 v45, 1.0, v45
    v_rcp_f32 v44, v44
    v_rcp_f32 v45, v45
    v_and_b32 v47, 0xffff0000, v41
    v_mul_f32 v44, v44, v42
    v_mul_f32 v45, v45, v43
    v_cvt_pk_bf16_f32 v40, v44, v45
    v_lshlrev_b32 v42, 16, v40
    v_and_b32 v43, 0xffff0000, v40
    v_mul_f32 v42, v42, v46
    v_mul_f32 v43, v43, v47
    v_cvt_pk_bf16_f32 v38, v42, v43
    s_add_u32 s93, s96, 737280
    buffer_store_dwordx3 v[36:38], v19, s[52:55], s93 offen sc1
    v_cvt_pk_bf16_f32 v40, v232, v233
    v_cvt_pk_bf16_f32 v41, v234, v235
    v_lshlrev_b32 v42, 16, v40
    v_and_b32 v43, 0xffff0000, v40
    v_mul_f32 v44, v42, v42
    v_mul_f32 v45, v43, v43
    v_fma_f32 v44, v44, s98, v20
    v_fma_f32 v45, v45, s98, v20
    v_mul_f32 v44, v44, v42
    v_mul_f32 v45, v45, v43
    v_exp_f32 v44, v44
    v_exp_f32 v45, v45
    v_lshlrev_b32 v46, 16, v41
    v_add_f32 v44, 1.0, v44
    v_add_f32 v45, 1.0, v45
    v_rcp_f32 v44, v44
    v_rcp_f32 v45, v45
    v_and_b32 v47, 0xffff0000, v41
    v_mul_f32 v44, v44, v42
    v_mul_f32 v45, v45, v43
    v_cvt_pk_bf16_f32 v40, v44, v45
    v_lshlrev_b32 v42, 16, v40
    v_and_b32 v43, 0xffff0000, v40
    v_mul_f32 v42, v42, v46
    v_mul_f32 v43, v43, v47
    v_cvt_pk_bf16_f32 v32, v42, v43
    v_cvt_pk_bf16_f32 v48, v236, v237
    v_cvt_pk_bf16_f32 v49, v238, v239
    v_lshlrev_b32 v50, 16, v48
    v_and_b32 v51, 0xffff0000, v48
    v_mul_f32 v52, v50, v50
    v_mul_f32 v53, v51, v51
    v_fma_f32 v52, v52, s98, v20
    v_fma_f32 v53, v53, s98, v20
    v_mul_f32 v52, v52, v50
    v_mul_f32 v53, v53, v51
    v_exp_f32 v52, v52
    v_exp_f32 v53, v53
    v_lshlrev_b32 v54, 16, v49
    v_add_f32 v52, 1.0, v52
    v_add_f32 v53, 1.0, v53
    v_rcp_f32 v52, v52
    v_rcp_f32 v53, v53
    v_and_b32 v55, 0xffff0000, v49
    v_mul_f32 v52, v52, v50
    v_mul_f32 v53, v53, v51
    v_cvt_pk_bf16_f32 v48, v52, v53
    v_lshlrev_b32 v50, 16, v48
    v_and_b32 v51, 0xffff0000, v48
    v_mul_f32 v50, v50, v54
    v_mul_f32 v51, v51, v55
    v_cvt_pk_bf16_f32 v33, v50, v51
    v_cvt_pk_bf16_f32 v40, v240, v241
    v_cvt_pk_bf16_f32 v41, v242, v243
    v_lshlrev_b32 v42, 16, v40
    v_and_b32 v43, 0xffff0000, v40
    v_mul_f32 v44, v42, v42
    v_mul_f32 v45, v43, v43
    v_fma_f32 v44, v44, s98, v20
    v_fma_f32 v45, v45, s98, v20
    v_mul_f32 v44, v44, v42
    v_mul_f32 v45, v45, v43
    v_exp_f32 v44, v44
    v_exp_f32 v45, v45
    v_lshlrev_b32 v46, 16, v41
    v_add_f32 v44, 1.0, v44
    v_add_f32 v45, 1.0, v45
    v_rcp_f32 v44, v44
    v_rcp_f32 v45, v45
    v_and_b32 v47, 0xffff0000, v41
    v_mul_f32 v44, v44, v42
    v_mul_f32 v45, v45, v43
    v_cvt_pk_bf16_f32 v40, v44, v45
    v_lshlrev_b32 v42, 16, v40
    v_and_b32 v43, 0xffff0000, v40
    v_mul_f32 v42, v42, v46
    v_mul_f32 v43, v43, v47
    v_cvt_pk_bf16_f32 v34, v42, v43
    s_add_u32 s93, s96, 884736
    buffer_store_dwordx3 v[32:34], v19, s[52:55], s93 offen sc1
    v_cvt_pk_bf16_f32 v40, v244, v245
    v_cvt_pk_bf16_f32 v41, v246, v247
    v_lshlrev_b32 v42, 16, v40
    v_and_b32 v43, 0xffff0000, v40
    v_mul_f32 v44, v42, v42
    v_mul_f32 v45, v43, v43
    v_fma_f32 v44, v44, s98, v20
    v_fma_f32 v45, v45, s98, v20
    v_mul_f32 v44, v44, v42
    v_mul_f32 v45, v45, v43
    v_exp_f32 v44, v44
    v_exp_f32 v45, v45
    v_lshlrev_b32 v46, 16, v41
    v_add_f32 v44, 1.0, v44
    v_add_f32 v45, 1.0, v45
    v_rcp_f32 v44, v44
    v_rcp_f32 v45, v45
    v_and_b32 v47, 0xffff0000, v41
    v_mul_f32 v44, v44, v42
    v_mul_f32 v45, v45, v43
    v_cvt_pk_bf16_f32 v40, v44, v45
    v_lshlrev_b32 v42, 16, v40
    v_and_b32 v43, 0xffff0000, v40
    v_mul_f32 v42, v42, v46
    v_mul_f32 v43, v43, v47
    v_cvt_pk_bf16_f32 v36, v42, v43
    v_cvt_pk_bf16_f32 v48, v248, v249
    v_cvt_pk_bf16_f32 v49, v250, v251
    v_lshlrev_b32 v50, 16, v48
    v_and_b32 v51, 0xffff0000, v48
    v_mul_f32 v52, v50, v50
    v_mul_f32 v53, v51, v51
    v_fma_f32 v52, v52, s98, v20
    v_fma_f32 v53, v53, s98, v20
    v_mul_f32 v52, v52, v50
    v_mul_f32 v53, v53, v51
    v_exp_f32 v52, v52
    v_exp_f32 v53, v53
    v_lshlrev_b32 v54, 16, v49
    v_add_f32 v52, 1.0, v52
    v_add_f32 v53, 1.0, v53
    v_rcp_f32 v52, v52
    v_rcp_f32 v53, v53
    v_and_b32 v55, 0xffff0000, v49
    v_mul_f32 v52, v52, v50
    v_mul_f32 v53, v53, v51
    v_cvt_pk_bf16_f32 v48, v52, v53
    v_lshlrev_b32 v50, 16, v48
    v_and_b32 v51, 0xffff0000, v48
    v_mul_f32 v50, v50, v54
    v_mul_f32 v51, v51, v55
    v_cvt_pk_bf16_f32 v37, v50, v51
    v_cvt_pk_bf16_f32 v40, v252, v253
    v_cvt_pk_bf16_f32 v41, v254, v255
    v_lshlrev_b32 v42, 16, v40
    v_and_b32 v43, 0xffff0000, v40
    v_mul_f32 v44, v42, v42
    v_mul_f32 v45, v43, v43
    v_fma_f32 v44, v44, s98, v20
    v_fma_f32 v45, v45, s98, v20
    v_mul_f32 v44, v44, v42
    v_mul_f32 v45, v45, v43
    v_exp_f32 v44, v44
    v_exp_f32 v45, v45
    v_lshlrev_b32 v46, 16, v41
    v_add_f32 v44, 1.0, v44
    v_add_f32 v45, 1.0, v45
    v_rcp_f32 v44, v44
    v_rcp_f32 v45, v45
    v_and_b32 v47, 0xffff0000, v41
    v_mul_f32 v44, v44, v42
    v_mul_f32 v45, v45, v43
    v_cvt_pk_bf16_f32 v40, v44, v45
    v_lshlrev_b32 v42, 16, v40
    v_and_b32 v43, 0xffff0000, v40
    v_mul_f32 v42, v42, v46
    v_mul_f32 v43, v43, v47
    v_cvt_pk_bf16_f32 v38, v42, v43
    s_add_u32 s93, s96, 1032192
    buffer_store_dwordx3 v[36:38], v19, s[52:55], s93 offen sc1
    s_add_u32 s96, s96, 2359296
    s_add_u32 s94, s94, 294912
    s_cmp_ge_u32 s95, 6
    s_cselect_b32 s93, 294912, 0
    s_sub_u32 s94, s94, s93
    s_add_u32 s95, s95, 1
    s_cmp_lt_u32 s95, 8
    s_waitcnt lgkmcnt(0)
    s_cbranch_scc1 L_g1_glum
    s_waitcnt vmcnt(0)
    s_barrier
    s_lshl_b32 s83, s95, 8
    s_and_b32 s82, s5, 1
    s_lshl_b32 s82, s82, 7
    s_add_u32 s83, s83, s82
    s_mul_i32 s82, s100, 43
    s_lshr_b32 s82, s82, 9
    s_lshl_b32 s82, s82, 5
    s_add_u32 s83, s83, s82
    s_add_u32 s83, s83, 0x82fff00
    v_mov_b32 v21, 0
    v_mov_b32 v22, 1
    s_cmp_lg_u32 s3, 0
    s_cbranch_scc1 L_sig_27
    s_mov_b64 exec, 1
    buffer_atomic_add v22, v21, s[52:55], s83 offen offset:0
    s_mov_b64 exec, -1
L_sig_27:
L_g1end_m:
    s_sub_u32 s101, s5, 32
    s_branch L_m_ffn
L_m_p3q:
    s_cmp_lt_u32 s5, 32
    s_cbranch_scc1 L_m_p4
    s_sub_u32 s101, s5, 32
L_m_ffn:
    s_mul_i32 s84, s101, 43691
    s_lshr_b32 s84, s84, 19
    s_mul_i32 s85, s84, 12
    s_sub_u32 s85, s101, s85
    s_and_b32 s86, s85, 3
    s_lshr_b32 s85, s85, 2
    v_lshlrev_b32 v0, 4, v1
    v_mul_u32_u24 v2, 48, v1
    s_lshl_b32 s87, s84, 3
    s_lshl_b32 s88, s3, 1
    s_add_u32 s87, s87, s88
    s_mul_i32 s87, s87, 48
    s_mul_i32 s88, s86, 12
    s_add_u32 s87, s87, s88
    s_mul_i32 s87, s87, 3072
    s_add_u32 s87, s87, 0x4000000
    s_mul_i32 s88, s86, 1327104
    s_mul_i32 s89, s85, 384
    s_add_u32 s88, s88, s89
    s_mul_i32 s89, s3, 192
    s_mov_b32 s90, 2731
    v_add_u32 v16, s89, v1
    v_add_u32 v16, 0, v16
    v_mul_u32_u24 v17, s90, v16
    v_lshrrev_b32 v17, 16, v17
    v_mul_u32_u24 v18, 24, v17
    v_sub_u32 v18, v16, v18
    v_bfe_u32 v19, v17, 1, 2
    v_lshlrev_b32 v19, 1, v19
    v_xor_b32 v18, v18, v19
    v_lshlrev_b32 v18, 4, v18
    v_lshrrev_b32 v19, 4, v17
    v_bfe_u32 v20, v17, 2, 1
    v_lshl_add_u32 v19, v19, 1, v20
    v_bfe_u32 v20, v17, 3, 1
    v_and_b32 v21, 3, v17
    v_lshl_add_u32 v20, v20, 2, v21
    v_add_u32 v21, 0, v20
    v_mul_u32_u24 v22, 43, v21
    v_lshrrev_b32 v22, 8, v22
    v_mul_u32_u24 v23, 6, v22
    v_sub_u32 v23, v21, v23
    v_mul_u32_u24 v22, 24, v22
    v_lshrrev_b32 v24, 1, v23
    v_lshl_add_u32 v22, v24, 3, v22
    v_and_b32 v24, 1, v23
    v_add_u32 v22, v22, v24
    v_lshl_add_u32 v22, v19, 1, v22
    v_mul_u32_u24 v22, 1152, v22
    v_add_u32 v4, v22, v18
    v_add_u32 v21, 8, v20
    v_mul_u32_u24 v22, 43, v21
    v_lshrrev_b32 v22, 8, v22
    v_mul_u32_u24 v23, 6, v22
    v_sub_u32 v23, v21, v23
    v_mul_u32_u24 v22, 24, v22
    v_lshrrev_b32 v24, 1, v23
    v_lshl_add_u32 v22, v24, 3, v22
    v_and_b32 v24, 1, v23
    v_add_u32 v22, v22, v24
    v_lshl_add_u32 v22, v19, 1, v22
    v_mul_u32_u24 v22, 1152, v22
    v_add_u32 v7, v22, v18
    v_add_u32 v21, 16, v20
    v_mul_u32_u24 v22, 43, v21
    v_lshrrev_b32 v22, 8, v22
    v_mul_u32_u24 v23, 6, v22
    v_sub_u32 v23, v21, v23
    v_mul_u32_u24 v22, 24, v22
    v_lshrrev_b32 v24, 1, v23
    v_lshl_add_u32 v22, v24, 3, v22
    v_and_b32 v24, 1, v23
    v_add_u32 v22, v22, v24
    v_lshl_add_u32 v22, v19, 1, v22
    v_mul_u32_u24 v22, 1152, v22
    v_add_u32 v10, v22, v18
    v_add_u32 v16, s89, v1
    v_add_u32 v16, 64, v16
    v_mul_u32_u24 v17, s90, v16
    v_lshrrev_b32 v17, 16, v17
    v_mul_u32_u24 v18, 24, v17
    v_sub_u32 v18, v16, v18
    v_bfe_u32 v19, v17, 1, 2
    v_lshlrev_b32 v19, 1, v19
    v_xor_b32 v18, v18, v19
    v_lshlrev_b32 v18, 4, v18
    v_lshrrev_b32 v19, 4, v17
    v_bfe_u32 v20, v17, 2, 1
    v_lshl_add_u32 v19, v19, 1, v20
    v_bfe_u32 v20, v17, 3, 1
    v_and_b32 v21, 3, v17
    v_lshl_add_u32 v20, v20, 2, v21
    v_add_u32 v21, 0, v20
    v_mul_u32_u24 v22, 43, v21
    v_lshrrev_b32 v22, 8, v22
    v_mul_u32_u24 v23, 6, v22
    v_sub_u32 v23, v21, v23
    v_mul_u32_u24 v22, 24, v22
    v_lshrrev_b32 v24, 1, v23
    v_lshl_add_u32 v22, v24, 3, v22
    v_and_b32 v24, 1, v23
    v_add_u32 v22, v22, v24
    v_lshl_add_u32 v22, v19, 1, v22
    v_mul_u32_u24 v22, 1152, v22
    v_add_u32 v5, v22, v18
    v_add_u32 v21, 8, v20
    v_mul_u32_u24 v22, 43, v21
    v_lshrrev_b32 v22, 8, v22
    v_mul_u32_u24 v23, 6, v22
    v_sub_u32 v23, v21, v23
    v_mul_u32_u24 v22, 24, v22
    v_lshrrev_b32 v24, 1, v23
    v_lshl_add_u32 v22, v24, 3, v22
    v_and_b32 v24, 1, v23
    v_add_u32 v22, v22, v24
    v_lshl_add_u32 v22, v19, 1, v22
    v_mul_u32_u24 v22, 1152, v22
    v_add_u32 v8, v22, v18
    v_add_u32 v21, 16, v20
    v_mul_u32_u24 v22, 43, v21
    v_lshrrev_b32 v22, 8, v22
    v_mul_u32_u24 v23, 6, v22
    v_sub_u32 v23, v21, v23
    v_mul_u32_u24 v22, 24, v22
    v_lshrrev_b32 v24, 1, v23
    v_lshl_add_u32 v22, v24, 3, v22
    v_and_b32 v24, 1, v23
    v_add_u32 v22, v22, v24
    v_lshl_add_u32 v22, v19, 1, v22
    v_mul_u32_u24 v22, 1152, v22
    v_add_u32 v11, v22, v18
    v_add_u32 v16, s89, v1
    v_add_u32 v16, 128, v16
    v_mul_u32_u24 v17, s90, v16
    v_lshrrev_b32 v17, 16, v17
    v_mul_u32_u24 v18, 24, v17
    v_sub_u32 v18, v16, v18
    v_bfe_u32 v19, v17, 1, 2
    v_lshlrev_b32 v19, 1, v19
    v_xor_b32 v18, v18, v19
    v_lshlrev_b32 v18, 4, v18
    v_lshrrev_b32 v19, 4, v17
    v_bfe_u32 v20, v17, 2, 1
    v_lshl_add_u32 v19, v19, 1, v20
    v_bfe_u32 v20, v17, 3, 1
    v_and_b32 v21, 3, v17
    v_lshl_add_u32 v20, v20, 2, v21
    v_add_u32 v21, 0, v20
    v_mul_u32_u24 v22, 43, v21
    v_lshrrev_b32 v22, 8, v22
    v_mul_u32_u24 v23, 6, v22
    v_sub_u32 v23, v21, v23
    v_mul_u32_u24 v22, 24, v22
    v_lshrrev_b32 v24, 1, v23
    v_lshl_add_u32 v22, v24, 3, v22
    v_and_b32 v24, 1, v23
    v_add_u32 v22, v22, v24
    v_lshl_add_u32 v22, v19, 1, v22
    v_mul_u32_u24 v22, 1152, v22
    v_add_u32 v6, v22, v18
    v_add_u32 v21, 8, v20
    v_mul_u32_u24 v22, 43, v21
    v_lshrrev_b32 v22, 8, v22
    v_mul_u32_u24 v23, 6, v22
    v_sub_u32 v23, v21, v23
    v_mul_u32_u24 v22, 24, v22
    v_lshrrev_b32 v24, 1, v23
    v_lshl_add_u32 v22, v24, 3, v22
    v_and_b32 v24, 1, v23
    v_add_u32 v22, v22, v24
    v_lshl_add_u32 v22, v19, 1, v22
    v_mul_u32_u24 v22, 1152, v22
    v_add_u32 v9, v22, v18
    v_add_u32 v21, 16, v20
    v_mul_u32_u24 v22, 43, v21
    v_lshrrev_b32 v22, 8, v22
    v_mul_u32_u24 v23, 6, v22
    v_sub_u32 v23, v21, v23
    v_mul_u32_u24 v22, 24, v22
    v_lshrrev_b32 v24, 1, v23
    v_lshl_add_u32 v22, v24, 3, v22
    v_and_b32 v24, 1, v23
    v_add_u32 v22, v22, v24
    v_lshl_add_u32 v22, v19, 1, v22
    v_mul_u32_u24 v22, 1152, v22
    v_add_u32 v12, v22, v18
    v_lshrrev_b32 v16, 4, v1
    v_bfe_u32 v17, v1, 2, 2
    v_and_b32 v18, 3, v1
    v_lshrrev_b32 v19, 1, v16
    v_and_b32 v20, 1, v16
    v_lshlrev_b32 v21, 4, v19
    v_lshl_add_u32 v21, v20, 2, v21
    v_add_u32 v21, v21, v17
    v_mul_u32_u24 v21, 384, v21
    v_lshl_add_u32 v21, v18, 3, v21
    v_add_u32 v21, 8192, v21
    v_lshrrev_b32 v22, 1, v17
    v_lshl_add_u32 v22, v20, 1, v22
    s_and_b32 s89, s3, 1
    s_lshl_b32 s90, s89, 1
    v_xor_b32 v22, s90, v22
    v_lshl_add_u32 v24, v22, 5, v21
    v_xor_b32 v22, 1, v22
    v_lshl_add_u32 v25, v22, 5, v21
    v_add_u32 v26, 61440, v24
    v_add_u32 v27, 61440, v25
    s_lshr_b32 s90, s3, 1
    s_lshl_b32 s91, s90, 12
    v_add_u32 v28, s91, v0
    v_add_u32 v29, 61440, v28
    v_and_b32 v17, 15, v1
    v_mul_u32_u24 v30, 2304, v17
    v_lshl_add_u32 v30, v16, 4, v30
    s_mul_i32 s92, s86, 4718592
    s_lshl_b32 s93, s84, 1
    s_add_u32 s93, s93, s90
    s_mul_i32 s93, s93, 147456
    s_add_u32 s92, s92, s93
    s_mul_i32 s93, s85, 768
    s_add_u32 s92, s92, s93
    s_lshl_b32 s93, s89, 7
    s_add_u32 s92, s92, s93
    s_add_u32 s92, s92, 0x8800000
    s_lshl_b32 s94, s3, 11
    s_mul_i32 s95, s3, 3072
    s_add_u32 s95, s95, 8192
    s_lshl_b32 s82, s84, 7
    s_lshl_b32 s98, s86, 5
    s_add_u32 s82, s82, s98
    s_add_u32 s82, s82, 0x8300000
    v_mov_b32 v16, 0
    s_nop 1
L_wait_28:
    buffer_load_dword v17, v16, s[52:55], s82 offen offset:0 sc1
    s_waitcnt vmcnt(0)
    v_readfirstlane_b32 s83, v17
    s_nop 0
    s_cmp_ge_u32 s83, 12
    s_nop 2
    s_cbranch_scc1 L_waitok_29
    s_sleep 2
    s_sub_u32 s81, s81, 1
    s_cbranch_scc1 L_main_done
    s_branch L_wait_28
L_waitok_29:
    s_mul_i32 s98, s84, 3
    s_add_u32 s98, s98, s85
    s_lshl_b32 s98, s98, 7
    s_add_u32 s98, s98, 0x8303000
    s_barrier
    s_add_u32 m0, s94, 0
    s_add_u32 s96, s87, 0
    buffer_load_dwordx4 v2, s[52:55], s96 offen sc1 lds
    s_add_u32 m0, s94, 1024
    s_add_u32 s96, s87, 147456
    buffer_load_dwordx4 v2, s[52:55], s96 offen sc1 lds
    s_add_u32 s96, s88, 0
    s_add_u32 m0, s95, 0
    s_nop 0
    buffer_load_dwordx4 v4, s[40:43], s96 offen lds
    s_add_u32 m0, s95, 1024
    s_nop 0
    buffer_load_dwordx4 v5, s[40:43], s96 offen lds
    s_add_u32 m0, s95, 2048
    s_nop 0
    buffer_load_dwordx4 v6, s[40:43], s96 offen lds
    s_add_u32 m0, s94, 20480
    s_add_u32 s96, s87, 16
    buffer_load_dwordx4 v2, s[52:55], s96 offen sc1 lds
    s_add_u32 m0, s94, 21504
    s_add_u32 s96, s87, 147472
    buffer_load_dwordx4 v2, s[52:55], s96 offen sc1 lds
    s_add_u32 s96, s88, 0
    s_add_u32 m0, s95, 20480
    s_nop 0
    buffer_load_dwordx4 v7, s[40:43], s96 offen lds
    s_add_u32 m0, s95, 21504
    s_nop 0
    buffer_load_dwordx4 v8, s[40:43], s96 offen lds
    s_add_u32 m0, s95, 22528
    s_nop 0
    buffer_load_dwordx4 v9, s[40:43], s96 offen lds
    s_add_u32 m0, s94, 40960
    s_add_u32 s96, s87, 32
    buffer_load_dwordx4 v2, s[52:55], s96 offen sc1 lds
    s_add_u32 m0, s94, 41984
    s_add_u32 s96, s87, 147488
    buffer_load_dwordx4 v2, s[52:55], s96 offen sc1 lds
    s_add_u32 s96, s88, 0
    s_add_u32 m0, s95, 40960
    s_nop 0
    buffer_load_dwordx4 v10, s[40:43], s96 offen lds
    s_add_u32 m0, s95, 41984
    s_nop 0
    buffer_load_dwordx4 v11, s[40:43], s96 offen lds
    s_add_u32 m0, s95, 43008
    s_nop 0
    buffer_load_dwordx4 v12, s[40:43], s96 offen lds
    s_add_u32 m0, s94, 61440
    s_add_u32 s96, s87, 3072
    buffer_load_dwordx4 v2, s[52:55], s96 offen sc1 lds
    s_add_u32 m0, s94, 62464
    s_add_u32 s96, s87, 150528
    buffer_load_dwordx4 v2, s[52:55], s96 offen sc1 lds
    s_add_u32 s96, s88, 110592
    s_add_u32 m0, s95, 61440
    s_nop 0
    buffer_load_dwordx4 v4, s[40:43], s96 offen lds
    s_add_u32 m0, s95, 62464
    s_nop 0
    buffer_load_dwordx4 v5, s[40:43], s96 offen lds
    s_add_u32 m0, s95, 63488
    s_nop 0
    buffer_load_dwordx4 v6, s[40:43], s96 offen lds
    s_add_u32 m0, s94, 81920
    s_add_u32 s96, s87, 3088
    buffer_load_dwordx4 v2, s[52:55], s96 offen sc1 lds
    s_add_u32 m0, s94, 82944
    s_add_u32 s96, s87, 150544
    buffer_load_dwordx4 v2, s[52:55], s96 offen sc1 lds
    s_add_u32 s96, s88, 110592
    s_add_u32 m0, s95, 81920
    s_nop 0
    buffer_load_dwordx4 v7, s[40:43], s96 offen lds
    s_add_u32 m0, s95, 82944
    s_nop 0
    buffer_load_dwordx4 v8, s[40:43], s96 offen lds
    s_add_u32 m0, s95, 83968
    s_nop 0
    buffer_load_dwordx4 v9, s[40:43], s96 offen lds
    s_add_u32 m0, s94, 102400
    s_add_u32 s96, s87, 3104
    buffer_load_dwordx4 v2, s[52:55], s96 offen sc1 lds
    s_add_u32 m0, s94, 103424
    s_add_u32 s96, s87, 150560
    buffer_load_dwordx4 v2, s[52:55], s96 offen sc1 lds
    s_add_u32 s96, s88, 110592
    s_add_u32 m0, s95, 102400
    s_nop 0
    buffer_load_dwordx4 v10, s[40:43], s96 offen lds
    s_add_u32 m0, s95, 103424
    s_nop 0
    buffer_load_dwordx4 v11, s[40:43], s96 offen lds
    s_add_u32 m0, s95, 104448
    s_nop 0
    buffer_load_dwordx4 v12, s[40:43], s96 offen lds
    v_mov_b64 v[128:129], 0
    v_mov_b64 v[130:131], 0
    v_mov_b64 v[132:133], 0
    v_mov_b64 v[134:135], 0
    v_mov_b64 v[136:137], 0
    v_mov_b64 v[138:139], 0
    v_mov_b64 v[140:141], 0
    v_mov_b64 v[142:143], 0
    v_mov_b64 v[144:145], 0
    v_mov_b64 v[146:147], 0
    v_mov_b64 v[148:149], 0
    v_mov_b64 v[150:151], 0
    v_mov_b64 v[152:153], 0
    v_mov_b64 v[154:155], 0
    v_mov_b64 v[156:157], 0
    v_mov_b64 v[158:159], 0
    v_mov_b64 v[160:161], 0
    v_mov_b64 v[162:163], 0
    v_mov_b64 v[164:165], 0
    v_mov_b64 v[166:167], 0
    v_mov_b64 v[168:169], 0
    v_mov_b64 v[170:171], 0
    v_mov_b64 v[172:173], 0
    v_mov_b64 v[174:175], 0
    v_mov_b64 v[176:177], 0
    v_mov_b64 v[178:179], 0
    v_mov_b64 v[180:181], 0
    v_mov_b64 v[182:183], 0
    v_mov_b64 v[184:185], 0
    v_mov_b64 v[186:187], 0
    v_mov_b64 v[188:189], 0
    v_mov_b64 v[190:191], 0
    v_mov_b64 v[192:193], 0
    v_mov_b64 v[194:195], 0
    v_mov_b64 v[196:197], 0
    v_mov_b64 v[198:199], 0
    v_mov_b64 v[200:201], 0
    v_mov_b64 v[202:203], 0
    v_mov_b64 v[204:205], 0
    v_mov_b64 v[206:207], 0
    v_mov_b64 v[208:209], 0
    v_mov_b64 v[210:211], 0
    v_mov_b64 v[212:213], 0
    v_mov_b64 v[214:215], 0
    v_mov_b64 v[216:217], 0
    v_mov_b64 v[218:219], 0
    v_mov_b64 v[220:221], 0
    v_mov_b64 v[222:223], 0
    s_waitcnt vmcnt(25)
    s_barrier
    ds_read_b128 v[32:35], v28 offset:0
    ds_read_b128 v[36:39], v28 offset:1024
    ds_read_b128 v[40:43], v28 offset:2048
    ds_read_b128 v[44:47], v28 offset:3072
    ds_read_b64_tr_b16 v[64:65], v24 offset:0
    ds_read_b64_tr_b16 v[66:67], v24 offset:3072
    ds_read_b64_tr_b16 v[68:69], v25 offset:0
    ds_read_b64_tr_b16 v[70:71], v25 offset:3072
    ds_read_b64_tr_b16 v[72:73], v24 offset:128
    ds_read_b64_tr_b16 v[74:75], v24 offset:3200
    ds_read_b64_tr_b16 v[76:77], v25 offset:128
    ds_read_b64_tr_b16 v[78:79], v25 offset:3200
    ds_read_b64_tr_b16 v[80:81], v24 offset:256
    ds_read_b64_tr_b16 v[82:83], v24 offset:3328
    ds_read_b64_tr_b16 v[84:85], v25 offset:256
    ds_read_b64_tr_b16 v[86:87], v25 offset:3328
    s_mov_b32 s97, 0
    s_waitcnt lgkmcnt(0)
L_ffn_m:
    s_waitcnt lgkmcnt(0)
    s_waitcnt vmcnt(20)
    s_barrier
    v_mfma_f32_16x16x32_bf16 v[128:131], v[64:67], v[32:35], v[128:131]
    s_add_u32 m0, s94, 0
    s_add_u32 s96, s87, 6144
    buffer_load_dwordx4 v2, s[52:55], s96 offen sc1 lds
    s_add_u32 m0, s94, 1024
    s_add_u32 s96, s87, 153600
    buffer_load_dwordx4 v2, s[52:55], s96 offen sc1 lds
    s_add_u32 s96, s88, 221184
    s_add_u32 m0, s95, 0
    s_nop 0
    buffer_load_dwordx4 v4, s[40:43], s96 offen lds
    s_add_u32 m0, s95, 1024
    s_nop 0
    buffer_load_dwordx4 v5, s[40:43], s96 offen lds
    s_add_u32 m0, s95, 2048
    s_nop 0
    buffer_load_dwordx4 v6, s[40:43], s96 offen lds
    v_mfma_f32_16x16x32_bf16 v[132:135], v[68:71], v[32:35], v[132:135]
    ds_read_b128 v[48:51], v28 offset:20480
    v_mfma_f32_16x16x32_bf16 v[136:139], v[72:75], v[32:35], v[136:139]
    ds_read_b128 v[52:55], v28 offset:21504
    v_mfma_f32_16x16x32_bf16 v[140:143], v[76:79], v[32:35], v[140:143]
    ds_read_b128 v[56:59], v28 offset:22528
    v_mfma_f32_16x16x32_bf16 v[144:147], v[80:83], v[32:35], v[144:147]
    ds_read_b128 v[60:63], v28 offset:23552
    v_mfma_f32_16x16x32_bf16 v[148:151], v[84:87], v[32:35], v[148:151]
    ds_read_b64_tr_b16 v[88:89], v24 offset:20480
    v_mfma_f32_16x16x32_bf16 v[152:155], v[64:67], v[36:39], v[152:155]
    ds_read_b64_tr_b16 v[90:91], v24 offset:23552
    v_mfma_f32_16x16x32_bf16 v[156:159], v[68:71], v[36:39], v[156:159]
    ds_read_b64_tr_b16 v[92:93], v25 offset:20480
    v_mfma_f32_16x16x32_bf16 v[160:163], v[72:75], v[36:39], v[160:163]
    ds_read_b64_tr_b16 v[94:95], v25 offset:23552
    v_mfma_f32_16x16x32_bf16 v[164:167], v[76:79], v[36:39], v[164:167]
    ds_read_b64_tr_b16 v[96:97], v24 offset:20608
    v_mfma_f32_16x16x32_bf16 v[168:171], v[80:83], v[36:39], v[168:171]
    ds_read_b64_tr_b16 v[98:99], v24 offset:23680
    v_mfma_f32_16x16x32_bf16 v[172:175], v[84:87], v[36:39], v[172:175]
    ds_read_b64_tr_b16 v[100:101], v25 offset:20608
    v_mfma_f32_16x16x32_bf16 v[176:179], v[64:67], v[40:43], v[176:179]
    ds_read_b64_tr_b16 v[102:103], v25 offset:23680
    v_mfma_f32_16x16x32_bf16 v[180:183], v[68:71], v[40:43], v[180:183]
    ds_read_b64_tr_b16 v[104:105], v24 offset:20736
    v_mfma_f32_16x16x32_bf16 v[184:187], v[72:75], v[40:43], v[184:187]
    ds_read_b64_tr_b16 v[106:107], v24 offset:23808
    v_mfma_f32_16x16x32_bf16 v[188:191], v[76:79], v[40:43], v[188:191]
    ds_read_b64_tr_b16 v[108:109], v25 offset:20736
    v_mfma_f32_16x16x32_bf16 v[192:195], v[80:83], v[40:43], v[192:195]
    ds_read_b64_tr_b16 v[110:111], v25 offset:23808
    v_mfma_f32_16x16x32_bf16 v[196:199], v[84:87], v[40:43], v[196:199]
    v_mfma_f32_16x16x32_bf16 v[200:203], v[64:67], v[44:47], v[200:203]
    v_mfma_f32_16x16x32_bf16 v[204:207], v[68:71], v[44:47], v[204:207]
    v_mfma_f32_16x16x32_bf16 v[208:211], v[72:75], v[44:47], v[208:211]
    v_mfma_f32_16x16x32_bf16 v[212:215], v[76:79], v[44:47], v[212:215]
    v_mfma_f32_16x16x32_bf16 v[216:219], v[80:83], v[44:47], v[216:219]
    v_mfma_f32_16x16x32_bf16 v[220:223], v[84:87], v[44:47], v[220:223]
    s_waitcnt lgkmcnt(0)
    s_waitcnt vmcnt(20)
    s_barrier
    v_mfma_f32_16x16x32_bf16 v[128:131], v[88:91], v[48:51], v[128:131]
    s_add_u32 m0, s94, 20480
    s_add_u32 s96, s87, 6160
    buffer_load_dwordx4 v2, s[52:55], s96 offen sc1 lds
    s_add_u32 m0, s94, 21504
    s_add_u32 s96, s87, 153616
    buffer_load_dwordx4 v2, s[52:55], s96 offen sc1 lds
    s_add_u32 s96, s88, 221184
    s_add_u32 m0, s95, 20480
    s_nop 0
    buffer_load_dwordx4 v7, s[40:43], s96 offen lds
    s_add_u32 m0, s95, 21504
    s_nop 0
    buffer_load_dwordx4 v8, s[40:43], s96 offen lds
    s_add_u32 m0, s95, 22528
    s_nop 0
    buffer_load_dwordx4 v9, s[40:43], s96 offen lds
    v_mfma_f32_16x16x32_bf16 v[132:135], v[92:95], v[48:51], v[132:135]
    ds_read_b128 v[32:35], v28 offset:40960
    v_mfma_f32_16x16x32_bf16 v[136:139], v[96:99], v[48:51], v[136:139]
    ds_read_b128 v[36:39], v28 offset:41984
    v_mfma_f32_16x16x32_bf16 v[140:143], v[100:103], v[48:51], v[140:143]
    ds_read_b128 v[40:43], v28 offset:43008
    v_mfma_f32_16x16x32_bf16 v[144:147], v[104:107], v[48:51], v[144:147]
    ds_read_b128 v[44:47], v28 offset:44032
    v_mfma_f32_16x16x32_bf16 v[148:151], v[108:111], v[48:51], v[148:151]
    ds_read_b64_tr_b16 v[64:65], v24 offset:40960
    v_mfma_f32_16x16x32_bf16 v[152:155], v[88:91], v[52:55], v[152:155]
    ds_read_b64_tr_b16 v[66:67], v24 offset:44032
    v_mfma_f32_16x16x32_bf16 v[156:159], v[92:95], v[52:55], v[156:159]
    ds_read_b64_tr_b16 v[68:69], v25 offset:40960
    v_mfma_f32_16x16x32_bf16 v[160:163], v[96:99], v[52:55], v[160:163]
    ds_read_b64_tr_b16 v[70:71], v25 offset:44032
    v_mfma_f32_16x16x32_bf16 v[164:167], v[100:103], v[52:55], v[164:167]
    ds_read_b64_tr_b16 v[72:73], v24 offset:41088
    v_mfma_f32_16x16x32_bf16 v[168:171], v[104:107], v[52:55], v[168:171]
    ds_read_b64_tr_b16 v[74:75], v24 offset:44160
    v_mfma_f32_16x16x32_bf16 v[172:175], v[108:111], v[52:55], v[172:175]
    ds_read_b64_tr_b16 v[76:77], v25 offset:41088
    v_mfma_f32_16x16x32_bf16 v[176:179], v[88:91], v[56:59], v[176:179]
    ds_read_b64_tr_b16 v[78:79], v25 offset:44160
    v_mfma_f32_16x16x32_bf16 v[180:183], v[92:95], v[56:59], v[180:183]
    ds_read_b64_tr_b16 v[80:81], v24 offset:41216
    v_mfma_f32_16x16x32_bf16 v[184:187], v[96:99], v[56:59], v[184:187]
    ds_read_b64_tr_b16 v[82:83], v24 offset:44288
    v_mfma_f32_16x16x32_bf16 v[188:191], v[100:103], v[56:59], v[188:191]
    ds_read_b64_tr_b16 v[84:85], v25 offset:41216
    v_mfma_f32_16x16x32_bf16 v[192:195], v[104:107], v[56:59], v[192:195]
    ds_read_b64_tr_b16 v[86:87], v25 offset:44288
    v_mfma_f32_16x16x32_bf16 v[196:199], v[108:111], v[56:59], v[196:199]
    v_mfma_f32_16x16x32_bf16 v[200:203], v[88:91], v[60:63], v[200:203]
    v_mfma_f32_16x16x32_bf16 v[204:207], v[92:95], v[60:63], v[204:207]
    v_mfma_f32_16x16x32_bf16 v[208:211], v[96:99], v[60:63], v[208:211]
    v_mfma_f32_16x16x32_bf16 v[212:215], v[100:103], v[60:63], v[212:215]
    v_mfma_f32_16x16x32_bf16 v[216:219], v[104:107], v[60:63], v[216:219]
    v_mfma_f32_16x16x32_bf16 v[220:223], v[108:111], v[60:63], v[220:223]
    s_waitcnt lgkmcnt(0)
    s_waitcnt vmcnt(20)
    s_barrier
    v_mfma_f32_16x16x32_bf16 v[128:131], v[64:67], v[32:35], v[128:131]
    s_add_u32 m0, s94, 40960
    s_add_u32 s96, s87, 6176
    buffer_load_dwordx4 v2, s[52:55], s96 offen sc1 lds
    s_add_u32 m0, s94, 41984
    s_add_u32 s96, s87, 153632
    buffer_load_dwordx4 v2, s[52:55], s96 offen sc1 lds
    s_add_u32 s96, s88, 221184
    s_add_u32 m0, s95, 40960
    s_nop 0
    buffer_load_dwordx4 v10, s[40:43], s96 offen lds
    s_add_u32 m0, s95, 41984
    s_nop 0
    buffer_load_dwordx4 v11, s[40:43], s96 offen lds
    s_add_u32 m0, s95, 43008
    s_nop 0
    buffer_load_dwordx4 v12, s[40:43], s96 offen lds
    v_mfma_f32_16x16x32_bf16 v[132:135], v[68:71], v[32:35], v[132:135]
    ds_read_b128 v[48:51], v29 offset:0
    v_mfma_f32_16x16x32_bf16 v[136:139], v[72:75], v[32:35], v[136:139]
    ds_read_b128 v[52:55], v29 offset:1024
    v_mfma_f32_16x16x32_bf16 v[140:143], v[76:79], v[32:35], v[140:143]
    ds_read_b128 v[56:59], v29 offset:2048
    v_mfma_f32_16x16x32_bf16 v[144:147], v[80:83], v[32:35], v[144:147]
    ds_read_b128 v[60:63], v29 offset:3072
    v_mfma_f32_16x16x32_bf16 v[148:151], v[84:87], v[32:35], v[148:151]
    ds_read_b64_tr_b16 v[88:89], v26 offset:0
    v_mfma_f32_16x16x32_bf16 v[152:155], v[64:67], v[36:39], v[152:155]
    ds_read_b64_tr_b16 v[90:91], v26 offset:3072
    v_mfma_f32_16x16x32_bf16 v[156:159], v[68:71], v[36:39], v[156:159]
    ds_read_b64_tr_b16 v[92:93], v27 offset:0
    v_mfma_f32_16x16x32_bf16 v[160:163], v[72:75], v[36:39], v[160:163]
    ds_read_b64_tr_b16 v[94:95], v27 offset:3072
    v_mfma_f32_16x16x32_bf16 v[164:167], v[76:79], v[36:39], v[164:167]
    ds_read_b64_tr_b16 v[96:97], v26 offset:128
    v_mfma_f32_16x16x32_bf16 v[168:171], v[80:83], v[36:39], v[168:171]
    ds_read_b64_tr_b16 v[98:99], v26 offset:3200
    v_mfma_f32_16x16x32_bf16 v[172:175], v[84:87], v[36:39], v[172:175]
    ds_read_b64_tr_b16 v[100:101], v27 offset:128
    v_mfma_f32_16x16x32_bf16 v[176:179], v[64:67], v[40:43], v[176:179]
    ds_read_b64_tr_b16 v[102:103], v27 offset:3200
    v_mfma_f32_16x16x32_bf16 v[180:183], v[68:71], v[40:43], v[180:183]
    ds_read_b64_tr_b16 v[104:105], v26 offset:256
    v_mfma_f32_16x16x32_bf16 v[184:187], v[72:75], v[40:43], v[184:187]
    ds_read_b64_tr_b16 v[106:107], v26 offset:3328
    v_mfma_f32_16x16x32_bf16 v[188:191], v[76:79], v[40:43], v[188:191]
    ds_read_b64_tr_b16 v[108:109], v27 offset:256
    v_mfma_f32_16x16x32_bf16 v[192:195], v[80:83], v[40:43], v[192:195]
    ds_read_b64_tr_b16 v[110:111], v27 offset:3328
    v_mfma_f32_16x16x32_bf16 v[196:199], v[84:87], v[40:43], v[196:199]
    v_mfma_f32_16x16x32_bf16 v[200:203], v[64:67], v[44:47], v[200:203]
    v_mfma_f32_16x16x32_bf16 v[204:207], v[68:71], v[44:47], v[204:207]
    v_mfma_f32_16x16x32_bf16 v[208:211], v[72:75], v[44:47], v[208:211]
    v_mfma_f32_16x16x32_bf16 v[212:215], v[76:79], v[44:47], v[212:215]
    v_mfma_f32_16x16x32_bf16 v[216:219], v[80:83], v[44:47], v[216:219]
    v_mfma_f32_16x16x32_bf16 v[220:223], v[84:87], v[44:47], v[220:223]
    s_waitcnt lgkmcnt(0)
    s_waitcnt vmcnt(20)
    s_barrier
    v_mfma_f32_16x16x32_bf16 v[128:131], v[88:91], v[48:51], v[128:131]
    s_add_u32 m0, s94, 61440
    s_add_u32 s96, s87, 9216
    buffer_load_dwordx4 v2, s[52:55], s96 offen sc1 lds
    s_add_u32 m0, s94, 62464
    s_add_u32 s96, s87, 156672
    buffer_load_dwordx4 v2, s[52:55], s96 offen sc1 lds
    s_add_u32 s96, s88, 331776
    s_add_u32 m0, s95, 61440
    s_nop 0
    buffer_load_dwordx4 v4, s[40:43], s96 offen lds
    s_add_u32 m0, s95, 62464
    s_nop 0
    buffer_load_dwordx4 v5, s[40:43], s96 offen lds
    s_add_u32 m0, s95, 63488
    s_nop 0
    buffer_load_dwordx4 v6, s[40:43], s96 offen lds
    v_mfma_f32_16x16x32_bf16 v[132:135], v[92:95], v[48:51], v[132:135]
    ds_read_b128 v[32:35], v29 offset:20480
    v_mfma_f32_16x16x32_bf16 v[136:139], v[96:99], v[48:51], v[136:139]
    ds_read_b128 v[36:39], v29 offset:21504
    v_mfma_f32_16x16x32_bf16 v[140:143], v[100:103], v[48:51], v[140:143]
    ds_read_b128 v[40:43], v29 offset:22528
    v_mfma_f32_16x16x32_bf16 v[144:147], v[104:107], v[48:51], v[144:147]
    ds_read_b128 v[44:47], v29 offset:23552
    v_mfma_f32_16x16x32_bf16 v[148:151], v[108:111], v[48:51], v[148:151]
    ds_read_b64_tr_b16 v[64:65], v26 offset:20480
    v_mfma_f32_16x16x32_bf16 v[152:155], v[88:91], v[52:55], v[152:155]
    ds_read_b64_tr_b16 v[66:67], v26 offset:23552
    v_mfma_f32_16x16x32_bf16 v[156:159], v[92:95], v[52:55], v[156:159]
    ds_read_b64_tr_b16 v[68:69], v27 offset:20480
    v_mfma_f32_16x16x32_bf16 v[160:163], v[96:99], v[52:55], v[160:163]
    ds_read_b64_tr_b16 v[70:71], v27 offset:23552
    v_mfma_f32_16x16x32_bf16 v[164:167], v[100:103], v[52:55], v[164:167]
    ds_read_b64_tr_b16 v[72:73], v26 offset:20608
    v_mfma_f32_16x16x32_bf16 v[168:171], v[104:107], v[52:55], v[168:171]
    ds_read_b64_tr_b16 v[74:75], v26 offset:23680
    v_mfma_f32_16x16x32_bf16 v[172:175], v[108:111], v[52:55], v[172:175]
    ds_read_b64_tr_b16 v[76:77], v27 offset:20608
    v_mfma_f32_16x16x32_bf16 v[176:179], v[88:91], v[56:59], v[176:179]
    ds_read_b64_tr_b16 v[78:79], v27 offset:23680
    v_mfma_f32_16x16x32_bf16 v[180:183], v[92:95], v[56:59], v[180:183]
    ds_read_b64_tr_b16 v[80:81], v26 offset:20736
    v_mfma_f32_16x16x32_bf16 v[184:187], v[96:99], v[56:59], v[184:187]
    ds_read_b64_tr_b16 v[82:83], v26 offset:23808
    v_mfma_f32_16x16x32_bf16 v[188:191], v[100:103], v[56:59], v[188:191]
    ds_read_b64_tr_b16 v[84:85], v27 offset:20736
    v_mfma_f32_16x16x32_bf16 v[192:195], v[104:107], v[56:59], v[192:195]
    ds_read_b64_tr_b16 v[86:87], v27 offset:23808
    v_mfma_f32_16x16x32_bf16 v[196:199], v[108:111], v[56:59], v[196:199]
    v_mfma_f32_16x16x32_bf16 v[200:203], v[88:91], v[60:63], v[200:203]
    v_mfma_f32_16x16x32_bf16 v[204:207], v[92:95], v[60:63], v[204:207]
    v_mfma_f32_16x16x32_bf16 v[208:211], v[96:99], v[60:63], v[208:211]
    v_mfma_f32_16x16x32_bf16 v[212:215], v[100:103], v[60:63], v[212:215]
    v_mfma_f32_16x16x32_bf16 v[216:219], v[104:107], v[60:63], v[216:219]
    v_mfma_f32_16x16x32_bf16 v[220:223], v[108:111], v[60:63], v[220:223]
    s_waitcnt lgkmcnt(0)
    s_waitcnt vmcnt(20)
    s_barrier
    v_mfma_f32_16x16x32_bf16 v[128:131], v[64:67], v[32:35], v[128:131]
    s_add_u32 m0, s94, 81920
    s_add_u32 s96, s87, 9232
    buffer_load_dwordx4 v2, s[52:55], s96 offen sc1 lds
    s_add_u32 m0, s94, 82944
    s_add_u32 s96, s87, 156688
    buffer_load_dwordx4 v2, s[52:55], s96 offen sc1 lds
    s_add_u32 s96, s88, 331776
    s_add_u32 m0, s95, 81920
    s_nop 0
    buffer_load_dwordx4 v7, s[40:43], s96 offen lds
    s_add_u32 m0, s95, 82944
    s_nop 0
    buffer_load_dwordx4 v8, s[40:43], s96 offen lds
    s_add_u32 m0, s95, 83968
    s_nop 0
    buffer_load_dwordx4 v9, s[40:43], s96 offen lds
    v_mfma_f32_16x16x32_bf16 v[132:135], v[68:71], v[32:35], v[132:135]
    ds_read_b128 v[48:51], v29 offset:40960
    v_mfma_f32_16x16x32_bf16 v[136:139], v[72:75], v[32:35], v[136:139]
    ds_read_b128 v[52:55], v29 offset:41984
    v_mfma_f32_16x16x32_bf16 v[140:143], v[76:79], v[32:35], v[140:143]
    ds_read_b128 v[56:59], v29 offset:43008
    v_mfma_f32_16x16x32_bf16 v[144:147], v[80:83], v[32:35], v[144:147]
    ds_read_b128 v[60:63], v29 offset:44032
    v_mfma_f32_16x16x32_bf16 v[148:151], v[84:87], v[32:35], v[148:151]
    ds_read_b64_tr_b16 v[88:89], v26 offset:40960
    v_mfma_f32_16x16x32_bf16 v[152:155], v[64:67], v[36:39], v[152:155]
    ds_read_b64_tr_b16 v[90:91], v26 offset:44032
    v_mfma_f32_16x16x32_bf16 v[156:159], v[68:71], v[36:39], v[156:159]
    ds_read_b64_tr_b16 v[92:93], v27 offset:40960
    v_mfma_f32_16x16x32_bf16 v[160:163], v[72:75], v[36:39], v[160:163]
    ds_read_b64_tr_b16 v[94:95], v27 offset:44032
    v_mfma_f32_16x16x32_bf16 v[164:167], v[76:79], v[36:39], v[164:167]
    ds_read_b64_tr_b16 v[96:97], v26 offset:41088
    v_mfma_f32_16x16x32_bf16 v[168:171], v[80:83], v[36:39], v[168:171]
    ds_read_b64_tr_b16 v[98:99], v26 offset:44160
    v_mfma_f32_16x16x32_bf16 v[172:175], v[84:87], v[36:39], v[172:175]
    ds_read_b64_tr_b16 v[100:101], v27 offset:41088
    v_mfma_f32_16x16x32_bf16 v[176:179], v[64:67], v[40:43], v[176:179]
    ds_read_b64_tr_b16 v[102:103], v27 offset:44160
    v_mfma_f32_16x16x32_bf16 v[180:183], v[68:71], v[40:43], v[180:183]
    ds_read_b64_tr_b16 v[104:105], v26 offset:41216
    v_mfma_f32_16x16x32_bf16 v[184:187], v[72:75], v[40:43], v[184:187]
    ds_read_b64_tr_b16 v[106:107], v26 offset:44288
    v_mfma_f32_16x16x32_bf16 v[188:191], v[76:79], v[40:43], v[188:191]
    ds_read_b64_tr_b16 v[108:109], v27 offset:41216
    v_mfma_f32_16x16x32_bf16 v[192:195], v[80:83], v[40:43], v[192:195]
    ds_read_b64_tr_b16 v[110:111], v27 offset:44288
    v_mfma_f32_16x16x32_bf16 v[196:199], v[84:87], v[40:43], v[196:199]
    v_mfma_f32_16x16x32_bf16 v[200:203], v[64:67], v[44:47], v[200:203]
    v_mfma_f32_16x16x32_bf16 v[204:207], v[68:71], v[44:47], v[204:207]
    v_mfma_f32_16x16x32_bf16 v[208:211], v[72:75], v[44:47], v[208:211]
    v_mfma_f32_16x16x32_bf16 v[212:215], v[76:79], v[44:47], v[212:215]
    v_mfma_f32_16x16x32_bf16 v[216:219], v[80:83], v[44:47], v[216:219]
    v_mfma_f32_16x16x32_bf16 v[220:223], v[84:87], v[44:47], v[220:223]
    s_waitcnt lgkmcnt(0)
    s_waitcnt vmcnt(20)
    s_barrier
    v_mfma_f32_16x16x32_bf16 v[128:131], v[88:91], v[48:51], v[128:131]
    s_add_u32 m0, s94, 102400
    s_add_u32 s96, s87, 9248
    buffer_load_dwordx4 v2, s[52:55], s96 offen sc1 lds
    s_add_u32 m0, s94, 103424
    s_add_u32 s96, s87, 156704
    buffer_load_dwordx4 v2, s[52:55], s96 offen sc1 lds
    s_add_u32 s96, s88, 331776
    s_add_u32 m0, s95, 102400
    s_nop 0
    buffer_load_dwordx4 v10, s[40:43], s96 offen lds
    s_add_u32 m0, s95, 103424
    s_nop 0
    buffer_load_dwordx4 v11, s[40:43], s96 offen lds
    s_add_u32 m0, s95, 104448
    s_nop 0
    buffer_load_dwordx4 v12, s[40:43], s96 offen lds
    v_mfma_f32_16x16x32_bf16 v[132:135], v[92:95], v[48:51], v[132:135]
    ds_read_b128 v[32:35], v28 offset:0
    v_mfma_f32_16x16x32_bf16 v[136:139], v[96:99], v[48:51], v[136:139]
    ds_read_b128 v[36:39], v28 offset:1024
    v_mfma_f32_16x16x32_bf16 v[140:143], v[100:103], v[48:51], v[140:143]
    ds_read_b128 v[40:43], v28 offset:2048
    v_mfma_f32_16x16x32_bf16 v[144:147], v[104:107], v[48:51], v[144:147]
    ds_read_b128 v[44:47], v28 offset:3072
    v_mfma_f32_16x16x32_bf16 v[148:151], v[108:111], v[48:51], v[148:151]
    ds_read_b64_tr_b16 v[64:65], v24 offset:0
    v_mfma_f32_16x16x32_bf16 v[152:155], v[88:91], v[52:55], v[152:155]
    ds_read_b64_tr_b16 v[66:67], v24 offset:3072
    v_mfma_f32_16x16x32_bf16 v[156:159], v[92:95], v[52:55], v[156:159]
    ds_read_b64_tr_b16 v[68:69], v25 offset:0
    v_mfma_f32_16x16x32_bf16 v[160:163], v[96:99], v[52:55], v[160:163]
    ds_read_b64_tr_b16 v[70:71], v25 offset:3072
    v_mfma_f32_16x16x32_bf16 v[164:167], v[100:103], v[52:55], v[164:167]
    ds_read_b64_tr_b16 v[72:73], v24 offset:128
    v_mfma_f32_16x16x32_bf16 v[168:171], v[104:107], v[52:55], v[168:171]
    ds_read_b64_tr_b16 v[74:75], v24 offset:3200
    v_mfma_f32_16x16x32_bf16 v[172:175], v[108:111], v[52:55], v[172:175]
    ds_read_b64_tr_b16 v[76:77], v25 offset:128
    v_mfma_f32_16x16x32_bf16 v[176:179], v[88:91], v[56:59], v[176:179]
    ds_read_b64_tr_b16 v[78:79], v25 offset:3200
    v_mfma_f32_16x16x32_bf16 v[180:183], v[92:95], v[56:59], v[180:183]
    ds_read_b64_tr_b16 v[80:81], v24 offset:256
    v_mfma_f32_16x16x32_bf16 v[184:187], v[96:99], v[56:59], v[184:187]
    ds_read_b64_tr_b16 v[82:83], v24 offset:3328
    v_mfma_f32_16x16x32_bf16 v[188:191], v[100:103], v[56:59], v[188:191]
    ds_read_b64_tr_b16 v[84:85], v25 offset:256
    v_mfma_f32_16x16x32_bf16 v[192:195], v[104:107], v[56:59], v[192:195]
    ds_read_b64_tr_b16 v[86:87], v25 offset:3328
    v_mfma_f32_16x16x32_bf16 v[196:199], v[108:111], v[56:59], v[196:199]
    v_mfma_f32_16x16x32_bf16 v[200:203], v[88:91], v[60:63], v[200:203]
    v_mfma_f32_16x16x32_bf16 v[204:207], v[92:95], v[60:63], v[204:207]
    v_mfma_f32_16x16x32_bf16 v[208:211], v[96:99], v[60:63], v[208:211]
    v_mfma_f32_16x16x32_bf16 v[212:215], v[100:103], v[60:63], v[212:215]
    v_mfma_f32_16x16x32_bf16 v[216:219], v[104:107], v[60:63], v[216:219]
    v_mfma_f32_16x16x32_bf16 v[220:223], v[108:111], v[60:63], v[220:223]
    s_cmp_lt_u32 s97, 4
    s_cselect_b32 s96, 6144, 0
    s_add_u32 s87, s87, s96
    s_add_u32 s88, s88, 221184
    s_add_u32 s97, s97, 1
    s_cmp_lt_u32 s97, 6
    s_nop 1
    s_waitcnt lgkmcnt(0)
    s_cbranch_scc1 L_ffn_m
    s_add_u32 s96, s92, 0
    buffer_store_dwordx4 v[128:131], v30, s[52:55], s96 offen offset:0 sc1
    buffer_store_dwordx4 v[132:135], v30, s[52:55], s96 offen offset:64 sc1
    buffer_store_dwordx4 v[136:139], v30, s[52:55], s96 offen offset:256 sc1
    buffer_store_dwordx4 v[140:143], v30, s[52:55], s96 offen offset:320 sc1
    buffer_store_dwordx4 v[144:147], v30, s[52:55], s96 offen offset:512 sc1
    buffer_store_dwordx4 v[148:151], v30, s[52:55], s96 offen offset:576 sc1
    s_add_u32 s96, s92, 36864
    buffer_store_dwordx4 v[152:155], v30, s[52:55], s96 offen offset:0 sc1
    buffer_store_dwordx4 v[156:159], v30, s[52:55], s96 offen offset:64 sc1
    buffer_store_dwordx4 v[160:163], v30, s[52:55], s96 offen offset:256 sc1
    buffer_store_dwordx4 v[164:167], v30, s[52:55], s96 offen offset:320 sc1
    buffer_store_dwordx4 v[168:171], v30, s[52:55], s96 offen offset:512 sc1
    buffer_store_dwordx4 v[172:175], v30, s[52:55], s96 offen offset:576 sc1
    s_add_u32 s96, s92, 73728
    buffer_store_dwordx4 v[176:179], v30, s[52:55], s96 offen offset:0 sc1
    buffer_store_dwordx4 v[180:183], v30, s[52:55], s96 offen offset:64 sc1
    buffer_store_dwordx4 v[184:187], v30, s[52:55], s96 offen offset:256 sc1
    buffer_store_dwordx4 v[188:191], v30, s[52:55], s96 offen offset:320 sc1
    buffer_store_dwordx4 v[192:195], v30, s[52:55], s96 offen offset:512 sc1
    buffer_store_dwordx4 v[196:199], v30, s[52:55], s96 offen offset:576 sc1
    s_add_u32 s96, s92, 110592
    buffer_store_dwordx4 v[200:203], v30, s[52:55], s96 offen offset:0 sc1
    buffer_store_dwordx4 v[204:207], v30, s[52:55], s96 offen offset:64 sc1
    buffer_store_dwordx4 v[208:211], v30, s[52:55], s96 offen offset:256 sc1
    buffer_store_dwordx4 v[212:215], v30, s[52:55], s96 offen offset:320 sc1
    buffer_store_dwordx4 v[216:219], v30, s[52:55], s96 offen offset:512 sc1
    buffer_store_dwordx4 v[220:223], v30, s[52:55], s96 offen offset:576 sc1
    s_waitcnt vmcnt(0)
    s_barrier
    v_mov_b32 v8, 0
    v_mov_b32 v9, 1
    s_cmp_lg_u32 s3, 0
    s_cbranch_scc1 L_sig_30
    s_mov_b64 exec, 1
    buffer_atomic_add v9, v8, s[52:55], s98 offen offset:0
    s_mov_b64 exec, -1
L_sig_30:
    s_cmp_lt_u32 s5, 128
    s_cbranch_scc1 L_m_p4
    s_sub_u32 s5, s5, 128
    s_mov_b32 s100, 8
    s_mov_b32 s101, 48
    s_mov_b32 s97, 0
    s_branch L_m_wf2
L_m_p4:
    s_cmp_ge_u32 s5, 56
    s_cbranch_scc1 L_m_wf
    v_lshlrev_b32 v0, 4, v1
    v_lshrrev_b32 v4, 4, v1
    v_and_b32 v5, 15, v1
    v_bfe_u32 v2, v1, 2, 2
    v_and_b32 v3, 1, v1
    v_lshl_add_u32 v2, v2, 1, v3
    v_lshlrev_b32 v2, 4, v2
    v_lshl_add_u32 v2, v4, 8, v2
    v_lshl_add_u32 v6, v4, 2, 0
    v_cmp_le_u32 s[60:61], v6, v5
    v_lshl_add_u32 v6, v4, 2, 1
    v_cmp_le_u32 s[62:63], v6, v5
    v_lshl_add_u32 v6, v4, 2, 2
    v_cmp_le_u32 s[64:65], v6, v5
    v_lshl_add_u32 v6, v4, 2, 3
    v_cmp_le_u32 s[66:67], v6, v5
    v_cmp_gt_u32 s[68:69], 2, v4
    s_mov_b32 s70, 0x3db504f3
    s_mov_b32 s71, 0x3fb8aa3b
    v_mov_b32 v7, 0xce6e6b28
    s_lshl_b32 s5, s5, 2
    s_add_u32 s5, s5, s3
L_m_att:
    s_lshr_b32 s82, s5, 7
    s_lshl_b32 s82, s82, 2
    v_mov_b32 v8, 0
    s_nop 1
L_wait_31:
    buffer_load_dword v9, v8, s[48:51], s82 offen offset:32 sc1
    s_waitcnt vmcnt(0)
    v_readfirstlane_b32 s83, v9
    s_nop 0
    s_cmp_ge_u32 s83, 64
    s_nop 2
    s_cbranch_scc1 L_waitok_32
    s_sleep 2
    s_sub_u32 s81, s81, 1
    s_cbranch_scc1 L_main_done
    s_branch L_wait_31
L_waitok_32:
    s_lshl_b32 s84, s5, 13
    s_add_u32 s85, s84, 0x400000
    s_add_u32 s88, s85, 4096
    buffer_load_dwordx4 v[16:19], v0, s[52:55], s85 offen offset:0 sc1
    buffer_load_dwordx4 v[20:23], v0, s[52:55], s85 offen offset:1024 sc1
    buffer_load_dwordx4 v[24:27], v0, s[52:55], s85 offen offset:2048 sc1
    buffer_load_dwordx4 v[28:31], v0, s[52:55], s85 offen offset:3072 sc1
    buffer_load_dwordx4 v[32:35], v0, s[52:55], s88 offen offset:0 sc1
    buffer_load_dwordx4 v[36:39], v0, s[52:55], s88 offen offset:1024 sc1
    buffer_load_dwordx4 v[40:43], v0, s[52:55], s88 offen offset:2048 sc1
    buffer_load_dwordx4 v[44:47], v0, s[52:55], s88 offen offset:3072 sc1
    s_add_u32 s86, s84, 0x1800000
    s_add_u32 s88, s86, 4096
    buffer_load_dwordx4 v[48:51], v0, s[52:55], s86 offen offset:0 sc1
    buffer_load_dwordx4 v[52:55], v0, s[52:55], s86 offen offset:1024 sc1
    buffer_load_dwordx4 v[56:59], v0, s[52:55], s86 offen offset:2048 sc1
    buffer_load_dwordx4 v[60:63], v0, s[52:55], s86 offen offset:3072 sc1
    buffer_load_dwordx4 v[64:67], v0, s[52:55], s88 offen offset:0 sc1
    buffer_load_dwordx4 v[68:71], v0, s[52:55], s88 offen offset:1024 sc1
    buffer_load_dwordx4 v[72:75], v0, s[52:55], s88 offen offset:2048 sc1
    buffer_load_dwordx4 v[76:79], v0, s[52:55], s88 offen offset:3072 sc1
    s_add_u32 s87, s84, 0x2c00000
    s_add_u32 s88, s87, 4096
    buffer_load_dwordx4 v[80:83], v0, s[52:55], s87 offen offset:0 sc1
    buffer_load_dwordx4 v[84:87], v0, s[52:55], s87 offen offset:1024 sc1
    buffer_load_dwordx4 v[88:91], v0, s[52:55], s87 offen offset:2048 sc1
    buffer_load_dwordx4 v[92:95], v0, s[52:55], s87 offen offset:3072 sc1
    buffer_load_dwordx4 v[96:99], v0, s[52:55], s88 offen offset:0 sc1
    buffer_load_dwordx4 v[100:103], v0, s[52:55], s88 offen offset:1024 sc1
    buffer_load_dwordx4 v[104:107], v0, s[52:55], s88 offen offset:2048 sc1
    buffer_load_dwordx4 v[108:111], v0, s[52:55], s88 offen offset:3072 sc1
    s_waitcnt vmcnt(15)
    v_mfma_f32_16x16x32_bf16 v[148:151], v[48:51], v[16:19], 0
    s_waitcnt vmcnt(14)
    v_mfma_f32_16x16x32_bf16 v[148:151], v[52:55], v[20:23], v[148:151]
    s_waitcnt vmcnt(13)
    v_mfma_f32_16x16x32_bf16 v[148:151], v[56:59], v[24:27], v[148:151]
    s_waitcnt vmcnt(12)
    v_mfma_f32_16x16x32_bf16 v[148:151], v[60:63], v[28:31], v[148:151]
    v_mfma_f32_16x16x32_bf16 v[156:159], v[48:51], v[32:35], 0
    v_mfma_f32_16x16x32_bf16 v[156:159], v[52:55], v[36:39], v[156:159]
    v_mfma_f32_16x16x32_bf16 v[156:159], v[56:59], v[40:43], v[156:159]
    v_mfma_f32_16x16x32_bf16 v[156:159], v[60:63], v[44:47], v[156:159]
    s_waitcnt vmcnt(11)
    v_mfma_f32_16x16x32_bf16 v[160:163], v[64:67], v[32:35], 0
    s_waitcnt vmcnt(10)
    v_mfma_f32_16x16x32_bf16 v[160:163], v[68:71], v[36:39], v[160:163]
    s_waitcnt vmcnt(9)
    v_mfma_f32_16x16x32_bf16 v[160:163], v[72:75], v[40:43], v[160:163]
    s_waitcnt vmcnt(8)
    v_mfma_f32_16x16x32_bf16 v[160:163], v[76:79], v[44:47], v[160:163]
    v_cvt_pk_bf16_f32 v240, v148, v149
    v_cvt_pk_bf16_f32 v241, v150, v151
    v_lshlrev_b32 v148, 16, v240
    v_and_b32 v149, 0xffff0000, v240
    v_lshlrev_b32 v150, 16, v241
    v_and_b32 v151, 0xffff0000, v241
    v_mul_f32 v148, s70, v148
    v_mul_f32 v149, s70, v149
    v_mul_f32 v150, s70, v150
    v_mul_f32 v151, s70, v151
    v_cvt_pk_bf16_f32 v240, v148, v149
    v_cvt_pk_bf16_f32 v241, v150, v151
    v_lshlrev_b32 v148, 16, v240
    v_and_b32 v149, 0xffff0000, v240
    v_lshlrev_b32 v150, 16, v241
    v_and_b32 v151, 0xffff0000, v241
    v_cndmask_b32 v148, v7, v148, s[60:61]
    v_cndmask_b32 v149, v7, v149, s[62:63]
    v_cndmask_b32 v150, v7, v150, s[64:65]
    v_cndmask_b32 v151, v7, v151, s[66:67]
    v_cvt_pk_bf16_f32 v240, v156, v157
    v_cvt_pk_bf16_f32 v241, v158, v159
    v_lshlrev_b32 v156, 16, v240
    v_and_b32 v157, 0xffff0000, v240
    v_lshlrev_b32 v158, 16, v241
    v_and_b32 v159, 0xffff0000, v241
    v_mul_f32 v156, s70, v156
    v_mul_f32 v157, s70, v157
    v_mul_f32 v158, s70, v158
    v_mul_f32 v159, s70, v159
    v_cvt_pk_bf16_f32 v240, v156, v157
    v_cvt_pk_bf16_f32 v241, v158, v159
    v_lshlrev_b32 v156, 16, v240
    v_and_b32 v157, 0xffff0000, v240
    v_lshlrev_b32 v158, 16, v241
    v_and_b32 v159, 0xffff0000, v241
    v_cvt_pk_bf16_f32 v240, v160, v161
    v_cvt_pk_bf16_f32 v241, v162, v163
    v_lshlrev_b32 v160, 16, v240
    v_and_b32 v161, 0xffff0000, v240
    v_lshlrev_b32 v162, 16, v241
    v_and_b32 v163, 0xffff0000, v241
    v_mul_f32 v160, s70, v160
    v_mul_f32 v161, s70, v161
    v_mul_f32 v162, s70, v162
    v_mul_f32 v163, s70, v163
    v_cvt_pk_bf16_f32 v240, v160, v161
    v_cvt_pk_bf16_f32 v241, v162, v163
    v_lshlrev_b32 v160, 16, v240
    v_and_b32 v161, 0xffff0000, v240
    v_lshlrev_b32 v162, 16, v241
    v_and_b32 v163, 0xffff0000, v241
    v_cndmask_b32 v160, v7, v160, s[60:61]
    v_cndmask_b32 v161, v7, v161, s[62:63]
    v_cndmask_b32 v162, v7, v162, s[64:65]
    v_cndmask_b32 v163, v7, v163, s[66:67]
    s_lshl_b32 s84, s5, 12
    s_add_u32 s85, s84, 0x7400000
    s_add_u32 s86, s84, 0x5400000
    s_and_b32 s82, s5, 31
    s_lshl_b32 s82, s82, 7
    s_add_u32 s82, s82, 0x8305000
    s_lshr_b32 s89, s5, 5
    s_add_u32 s89, s89, 1
    s_min_u32 s88, s89, 63
    v_mov_b32 v8, 0
    s_nop 1
    s_waitcnt vmcnt(0)
L_wait_33:
    buffer_load_dword v9, v8, s[52:55], s82 offen offset:0 sc1
    s_waitcnt vmcnt(0)
    v_readfirstlane_b32 s83, v9
    s_nop 0
    s_cmp_ge_u32 s83, s88
    s_nop 2
    s_cbranch_scc1 L_waitok_34
    s_add_u32 s83, s83, 2
    s_cmp_ge_u32 s83, s88
    s_cbranch_scc1 L_near_35
    s_sleep 40
L_near_35:
    s_sub_u32 s81, s81, 1
    s_cbranch_scc1 L_main_done
    s_branch L_wait_33
L_waitok_34:
    s_cmp_lt_u32 s89, 64
    s_cbranch_scc1 L_at_norm
L_at_spec:
    buffer_load_dword v9, v8, s[52:55], s82 offen sc1
    buffer_load_dwordx4 v[112:115], v2, s[52:55], s85 offen offset:0 sc1
    buffer_load_dwordx4 v[116:119], v2, s[52:55], s85 offen offset:1024 sc1
    buffer_load_dwordx4 v[120:123], v2, s[52:55], s85 offen offset:2048 sc1
    buffer_load_dwordx4 v[124:127], v2, s[52:55], s85 offen offset:3072 sc1
    buffer_load_dwordx2 v[128:129], v0, s[52:55], s86 offen offset:8 sc1
    buffer_load_dwordx2 v[130:131], v0, s[52:55], s86 offen offset:1032 sc1
    buffer_load_dwordx2 v[132:133], v0, s[52:55], s86 offen offset:2056 sc1
    buffer_load_dwordx2 v[134:135], v0, s[52:55], s86 offen offset:3080 sc1
    s_waitcnt vmcnt(8)
    v_readfirstlane_b32 s83, v9
    s_waitcnt vmcnt(5)
    v_max3_u32 v10, v112, v116, v120
    s_waitcnt vmcnt(3)
    v_max3_u32 v10, v10, v124, v128
    s_waitcnt vmcnt(1)
    v_max3_u32 v10, v10, v130, v132
    s_waitcnt vmcnt(0)
    v_max_u32 v10, v10, v134
    v_cmp_eq_u32 vcc, -1, v10
    s_nop 4
    s_cbranch_vccz L_at_have
    s_sub_u32 s81, s81, 1
    s_cbranch_scc1 L_main_done
    s_cmp_lt_u32 s83, 64
    s_cbranch_scc1 L_at_spec
L_at_norm:
    buffer_load_dwordx4 v[112:115], v2, s[52:55], s85 offen offset:0 sc1
    buffer_load_dwordx4 v[116:119], v2, s[52:55], s85 offen offset:1024 sc1
    buffer_load_dwordx4 v[120:123], v2, s[52:55], s85 offen offset:2048 sc1
    buffer_load_dwordx4 v[124:127], v2, s[52:55], s85 offen offset:3072 sc1
    buffer_load_dwordx2 v[128:129], v0, s[52:55], s86 offen offset:8 sc1
    buffer_load_dwordx2 v[130:131], v0, s[52:55], s86 offen offset:1032 sc1
    buffer_load_dwordx2 v[132:133], v0, s[52:55], s86 offen offset:2056 sc1
    buffer_load_dwordx2 v[134:135], v0, s[52:55], s86 offen offset:3080 sc1
    s_waitcnt vmcnt(0)
L_at_have:
    v_mfma_f32_16x16x32_bf16 v[144:147], v[112:115], v[16:19], 0
    v_mfma_f32_16x16x32_bf16 v[152:155], v[112:115], v[32:35], 0
    v_mfma_f32_16x16x32_bf16 v[144:147], v[116:119], v[20:23], v[144:147]
    v_mfma_f32_16x16x32_bf16 v[152:155], v[116:119], v[36:39], v[152:155]
    v_mfma_f32_16x16x32_bf16 v[144:147], v[120:123], v[24:27], v[144:147]
    v_mfma_f32_16x16x32_bf16 v[152:155], v[120:123], v[40:43], v[152:155]
    v_mfma_f32_16x16x32_bf16 v[144:147], v[124:127], v[28:31], v[144:147]
    v_mfma_f32_16x16x32_bf16 v[152:155], v[124:127], v[44:47], v[152:155]
    s_nop 6
    v_cvt_pk_bf16_f32 v240, v146, v147
    v_lshlrev_b32 v146, 16, v240
    v_and_b32 v147, 0xffff0000, v240
    v_mul_f32 v146, s70, v146
    v_mul_f32 v147, s70, v147
    v_cvt_pk_bf16_f32 v240, v146, v147
    v_lshlrev_b32 v146, 16, v240
    v_and_b32 v147, 0xffff0000, v240
    v_cvt_pk_bf16_f32 v240, v154, v155
    v_lshlrev_b32 v154, 16, v240
    v_and_b32 v155, 0xffff0000, v240
    v_mul_f32 v154, s70, v154
    v_mul_f32 v155, s70, v155
    v_cvt_pk_bf16_f32 v240, v154, v155
    v_lshlrev_b32 v154, 16, v240
    v_and_b32 v155, 0xffff0000, v240
    v_max3_f32 v244, v146, v147, v148
    v_max3_f32 v244, v244, v149, v150
    v_max_f32 v244, v244, v151
    v_mov_b32 v245, v244
    s_nop 1
    v_permlane16_swap_b32 v244, v245
    v_max_f32 v244, v244, v245
    v_mov_b32 v245, v244
    s_nop 1
    v_permlane32_swap_b32 v244, v245
    v_max_f32 v244, v244, v245
    v_sub_f32 v146, v146, v244
    v_sub_f32 v147, v147, v244
    v_sub_f32 v148, v148, v244
    v_sub_f32 v149, v149, v244
    v_sub_f32 v150, v150, v244
    v_sub_f32 v151, v151, v244
    v_mul_f32 v146, s71, v146
    v_mul_f32 v147, s71, v147
    v_mul_f32 v148, s71, v148
    v_mul_f32 v149, s71, v149
    v_mul_f32 v150, s71, v150
    v_mul_f32 v151, s71, v151
    v_exp_f32 v146, v146
    v_exp_f32 v147, v147
    v_exp_f32 v148, v148
    v_exp_f32 v149, v149
    v_exp_f32 v150, v150
    v_exp_f32 v151, v151
    v_add_f32 v246, v146, v147
    v_add_f32 v246, v246, v148
    v_add_f32 v246, v246, v149
    v_add_f32 v246, v246, v150
    v_add_f32 v246, v246, v151
    v_mov_b32 v245, v246
    s_nop 1
    v_permlane16_swap_b32 v246, v245
    v_add_f32 v246, v246, v245
    v_mov_b32 v245, v246
    s_nop 1
    v_permlane32_swap_b32 v246, v245
    v_add_f32 v246, v246, v245
    v_rcp_f32 v246, v246
    s_nop 0
    v_mul_f32 v146, v146, v246
    v_mul_f32 v147, v147, v246
    v_mul_f32 v148, v148, v246
    v_mul_f32 v149, v149, v246
    v_mul_f32 v150, v150, v246
    v_mul_f32 v151, v151, v246
    v_cvt_pk_bf16_f32 v168, v146, v147
    v_cvt_pk_bf16_f32 v171, v146, v147
    v_cvt_pk_bf16_f32 v164, v148, v149
    v_cvt_pk_bf16_f32 v165, v150, v151
    v_mov_b64 v[166:167], 0
    v_mov_b32 v169, 0
    v_mov_b32 v170, 0
    v_mfma_f32_16x16x32_bf16 v[176:179], v[80:83], v[164:167], 0
    v_mfma_f32_16x16x32_bf16 v[180:183], v[84:87], v[164:167], 0
    v_mfma_f32_16x16x32_bf16 v[184:187], v[88:91], v[164:167], 0
    v_mfma_f32_16x16x32_bf16 v[188:191], v[92:95], v[164:167], 0
    v_mfma_f32_16x16x32_bf16 v[192:195], v[96:99], v[164:167], 0
    v_mfma_f32_16x16x32_bf16 v[196:199], v[100:103], v[164:167], 0
    v_mfma_f32_16x16x32_bf16 v[200:203], v[104:107], v[164:167], 0
    v_mfma_f32_16x16x32_bf16 v[204:207], v[108:111], v[164:167], 0
    v_mfma_f32_16x16x16_bf16 v[176:179], v[128:129], v[168:169], v[176:179]
    v_mfma_f32_16x16x16_bf16 v[180:183], v[128:129], v[170:171], v[180:183]
    v_mfma_f32_16x16x16_bf16 v[184:187], v[130:131], v[168:169], v[184:187]
    v_mfma_f32_16x16x16_bf16 v[188:191], v[130:131], v[170:171], v[188:191]
    v_mfma_f32_16x16x16_bf16 v[192:195], v[132:133], v[168:169], v[192:195]
    v_mfma_f32_16x16x16_bf16 v[196:199], v[132:133], v[170:171], v[196:199]
    v_mfma_f32_16x16x16_bf16 v[200:203], v[134:135], v[168:169], v[200:203]
    v_mfma_f32_16x16x16_bf16 v[204:207], v[134:135], v[170:171], v[204:207]
    v_max3_f32 v244, v154, v155, v156
    v_max3_f32 v244, v244, v157, v158
    v_max3_f32 v244, v244, v159, v160
    v_max3_f32 v244, v244, v161, v162
    v_max_f32 v244, v244, v163
    v_mov_b32 v245, v244
    s_nop 1
    v_permlane16_swap_b32 v244, v245
    v_max_f32 v244, v244, v245
    v_mov_b32 v245, v244
    s_nop 1
    v_permlane32_swap_b32 v244, v245
    v_max_f32 v244, v244, v245
    v_sub_f32 v154, v154, v244
    v_sub_f32 v155, v155, v244
    v_sub_f32 v156, v156, v244
    v_sub_f32 v157, v157, v244
    v_sub_f32 v158, v158, v244
    v_sub_f32 v159, v159, v244
    v_sub_f32 v160, v160, v244
    v_sub_f32 v161, v161, v244
    v_sub_f32 v162, v162, v244
    v_sub_f32 v163, v163, v244
    v_mul_f32 v154, s71, v154
    v_mul_f32 v155, s71, v155
    v_mul_f32 v156, s71, v156
    v_mul_f32 v157, s71, v157
    v_mul_f32 v158, s71, v158
    v_mul_f32 v159, s71, v159
    v_mul_f32 v160, s71, v160
    v_mul_f32 v161, s71, v161
    v_mul_f32 v162, s71, v162
    v_mul_f32 v163, s71, v163
    v_exp_f32 v154, v154
    v_exp_f32 v155, v155
    v_exp_f32 v156, v156
    v_exp_f32 v157, v157
    v_exp_f32 v158, v158
    v_exp_f32 v159, v159
    v_exp_f32 v160, v160
    v_exp_f32 v161, v161
    v_exp_f32 v162, v162
    v_exp_f32 v163, v163
    v_add_f32 v246, v154, v155
    v_add_f32 v246, v246, v156
    v_add_f32 v246, v246, v157
    v_add_f32 v246, v246, v158
    v_add_f32 v246, v246, v159
    v_add_f32 v246, v246, v160
    v_add_f32 v246, v246, v161
    v_add_f32 v246, v246, v162
    v_add_f32 v246, v246, v163
    v_mov_b32 v245, v246
    s_nop 1
    v_permlane16_swap_b32 v246, v245
    v_add_f32 v246, v246, v245
    v_mov_b32 v245, v246
    s_nop 1
    v_permlane32_swap_b32 v246, v245
    v_add_f32 v246, v246, v245
    v_rcp_f32 v246, v246
    s_nop 0
    v_mul_f32 v154, v154, v246
    v_mul_f32 v155, v155, v246
    v_mul_f32 v156, v156, v246
    v_mul_f32 v157, v157, v246
    v_mul_f32 v158, v158, v246
    v_mul_f32 v159, v159, v246
    v_mul_f32 v160, v160, v246
    v_mul_f32 v161, v161, v246
    v_mul_f32 v162, v162, v246
    v_mul_f32 v163, v163, v246
    v_cvt_pk_bf16_f32 v168, v154, v155
    v_cvt_pk_bf16_f32 v171, v154, v155
    v_cvt_pk_bf16_f32 v164, v156, v157
    v_cvt_pk_bf16_f32 v165, v158, v159
    v_cvt_pk_bf16_f32 v166, v160, v161
    v_cvt_pk_bf16_f32 v167, v162, v163
    s_nop 1
    v_mfma_f32_16x16x32_bf16 v[208:211], v[80:83], v[164:167], 0
    v_mfma_f32_16x16x32_bf16 v[212:215], v[84:87], v[164:167], 0
    v_mfma_f32_16x16x32_bf16 v[216:219], v[88:91], v[164:167], 0
    v_mfma_f32_16x16x32_bf16 v[220:223], v[92:95], v[164:167], 0
    v_mfma_f32_16x16x32_bf16 v[224:227], v[96:99], v[164:167], 0
    v_mfma_f32_16x16x32_bf16 v[228:231], v[100:103], v[164:167], 0
    v_mfma_f32_16x16x32_bf16 v[232:235], v[104:107], v[164:167], 0
    v_mfma_f32_16x16x32_bf16 v[236:239], v[108:111], v[164:167], 0
    v_mfma_f32_16x16x16_bf16 v[208:211], v[128:129], v[168:169], v[208:211]
    v_mfma_f32_16x16x16_bf16 v[212:215], v[128:129], v[170:171], v[212:215]
    v_mfma_f32_16x16x16_bf16 v[216:219], v[130:131], v[168:169], v[216:219]
    v_mfma_f32_16x16x16_bf16 v[220:223], v[130:131], v[170:171], v[220:223]
    v_mfma_f32_16x16x16_bf16 v[224:227], v[132:133], v[168:169], v[224:227]
    v_mfma_f32_16x16x16_bf16 v[228:231], v[132:133], v[170:171], v[228:231]
    v_mfma_f32_16x16x16_bf16 v[232:235], v[134:135], v[168:169], v[232:235]
    v_mfma_f32_16x16x16_bf16 v[236:239], v[134:135], v[170:171], v[236:239]
    s_lshr_b32 s84, s5, 5
    s_lshl_b32 s84, s84, 18
    s_and_b32 s85, s5, 31
    s_lshl_b32 s85, s85, 12
    s_add_u32 s84, s84, s85
    s_add_u32 s84, s84, 0x6000000
    s_add_u32 s85, s84, 131072
    v_cvt_pk_bf16_f32 v16, v176, v177
    v_cvt_pk_bf16_f32 v17, v178, v179
    v_cvt_pk_bf16_f32 v18, v180, v181
    v_cvt_pk_bf16_f32 v19, v182, v183
    buffer_store_dwordx4 v[16:19], v0, s[52:55], s84 offen offset:0 sc1
    v_cvt_pk_bf16_f32 v20, v184, v185
    v_cvt_pk_bf16_f32 v21, v186, v187
    v_cvt_pk_bf16_f32 v22, v188, v189
    v_cvt_pk_bf16_f32 v23, v190, v191
    buffer_store_dwordx4 v[20:23], v0, s[52:55], s84 offen offset:1024 sc1
    v_cvt_pk_bf16_f32 v24, v192, v193
    v_cvt_pk_bf16_f32 v25, v194, v195
    v_cvt_pk_bf16_f32 v26, v196, v197
    v_cvt_pk_bf16_f32 v27, v198, v199
    buffer_store_dwordx4 v[24:27], v0, s[52:55], s84 offen offset:2048 sc1
    v_cvt_pk_bf16_f32 v28, v200, v201
    v_cvt_pk_bf16_f32 v29, v202, v203
    v_cvt_pk_bf16_f32 v30, v204, v205
    v_cvt_pk_bf16_f32 v31, v206, v207
    buffer_store_dwordx4 v[28:31], v0, s[52:55], s84 offen offset:3072 sc1
    v_cvt_pk_bf16_f32 v32, v208, v209
    v_cvt_pk_bf16_f32 v33, v210, v211
    v_cvt_pk_bf16_f32 v34, v212, v213
    v_cvt_pk_bf16_f32 v35, v214, v215
    buffer_store_dwordx4 v[32:35], v0, s[52:55], s85 offen offset:0 sc1
    v_cvt_pk_bf16_f32 v36, v216, v217
    v_cvt_pk_bf16_f32 v37, v218, v219
    v_cvt_pk_bf16_f32 v38, v220, v221
    v_cvt_pk_bf16_f32 v39, v222, v223
    buffer_store_dwordx4 v[36:39], v0, s[52:55], s85 offen offset:1024 sc1
    v_cvt_pk_bf16_f32 v40, v224, v225
    v_cvt_pk_bf16_f32 v41, v226, v227
    v_cvt_pk_bf16_f32 v42, v228, v229
    v_cvt_pk_bf16_f32 v43, v230, v231
    buffer_store_dwordx4 v[40:43], v0, s[52:55], s85 offen offset:2048 sc1
    v_cvt_pk_bf16_f32 v44, v232, v233
    v_cvt_pk_bf16_f32 v45, v234, v235
    v_cvt_pk_bf16_f32 v46, v236, v237
    v_cvt_pk_bf16_f32 v47, v238, v239
    buffer_store_dwordx4 v[44:47], v0, s[52:55], s85 offen offset:3072 sc1
    s_waitcnt vmcnt(0)
    s_lshr_b32 s82, s5, 3
    s_lshl_b32 s82, s82, 5
    s_add_u32 s82, s82, 0x8301000
    v_mov_b32 v8, 0
    v_mov_b32 v9, 1
    s_mov_b64 exec, 1
    buffer_atomic_add v9, v8, s[52:55], s82 offen offset:0
    s_mov_b64 exec, -1
    s_add_u32 s5, s5, 224
    s_cmp_lt_u32 s5, 2048
    s_cbranch_scc1 L_m_att
    s_branch L_main_done
L_m_wf:
    s_sub_u32 s5, s5, 56
    s_mov_b32 s100, 6
    s_mov_b32 s101, 128
    s_mov_b32 s97, 48
L_m_wf2:
    s_mul_i32 s98, s5, 43691
    s_lshr_b32 s98, s98, 19
    s_mul_i32 s99, s98, 12
    s_sub_u32 s99, s5, s99
    s_add_u32 s98, s98, s97
    s_barrier
    v_lshlrev_b32 v0, 4, v1
    s_mul_i32 s84, s3, 1179648
    s_mul_i32 s85, s99, 96
    s_add_u32 s84, s84, s85
    s_mul_i32 s87, s3, 24576
    s_mov_b32 s85, 10923
    v_add_u32 v8, 0, v1
    v_mul_u32_u24 v9, s85, v8
    v_lshrrev_b32 v9, 16, v9
    v_mul_u32_u24 v10, 6, v9
    v_sub_u32 v10, v8, v10
    v_mul_u32_u24 v2, 1152, v9
    v_lshl_add_u32 v2, v10, 4, v2
    v_add_u32 v8, 64, v1
    v_mul_u32_u24 v9, s85, v8
    v_lshrrev_b32 v9, 16, v9
    v_mul_u32_u24 v10, 6, v9
    v_sub_u32 v10, v8, v10
    v_mul_u32_u24 v3, 1152, v9
    v_lshl_add_u32 v3, v10, 4, v3
    v_add_u32 v8, 128, v1
    v_mul_u32_u24 v9, s85, v8
    v_lshrrev_b32 v9, 16, v9
    v_mul_u32_u24 v10, 6, v9
    v_sub_u32 v10, v8, v10
    v_mul_u32_u24 v4, 1152, v9
    v_lshl_add_u32 v4, v10, 4, v4
    v_add_u32 v5, s87, v0
    v_lshrrev_b32 v8, 2, v1
    v_mul_u32_u24 v6, 96, v8
    v_and_b32 v9, 3, v1
    v_lshl_add_u32 v6, v9, 3, v6
    v_add_u32 v6, s87, v6
    buffer_load_dwordx4 a[0:3], v2, s[28:31], s84 offen
    buffer_load_dwordx4 a[4:7], v3, s[28:31], s84 offen
    buffer_load_dwordx4 a[8:11], v4, s[28:31], s84 offen
    s_add_u32 s84, s84, 36864
    buffer_load_dwordx4 a[12:15], v2, s[28:31], s84 offen
    buffer_load_dwordx4 a[16:19], v3, s[28:31], s84 offen
    buffer_load_dwordx4 a[20:23], v4, s[28:31], s84 offen
    s_add_u32 s84, s84, 36864
    buffer_load_dwordx4 a[24:27], v2, s[28:31], s84 offen
    buffer_load_dwordx4 a[28:31], v3, s[28:31], s84 offen
    buffer_load_dwordx4 a[32:35], v4, s[28:31], s84 offen
    s_add_u32 s84, s84, 36864
    buffer_load_dwordx4 a[36:39], v2, s[28:31], s84 offen
    buffer_load_dwordx4 a[40:43], v3, s[28:31], s84 offen
    buffer_load_dwordx4 a[44:47], v4, s[28:31], s84 offen
    s_add_u32 s84, s84, 36864
    buffer_load_dwordx4 a[48:51], v2, s[28:31], s84 offen
    buffer_load_dwordx4 a[52:55], v3, s[28:31], s84 offen
    buffer_load_dwordx4 a[56:59], v4, s[28:31], s84 offen
    s_add_u32 s84, s84, 36864
    buffer_load_dwordx4 a[60:63], v2, s[28:31], s84 offen
    buffer_load_dwordx4 a[64:67], v3, s[28:31], s84 offen
    buffer_load_dwordx4 a[68:71], v4, s[28:31], s84 offen
    s_add_u32 s84, s84, 36864
    buffer_load_dwordx4 a[72:75], v2, s[28:31], s84 offen
    buffer_load_dwordx4 a[76:79], v3, s[28:31], s84 offen
    buffer_load_dwordx4 a[80:83], v4, s[28:31], s84 offen
    s_add_u32 s84, s84, 36864
    buffer_load_dwordx4 a[84:87], v2, s[28:31], s84 offen
    buffer_load_dwordx4 a[88:91], v3, s[28:31], s84 offen
    buffer_load_dwordx4 a[92:95], v4, s[28:31], s84 offen
    s_add_u32 s84, s84, 36864
    buffer_load_dwordx4 a[96:99], v2, s[28:31], s84 offen
    buffer_load_dwordx4 a[100:103], v3, s[28:31], s84 offen
    buffer_load_dwordx4 a[104:107], v4, s[28:31], s84 offen
    s_add_u32 s84, s84, 36864
    buffer_load_dwordx4 a[108:111], v2, s[28:31], s84 offen
    buffer_load_dwordx4 a[112:115], v3, s[28:31], s84 offen
    buffer_load_dwordx4 a[116:119], v4, s[28:31], s84 offen
    s_add_u32 s84, s84, 36864
    buffer_load_dwordx4 a[120:123], v2, s[28:31], s84 offen
    buffer_load_dwordx4 a[124:127], v3, s[28:31], s84 offen
    buffer_load_dwordx4 a[128:131], v4, s[28:31], s84 offen
    s_add_u32 s84, s84, 36864
    buffer_load_dwordx4 a[132:135], v2, s[28:31], s84 offen
    buffer_load_dwordx4 a[136:139], v3, s[28:31], s84 offen
    buffer_load_dwordx4 a[140:143], v4, s[28:31], s84 offen
    s_add_u32 s84, s84, 36864
    buffer_load_dwordx4 a[144:147], v2, s[28:31], s84 offen
    buffer_load_dwordx4 a[148:151], v3, s[28:31], s84 offen
    buffer_load_dwordx4 a[152:155], v4, s[28:31], s84 offen
    s_add_u32 s84, s84, 36864
    buffer_load_dwordx4 a[156:159], v2, s[28:31], s84 offen
    buffer_load_dwordx4 a[160:163], v3, s[28:31], s84 offen
    buffer_load_dwordx4 a[164:167], v4, s[28:31], s84 offen
    s_add_u32 s84, s84, 36864
    buffer_load_dwordx4 a[168:171], v2, s[28:31], s84 offen
    buffer_load_dwordx4 a[172:175], v3, s[28:31], s84 offen
    buffer_load_dwordx4 a[176:179], v4, s[28:31], s84 offen
    s_add_u32 s84, s84, 36864
    buffer_load_dwordx4 a[180:183], v2, s[28:31], s84 offen
    buffer_load_dwordx4 a[184:187], v3, s[28:31], s84 offen
    buffer_load_dwordx4 a[188:191], v4, s[28:31], s84 offen
    s_add_u32 s84, s84, 36864
    s_waitcnt vmcnt(47)
    ds_write_b128 v5, a[0:3] offset:0
    s_waitcnt vmcnt(46)
    ds_write_b128 v5, a[4:7] offset:1024
    s_waitcnt vmcnt(45)
    ds_write_b128 v5, a[8:11] offset:2048
    s_waitcnt vmcnt(44)
    ds_write_b128 v5, a[12:15] offset:3072
    s_waitcnt vmcnt(43)
    ds_write_b128 v5, a[16:19] offset:4096
    s_waitcnt vmcnt(42)
    ds_write_b128 v5, a[20:23] offset:5120
    s_waitcnt vmcnt(41)
    ds_write_b128 v5, a[24:27] offset:6144
    s_waitcnt vmcnt(40)
    ds_write_b128 v5, a[28:31] offset:7168
    s_waitcnt vmcnt(39)
    ds_write_b128 v5, a[32:35] offset:8192
    s_waitcnt vmcnt(38)
    ds_write_b128 v5, a[36:39] offset:9216
    s_waitcnt vmcnt(37)
    ds_write_b128 v5, a[40:43] offset:10240
    s_waitcnt vmcnt(36)
    ds_write_b128 v5, a[44:47] offset:11264
    s_waitcnt vmcnt(35)
    ds_write_b128 v5, a[48:51] offset:12288
    s_waitcnt vmcnt(34)
    ds_write_b128 v5, a[52:55] offset:13312
    s_waitcnt vmcnt(33)
    ds_write_b128 v5, a[56:59] offset:14336
    s_waitcnt vmcnt(32)
    ds_write_b128 v5, a[60:63] offset:15360
    s_waitcnt vmcnt(31)
    ds_write_b128 v5, a[64:67] offset:16384
    s_waitcnt vmcnt(30)
    ds_write_b128 v5, a[68:71] offset:17408
    s_waitcnt vmcnt(29)
    ds_write_b128 v5, a[72:75] offset:18432
    s_waitcnt vmcnt(28)
    ds_write_b128 v5, a[76:79] offset:19456
    s_waitcnt vmcnt(27)
    ds_write_b128 v5, a[80:83] offset:20480
    s_waitcnt vmcnt(26)
    ds_write_b128 v5, a[84:87] offset:21504
    s_waitcnt vmcnt(25)
    ds_write_b128 v5, a[88:91] offset:22528
    s_waitcnt vmcnt(24)
    ds_write_b128 v5, a[92:95] offset:23552
    s_waitcnt lgkmcnt(0)
    buffer_load_dwordx4 a[192:195], v2, s[28:31], s84 offen
    buffer_load_dwordx4 a[196:199], v3, s[28:31], s84 offen
    buffer_load_dwordx4 a[200:203], v4, s[28:31], s84 offen
    s_add_u32 s84, s84, 36864
    buffer_load_dwordx4 a[204:207], v2, s[28:31], s84 offen
    buffer_load_dwordx4 a[208:211], v3, s[28:31], s84 offen
    buffer_load_dwordx4 a[212:215], v4, s[28:31], s84 offen
    s_add_u32 s84, s84, 36864
    buffer_load_dwordx4 a[216:219], v2, s[28:31], s84 offen
    buffer_load_dwordx4 a[220:223], v3, s[28:31], s84 offen
    buffer_load_dwordx4 a[224:227], v4, s[28:31], s84 offen
    s_add_u32 s84, s84, 36864
    buffer_load_dwordx4 a[228:231], v2, s[28:31], s84 offen
    buffer_load_dwordx4 a[232:235], v3, s[28:31], s84 offen
    buffer_load_dwordx4 a[236:239], v4, s[28:31], s84 offen
    s_add_u32 s84, s84, 36864
    buffer_load_dwordx4 a[240:243], v2, s[28:31], s84 offen
    buffer_load_dwordx4 a[244:247], v3, s[28:31], s84 offen
    buffer_load_dwordx4 a[248:251], v4, s[28:31], s84 offen
    s_add_u32 s84, s84, 36864
    buffer_load_dwordx4 a[252:255], v2, s[28:31], s84 offen
    buffer_load_dwordx4 v[128:131], v3, s[28:31], s84 offen
    buffer_load_dwordx4 v[132:135], v4, s[28:31], s84 offen
    s_add_u32 s84, s84, 36864
    buffer_load_dwordx4 v[136:139], v2, s[28:31], s84 offen
    buffer_load_dwordx4 v[140:143], v3, s[28:31], s84 offen
    buffer_load_dwordx4 v[144:147], v4, s[28:31], s84 offen
    s_add_u32 s84, s84, 36864
    buffer_load_dwordx4 v[148:151], v2, s[28:31], s84 offen
    buffer_load_dwordx4 v[152:155], v3, s[28:31], s84 offen
    buffer_load_dwordx4 v[156:159], v4, s[28:31], s84 offen
    s_add_u32 s84, s84, 36864
    ds_read_b64_tr_b16 a[0:1], v6 offset:0
    ds_read_b64_tr_b16 a[2:3], v6 offset:1536
    ds_read_b64_tr_b16 a[4:5], v6 offset:32
    ds_read_b64_tr_b16 a[6:7], v6 offset:1568
    ds_read_b64_tr_b16 a[8:9], v6 offset:64
    ds_read_b64_tr_b16 a[10:11], v6 offset:1600
    ds_read_b64_tr_b16 a[12:13], v6 offset:3072
    ds_read_b64_tr_b16 a[14:15], v6 offset:4608
    ds_read_b64_tr_b16 a[16:17], v6 offset:3104
    ds_read_b64_tr_b16 a[18:19], v6 offset:4640
    ds_read_b64_tr_b16 a[20:21], v6 offset:3136
    ds_read_b64_tr_b16 a[22:23], v6 offset:4672
    ds_read_b64_tr_b16 a[24:25], v6 offset:6144
    ds_read_b64_tr_b16 a[26:27], v6 offset:7680
    ds_read_b64_tr_b16 a[28:29], v6 offset:6176
    ds_read_b64_tr_b16 a[30:31], v6 offset:7712
    ds_read_b64_tr_b16 a[32:33], v6 offset:6208
    ds_read_b64_tr_b16 a[34:35], v6 offset:7744
    ds_read_b64_tr_b16 a[36:37], v6 offset:9216
    ds_read_b64_tr_b16 a[38:39], v6 offset:10752
    ds_read_b64_tr_b16 a[40:41], v6 offset:9248
    ds_read_b64_tr_b16 a[42:43], v6 offset:10784
    ds_read_b64_tr_b16 a[44:45], v6 offset:9280
    ds_read_b64_tr_b16 a[46:47], v6 offset:10816
    ds_read_b64_tr_b16 a[48:49], v6 offset:12288
    ds_read_b64_tr_b16 a[50:51], v6 offset:13824
    ds_read_b64_tr_b16 a[52:53], v6 offset:12320
    ds_read_b64_tr_b16 a[54:55], v6 offset:13856
    ds_read_b64_tr_b16 a[56:57], v6 offset:12352
    ds_read_b64_tr_b16 a[58:59], v6 offset:13888
    ds_read_b64_tr_b16 a[60:61], v6 offset:15360
    ds_read_b64_tr_b16 a[62:63], v6 offset:16896
    ds_read_b64_tr_b16 a[64:65], v6 offset:15392
    ds_read_b64_tr_b16 a[66:67], v6 offset:16928
    ds_read_b64_tr_b16 a[68:69], v6 offset:15424
    ds_read_b64_tr_b16 a[70:71], v6 offset:16960
    ds_read_b64_tr_b16 a[72:73], v6 offset:18432
    ds_read_b64_tr_b16 a[74:75], v6 offset:19968
    ds_read_b64_tr_b16 a[76:77], v6 offset:18464
    ds_read_b64_tr_b16 a[78:79], v6 offset:20000
    ds_read_b64_tr_b16 a[80:81], v6 offset:18496
    ds_read_b64_tr_b16 a[82:83], v6 offset:20032
    ds_read_b64_tr_b16 a[84:85], v6 offset:21504
    ds_read_b64_tr_b16 a[86:87], v6 offset:23040
    ds_read_b64_tr_b16 a[88:89], v6 offset:21536
    ds_read_b64_tr_b16 a[90:91], v6 offset:23072
    ds_read_b64_tr_b16 a[92:93], v6 offset:21568
    ds_read_b64_tr_b16 a[94:95], v6 offset:23104
    s_waitcnt lgkmcnt(0)
    s_waitcnt vmcnt(47)
    ds_write_b128 v5, a[96:99] offset:0
    s_waitcnt vmcnt(46)
    ds_write_b128 v5, a[100:103] offset:1024
    s_waitcnt vmcnt(45)
    ds_write_b128 v5, a[104:107] offset:2048
    s_waitcnt vmcnt(44)
    ds_write_b128 v5, a[108:111] offset:3072
    s_waitcnt vmcnt(43)
    ds_write_b128 v5, a[112:115] offset:4096
    s_waitcnt vmcnt(42)
    ds_write_b128 v5, a[116:119] offset:5120
    s_waitcnt vmcnt(41)
    ds_write_b128 v5, a[120:123] offset:6144
    s_waitcnt vmcnt(40)
    ds_write_b128 v5, a[124:127] offset:7168
    s_waitcnt vmcnt(39)
    ds_write_b128 v5, a[128:131] offset:8192
    s_waitcnt vmcnt(38)
    ds_write_b128 v5, a[132:135] offset:9216
    s_waitcnt vmcnt(37)
    ds_write_b128 v5, a[136:139] offset:10240
    s_waitcnt vmcnt(36)
    ds_write_b128 v5, a[140:143] offset:11264
    s_waitcnt vmcnt(35)
    ds_write_b128 v5, a[144:147] offset:12288
    s_waitcnt vmcnt(34)
    ds_write_b128 v5, a[148:151] offset:13312
    s_waitcnt vmcnt(33)
    ds_write_b128 v5, a[152:155] offset:14336
    s_waitcnt vmcnt(32)
    ds_write_b128 v5, a[156:159] offset:15360
    s_waitcnt vmcnt(31)
    ds_write_b128 v5, a[160:163] offset:16384
    s_waitcnt vmcnt(30)
    ds_write_b128 v5, a[164:167] offset:17408
    s_waitcnt vmcnt(29)
    ds_write_b128 v5, a[168:171] offset:18432
    s_waitcnt vmcnt(28)
    ds_write_b128 v5, a[172:175] offset:19456
    s_waitcnt vmcnt(27)
    ds_write_b128 v5, a[176:179] offset:20480
    s_waitcnt vmcnt(26)
    ds_write_b128 v5, a[180:183] offset:21504
    s_waitcnt vmcnt(25)
    ds_write_b128 v5, a[184:187] offset:22528
    s_waitcnt vmcnt(24)
    ds_write_b128 v5, a[188:191] offset:23552
    s_waitcnt lgkmcnt(0)
    buffer_load_dwordx4 v[160:163], v2, s[28:31], s84 offen
    buffer_load_dwordx4 v[164:167], v3, s[28:31], s84 offen
    buffer_load_dwordx4 v[168:171], v4, s[28:31], s84 offen
    s_add_u32 s84, s84, 36864
    buffer_load_dwordx4 v[172:175], v2, s[28:31], s84 offen
    buffer_load_dwordx4 v[176:179], v3, s[28:31], s84 offen
    buffer_load_dwordx4 v[180:183], v4, s[28:31], s84 offen
    s_add_u32 s84, s84, 36864
    buffer_load_dwordx4 v[184:187], v2, s[28:31], s84 offen
    buffer_load_dwordx4 v[188:191], v3, s[28:31], s84 offen
    buffer_load_dwordx4 v[192:195], v4, s[28:31], s84 offen
    s_add_u32 s84, s84, 36864
    buffer_load_dwordx4 v[196:199], v2, s[28:31], s84 offen
    buffer_load_dwordx4 v[200:203], v3, s[28:31], s84 offen
    buffer_load_dwordx4 v[204:207], v4, s[28:31], s84 offen
    s_add_u32 s84, s84, 36864
    buffer_load_dwordx4 v[208:211], v2, s[28:31], s84 offen
    buffer_load_dwordx4 v[212:215], v3, s[28:31], s84 offen
    buffer_load_dwordx4 v[216:219], v4, s[28:31], s84 offen
    s_add_u32 s84, s84, 36864
    buffer_load_dwordx4 v[220:223], v2, s[28:31], s84 offen
    buffer_load_dwordx4 v[224:227], v3, s[28:31], s84 offen
    buffer_load_dwordx4 v[228:231], v4, s[28:31], s84 offen
    s_add_u32 s84, s84, 36864
    buffer_load_dwordx4 v[232:235], v2, s[28:31], s84 offen
    buffer_load_dwordx4 v[236:239], v3, s[28:31], s84 offen
    buffer_load_dwordx4 v[240:243], v4, s[28:31], s84 offen
    s_add_u32 s84, s84, 36864
    buffer_load_dwordx4 v[244:247], v2, s[28:31], s84 offen
    buffer_load_dwordx4 v[248:251], v3, s[28:31], s84 offen
    buffer_load_dwordx4 v[252:255], v4, s[28:31], s84 offen
    s_add_u32 s84, s84, 36864
    ds_read_b64_tr_b16 a[96:97], v6 offset:0
    ds_read_b64_tr_b16 a[98:99], v6 offset:1536
    ds_read_b64_tr_b16 a[100:101], v6 offset:32
    ds_read_b64_tr_b16 a[102:103], v6 offset:1568
    ds_read_b64_tr_b16 a[104:105], v6 offset:64
    ds_read_b64_tr_b16 a[106:107], v6 offset:1600
    ds_read_b64_tr_b16 a[108:109], v6 offset:3072
    ds_read_b64_tr_b16 a[110:111], v6 offset:4608
    ds_read_b64_tr_b16 a[112:113], v6 offset:3104
    ds_read_b64_tr_b16 a[114:115], v6 offset:4640
    ds_read_b64_tr_b16 a[116:117], v6 offset:3136
    ds_read_b64_tr_b16 a[118:119], v6 offset:4672
    ds_read_b64_tr_b16 a[120:121], v6 offset:6144
    ds_read_b64_tr_b16 a[122:123], v6 offset:7680
    ds_read_b64_tr_b16 a[124:125], v6 offset:6176
    ds_read_b64_tr_b16 a[126:127], v6 offset:7712
    ds_read_b64_tr_b16 a[128:129], v6 offset:6208
    ds_read_b64_tr_b16 a[130:131], v6 offset:7744
    ds_read_b64_tr_b16 a[132:133], v6 offset:9216
    ds_read_b64_tr_b16 a[134:135], v6 offset:10752
    ds_read_b64_tr_b16 a[136:137], v6 offset:9248
    ds_read_b64_tr_b16 a[138:139], v6 offset:10784
    ds_read_b64_tr_b16 a[140:141], v6 offset:9280
    ds_read_b64_tr_b16 a[142:143], v6 offset:10816
    ds_read_b64_tr_b16 a[144:145], v6 offset:12288
    ds_read_b64_tr_b16 a[146:147], v6 offset:13824
    ds_read_b64_tr_b16 a[148:149], v6 offset:12320
    ds_read_b64_tr_b16 a[150:151], v6 offset:13856
    ds_read_b64_tr_b16 a[152:153], v6 offset:12352
    ds_read_b64_tr_b16 a[154:155], v6 offset:13888
    ds_read_b64_tr_b16 a[156:157], v6 offset:15360
    ds_read_b64_tr_b16 a[158:159], v6 offset:16896
    ds_read_b64_tr_b16 a[160:161], v6 offset:15392
    ds_read_b64_tr_b16 a[162:163], v6 offset:16928
    ds_read_b64_tr_b16 a[164:165], v6 offset:15424
    ds_read_b64_tr_b16 a[166:167], v6 offset:16960
    ds_read_b64_tr_b16 a[168:169], v6 offset:18432
    ds_read_b64_tr_b16 a[170:171], v6 offset:19968
    ds_read_b64_tr_b16 a[172:173], v6 offset:18464
    ds_read_b64_tr_b16 a[174:175], v6 offset:20000
    ds_read_b64_tr_b16 a[176:177], v6 offset:18496
    ds_read_b64_tr_b16 a[178:179], v6 offset:20032
    ds_read_b64_tr_b16 a[180:181], v6 offset:21504
    ds_read_b64_tr_b16 a[182:183], v6 offset:23040
    ds_read_b64_tr_b16 a[184:185], v6 offset:21536
    ds_read_b64_tr_b16 a[186:187], v6 offset:23072
    ds_read_b64_tr_b16 a[188:189], v6 offset:21568
    ds_read_b64_tr_b16 a[190:191], v6 offset:23104
    s_waitcnt lgkmcnt(0)
    s_waitcnt vmcnt(47)
    ds_write_b128 v5, a[192:195] offset:0
    s_waitcnt vmcnt(46)
    ds_write_b128 v5, a[196:199] offset:1024
    s_waitcnt vmcnt(45)
    ds_write_b128 v5, a[200:203] offset:2048
    s_waitcnt vmcnt(44)
    ds_write_b128 v5, a[204:207] offset:3072
    s_waitcnt vmcnt(43)
    ds_write_b128 v5, a[208:211] offset:4096
    s_waitcnt vmcnt(42)
    ds_write_b128 v5, a[212:215] offset:5120
    s_waitcnt vmcnt(41)
    ds_write_b128 v5, a[216:219] offset:6144
    s_waitcnt vmcnt(40)
    ds_write_b128 v5, a[220:223] offset:7168
    s_waitcnt vmcnt(39)
    ds_write_b128 v5, a[224:227] offset:8192
    s_waitcnt vmcnt(38)
    ds_write_b128 v5, a[228:231] offset:9216
    s_waitcnt vmcnt(37)
    ds_write_b128 v5, a[232:235] offset:10240
    s_waitcnt vmcnt(36)
    ds_write_b128 v5, a[236:239] offset:11264
    s_waitcnt vmcnt(35)
    ds_write_b128 v5, a[240:243] offset:12288
    s_waitcnt vmcnt(34)
    ds_write_b128 v5, a[244:247] offset:13312
    s_waitcnt vmcnt(33)
    ds_write_b128 v5, a[248:251] offset:14336
    s_waitcnt vmcnt(32)
    ds_write_b128 v5, a[252:255] offset:15360
    s_waitcnt vmcnt(31)
    ds_write_b128 v5, v[128:131] offset:16384
    s_waitcnt vmcnt(30)
    ds_write_b128 v5, v[132:135] offset:17408
    s_waitcnt vmcnt(29)
    ds_write_b128 v5, v[136:139] offset:18432
    s_waitcnt vmcnt(28)
    ds_write_b128 v5, v[140:143] offset:19456
    s_waitcnt vmcnt(27)
    ds_write_b128 v5, v[144:147] offset:20480
    s_waitcnt vmcnt(26)
    ds_write_b128 v5, v[148:151] offset:21504
    s_waitcnt vmcnt(25)
    ds_write_b128 v5, v[152:155] offset:22528
    s_waitcnt vmcnt(24)
    ds_write_b128 v5, v[156:159] offset:23552
    s_waitcnt lgkmcnt(0)
    ds_read_b64_tr_b16 a[192:193], v6 offset:0
    ds_read_b64_tr_b16 a[194:195], v6 offset:1536
    ds_read_b64_tr_b16 a[196:197], v6 offset:32
    ds_read_b64_tr_b16 a[198:199], v6 offset:1568
    ds_read_b64_tr_b16 a[200:201], v6 offset:64
    ds_read_b64_tr_b16 a[202:203], v6 offset:1600
    ds_read_b64_tr_b16 a[204:205], v6 offset:3072
    ds_read_b64_tr_b16 a[206:207], v6 offset:4608
    ds_read_b64_tr_b16 a[208:209], v6 offset:3104
    ds_read_b64_tr_b16 a[210:211], v6 offset:4640
    ds_read_b64_tr_b16 a[212:213], v6 offset:3136
    ds_read_b64_tr_b16 a[214:215], v6 offset:4672
    ds_read_b64_tr_b16 a[216:217], v6 offset:6144
    ds_read_b64_tr_b16 a[218:219], v6 offset:7680
    ds_read_b64_tr_b16 a[220:221], v6 offset:6176
    ds_read_b64_tr_b16 a[222:223], v6 offset:7712
    ds_read_b64_tr_b16 a[224:225], v6 offset:6208
    ds_read_b64_tr_b16 a[226:227], v6 offset:7744
    ds_read_b64_tr_b16 a[228:229], v6 offset:9216
    ds_read_b64_tr_b16 a[230:231], v6 offset:10752
    ds_read_b64_tr_b16 a[232:233], v6 offset:9248
    ds_read_b64_tr_b16 a[234:235], v6 offset:10784
    ds_read_b64_tr_b16 a[236:237], v6 offset:9280
    ds_read_b64_tr_b16 a[238:239], v6 offset:10816
    ds_read_b64_tr_b16 a[240:241], v6 offset:12288
    ds_read_b64_tr_b16 a[242:243], v6 offset:13824
    ds_read_b64_tr_b16 a[244:245], v6 offset:12320
    ds_read_b64_tr_b16 a[246:247], v6 offset:13856
    ds_read_b64_tr_b16 a[248:249], v6 offset:12352
    ds_read_b64_tr_b16 a[250:251], v6 offset:13888
    ds_read_b64_tr_b16 a[252:253], v6 offset:15360
    ds_read_b64_tr_b16 a[254:255], v6 offset:16896
    ds_read_b64_tr_b16 v[128:129], v6 offset:15392
    ds_read_b64_tr_b16 v[130:131], v6 offset:16928
    ds_read_b64_tr_b16 v[132:133], v6 offset:15424
    ds_read_b64_tr_b16 v[134:135], v6 offset:16960
    ds_read_b64_tr_b16 v[136:137], v6 offset:18432
    ds_read_b64_tr_b16 v[138:139], v6 offset:19968
    ds_read_b64_tr_b16 v[140:141], v6 offset:18464
    ds_read_b64_tr_b16 v[142:143], v6 offset:20000
    ds_read_b64_tr_b16 v[144:145], v6 offset:18496
    ds_read_b64_tr_b16 v[146:147], v6 offset:20032
    ds_read_b64_tr_b16 v[148:149], v6 offset:21504
    ds_read_b64_tr_b16 v[150:151], v6 offset:23040
    ds_read_b64_tr_b16 v[152:153], v6 offset:21536
    ds_read_b64_tr_b16 v[154:155], v6 offset:23072
    ds_read_b64_tr_b16 v[156:157], v6 offset:21568
    ds_read_b64_tr_b16 v[158:159], v6 offset:23104
    s_waitcnt lgkmcnt(0)
    s_waitcnt vmcnt(23)
    ds_write_b128 v5, v[160:163] offset:0
    s_waitcnt vmcnt(22)
    ds_write_b128 v5, v[164:167] offset:1024
    s_waitcnt vmcnt(21)
    ds_write_b128 v5, v[168:171] offset:2048
    s_waitcnt vmcnt(20)
    ds_write_b128 v5, v[172:175] offset:3072
    s_waitcnt vmcnt(19)
    ds_write_b128 v5, v[176:179] offset:4096
    s_waitcnt vmcnt(18)
    ds_write_b128 v5, v[180:183] offset:5120
    s_waitcnt vmcnt(17)
    ds_write_b128 v5, v[184:187] offset:6144
    s_waitcnt vmcnt(16)
    ds_write_b128 v5, v[188:191] offset:7168
    s_waitcnt vmcnt(15)
    ds_write_b128 v5, v[192:195] offset:8192
    s_waitcnt vmcnt(14)
    ds_write_b128 v5, v[196:199] offset:9216
    s_waitcnt vmcnt(13)
    ds_write_b128 v5, v[200:203] offset:10240
    s_waitcnt vmcnt(12)
    ds_write_b128 v5, v[204:207] offset:11264
    s_waitcnt vmcnt(11)
    ds_write_b128 v5, v[208:211] offset:12288
    s_waitcnt vmcnt(10)
    ds_write_b128 v5, v[212:215] offset:13312
    s_waitcnt vmcnt(9)
    ds_write_b128 v5, v[216:219] offset:14336
    s_waitcnt vmcnt(8)
    ds_write_b128 v5, v[220:223] offset:15360
    s_waitcnt vmcnt(7)
    ds_write_b128 v5, v[224:227] offset:16384
    s_waitcnt vmcnt(6)
    ds_write_b128 v5, v[228:231] offset:17408
    s_waitcnt vmcnt(5)
    ds_write_b128 v5, v[232:235] offset:18432
    s_waitcnt vmcnt(4)
    ds_write_b128 v5, v[236:239] offset:19456
    s_waitcnt vmcnt(3)
    ds_write_b128 v5, v[240:243] offset:20480
    s_waitcnt vmcnt(2)
    ds_write_b128 v5, v[244:247] offset:21504
    s_waitcnt vmcnt(1)
    ds_write_b128 v5, v[248:251] offset:22528
    s_waitcnt vmcnt(0)
    ds_write_b128 v5, v[252:255] offset:23552
    s_waitcnt lgkmcnt(0)
    ds_read_b64_tr_b16 v[160:161], v6 offset:0
    ds_read_b64_tr_b16 v[162:163], v6 offset:1536
    ds_read_b64_tr_b16 v[164:165], v6 offset:32
    ds_read_b64_tr_b16 v[166:167], v6 offset:1568
    ds_read_b64_tr_b16 v[168:169], v6 offset:64
    ds_read_b64_tr_b16 v[170:171], v6 offset:1600
    ds_read_b64_tr_b16 v[172:173], v6 offset:3072
    ds_read_b64_tr_b16 v[174:175], v6 offset:4608
    ds_read_b64_tr_b16 v[176:177], v6 offset:3104
    ds_read_b64_tr_b16 v[178:179], v6 offset:4640
    ds_read_b64_tr_b16 v[180:181], v6 offset:3136
    ds_read_b64_tr_b16 v[182:183], v6 offset:4672
    ds_read_b64_tr_b16 v[184:185], v6 offset:6144
    ds_read_b64_tr_b16 v[186:187], v6 offset:7680
    ds_read_b64_tr_b16 v[188:189], v6 offset:6176
    ds_read_b64_tr_b16 v[190:191], v6 offset:7712
    ds_read_b64_tr_b16 v[192:193], v6 offset:6208
    ds_read_b64_tr_b16 v[194:195], v6 offset:7744
    ds_read_b64_tr_b16 v[196:197], v6 offset:9216
    ds_read_b64_tr_b16 v[198:199], v6 offset:10752
    ds_read_b64_tr_b16 v[200:201], v6 offset:9248
    ds_read_b64_tr_b16 v[202:203], v6 offset:10784
    ds_read_b64_tr_b16 v[204:205], v6 offset:9280
    ds_read_b64_tr_b16 v[206:207], v6 offset:10816
    ds_read_b64_tr_b16 v[208:209], v6 offset:12288
    ds_read_b64_tr_b16 v[210:211], v6 offset:13824
    ds_read_b64_tr_b16 v[212:213], v6 offset:12320
    ds_read_b64_tr_b16 v[214:215], v6 offset:13856
    ds_read_b64_tr_b16 v[216:217], v6 offset:12352
    ds_read_b64_tr_b16 v[218:219], v6 offset:13888
    ds_read_b64_tr_b16 v[220:221], v6 offset:15360
    ds_read_b64_tr_b16 v[222:223], v6 offset:16896
    ds_read_b64_tr_b16 v[224:225], v6 offset:15392
    ds_read_b64_tr_b16 v[226:227], v6 offset:16928
    ds_read_b64_tr_b16 v[228:229], v6 offset:15424
    ds_read_b64_tr_b16 v[230:231], v6 offset:16960
    ds_read_b64_tr_b16 v[232:233], v6 offset:18432
    ds_read_b64_tr_b16 v[234:235], v6 offset:19968
    ds_read_b64_tr_b16 v[236:237], v6 offset:18464
    ds_read_b64_tr_b16 v[238:239], v6 offset:20000
    ds_read_b64_tr_b16 v[240:241], v6 offset:18496
    ds_read_b64_tr_b16 v[242:243], v6 offset:20032
    ds_read_b64_tr_b16 v[244:245], v6 offset:21504
    ds_read_b64_tr_b16 v[246:247], v6 offset:23040
    ds_read_b64_tr_b16 v[248:249], v6 offset:21536
    ds_read_b64_tr_b16 v[250:251], v6 offset:23072
    ds_read_b64_tr_b16 v[252:253], v6 offset:21568
    ds_read_b64_tr_b16 v[254:255], v6 offset:23104
    s_waitcnt lgkmcnt(0)
    v_and_b32 v8, 15, v1
    v_lshrrev_b32 v9, 4, v1
    v_mul_u32_u24 v2, 1152, v8
    v_lshl_add_u32 v2, v9, 3, v2
    v_lshlrev_b32 v3, 1, v2
    s_mul_i32 s86, s3, 6144
    v_add_u32 v4, s86, v0
    s_min_u32 s86, s3, 2
    s_lshl_b32 s86, s86, 10
    v_add_u32 v5, s86, v0
    s_barrier
    s_nop 0
L_m_wfl:
    s_lshr_b32 s82, s98, 3
    s_mul_i32 s82, s82, 3
    s_lshr_b32 s84, s99, 2
    s_add_u32 s82, s82, s84
    s_lshl_b32 s82, s82, 7
    s_add_u32 s82, s82, 0x8303000
    v_mov_b32 v6, 0
    s_nop 1
L_wait_37:
    buffer_load_dword v7, v6, s[52:55], s82 offen offset:0 sc1
    s_waitcnt vmcnt(0)
    v_readfirstlane_b32 s83, v7
    s_nop 0
    s_cmp_ge_u32 s83, 4
    s_nop 2
    s_cbranch_scc1 L_waitok_38
    s_sleep 2
    s_sub_u32 s81, s81, 1
    s_cbranch_scc1 L_main_done
    s_branch L_wait_37
L_waitok_38:
    s_min_u32 s88, s3, 2
    s_lshl_b32 s88, s88, 5
    s_mul_i32 s89, s99, 96
    s_add_u32 s88, s88, s89
    s_mul_i32 s89, s98, 18432
    s_add_u32 s88, s88, s89
    s_lshl_b32 s89, s88, 1
    s_add_u32 s89, s89, 0x8800000
    buffer_load_dwordx2 v[20:21], v2, s[8:11], s88 offen
    s_add_u32 s90, s89, 0
    buffer_load_dwordx4 v[24:27], v3, s[52:55], s90 offen sc1
    s_add_u32 s90, s89, 4718592
    buffer_load_dwordx4 v[28:31], v3, s[52:55], s90 offen sc1
    s_add_u32 s90, s89, 9437184
    buffer_load_dwordx4 v[32:35], v3, s[52:55], s90 offen sc1
    s_add_u32 s90, s89, 14155776
    buffer_load_dwordx4 v[36:39], v3, s[52:55], s90 offen sc1
    s_lshl_b32 s84, s98, 17
    s_lshl_b32 s85, s3, 15
    s_add_u32 s84, s84, s85
    s_add_u32 s84, s84, 0x6000000
    s_lshr_b32 s82, s98, 1
    s_lshl_b32 s82, s82, 7
    s_lshl_b32 s85, s3, 5
    s_add_u32 s82, s82, s85
    s_add_u32 s82, s82, 0x8301000
    v_mov_b32 v6, 0
    s_nop 1
    s_waitcnt vmcnt(0)
L_wait_39:
    buffer_load_dword v7, v6, s[52:55], s82 offen offset:0 sc1
    s_waitcnt vmcnt(0)
    v_readfirstlane_b32 s83, v7
    s_nop 0
    s_cmp_ge_u32 s83, 8
    s_nop 2
    s_cbranch_scc1 L_waitok_40
    s_sleep 1
    s_sub_u32 s81, s81, 1
    s_cbranch_scc1 L_main_done
    s_branch L_wait_39
L_waitok_40:
    s_add_u32 s86, s84, 0
    buffer_load_dwordx4 v[40:43], v0, s[52:55], s86 offen offset:0 sc1
    buffer_load_dwordx4 v[44:47], v0, s[52:55], s86 offen offset:1024 sc1
    buffer_load_dwordx4 v[48:51], v0, s[52:55], s86 offen offset:2048 sc1
    buffer_load_dwordx4 v[52:55], v0, s[52:55], s86 offen offset:3072 sc1
    s_add_u32 s86, s84, 4096
    buffer_load_dwordx4 v[56:59], v0, s[52:55], s86 offen offset:0 sc1
    buffer_load_dwordx4 v[60:63], v0, s[52:55], s86 offen offset:1024 sc1
    buffer_load_dwordx4 v[64:67], v0, s[52:55], s86 offen offset:2048 sc1
    buffer_load_dwordx4 v[68:71], v0, s[52:55], s86 offen offset:3072 sc1
    s_add_u32 s86, s84, 8192
    buffer_load_dwordx4 v[72:75], v0, s[52:55], s86 offen offset:0 sc1
    buffer_load_dwordx4 v[76:79], v0, s[52:55], s86 offen offset:1024 sc1
    buffer_load_dwordx4 v[80:83], v0, s[52:55], s86 offen offset:2048 sc1
    buffer_load_dwordx4 v[84:87], v0, s[52:55], s86 offen offset:3072 sc1
    s_add_u32 s86, s84, 12288
    buffer_load_dwordx4 v[88:91], v0, s[52:55], s86 offen offset:0 sc1
    buffer_load_dwordx4 v[92:95], v0, s[52:55], s86 offen offset:1024 sc1
    buffer_load_dwordx4 v[96:99], v0, s[52:55], s86 offen offset:2048 sc1
    buffer_load_dwordx4 v[100:103], v0, s[52:55], s86 offen offset:3072 sc1
    s_add_u32 s86, s84, 16384
    buffer_load_dwordx4 v[104:107], v0, s[52:55], s86 offen offset:0 sc1
    buffer_load_dwordx4 v[108:111], v0, s[52:55], s86 offen offset:1024 sc1
    buffer_load_dwordx4 v[112:115], v0, s[52:55], s86 offen offset:2048 sc1
    buffer_load_dwordx4 v[116:119], v0, s[52:55], s86 offen offset:3072 sc1
    s_add_u32 s86, s84, 20480
    buffer_load_dwordx4 v[120:123], v0, s[52:55], s86 offen offset:0 sc1
    buffer_load_dwordx4 v[124:127], v0, s[52:55], s86 offen offset:1024 sc1
    s_waitcnt vmcnt(21)
    v_mfma_f32_16x16x32_bf16 v[8:11], a[0:3], v[40:43], 0
    v_mfma_f32_16x16x32_bf16 v[12:15], a[4:7], v[40:43], 0
    v_mfma_f32_16x16x32_bf16 v[16:19], a[8:11], v[40:43], 0
    s_add_u32 s86, s84, 20480
    buffer_load_dwordx4 v[40:43], v0, s[52:55], s86 offen offset:2048 sc1
    s_waitcnt vmcnt(21)
    v_mfma_f32_16x16x32_bf16 v[8:11], a[12:15], v[44:47], v[8:11]
    v_mfma_f32_16x16x32_bf16 v[12:15], a[16:19], v[44:47], v[12:15]
    v_mfma_f32_16x16x32_bf16 v[16:19], a[20:23], v[44:47], v[16:19]
    buffer_load_dwordx4 v[44:47], v0, s[52:55], s86 offen offset:3072 sc1
    s_waitcnt vmcnt(21)
    v_mfma_f32_16x16x32_bf16 v[8:11], a[24:27], v[48:51], v[8:11]
    v_mfma_f32_16x16x32_bf16 v[12:15], a[28:31], v[48:51], v[12:15]
    v_mfma_f32_16x16x32_bf16 v[16:19], a[32:35], v[48:51], v[16:19]
    s_add_u32 s86, s84, 24576
    buffer_load_dwordx4 v[48:51], v0, s[52:55], s86 offen offset:0 sc1
    s_waitcnt vmcnt(21)
    v_mfma_f32_16x16x32_bf16 v[8:11], a[36:39], v[52:55], v[8:11]
    v_mfma_f32_16x16x32_bf16 v[12:15], a[40:43], v[52:55], v[12:15]
    v_mfma_f32_16x16x32_bf16 v[16:19], a[44:47], v[52:55], v[16:19]
    buffer_load_dwordx4 v[52:55], v0, s[52:55], s86 offen offset:1024 sc1
    s_waitcnt vmcnt(21)
    v_mfma_f32_16x16x32_bf16 v[8:11], a[48:51], v[56:59], v[8:11]
    v_mfma_f32_16x16x32_bf16 v[12:15], a[52:55], v[56:59], v[12:15]
    v_mfma_f32_16x16x32_bf16 v[16:19], a[56:59], v[56:59], v[16:19]
    buffer_load_dwordx4 v[56:59], v0, s[52:55], s86 offen offset:2048 sc1
    s_waitcnt vmcnt(21)
    v_mfma_f32_16x16x32_bf16 v[8:11], a[60:63], v[60:63], v[8:11]
    v_mfma_f32_16x16x32_bf16 v[12:15], a[64:67], v[60:63], v[12:15]
    v_mfma_f32_16x16x32_bf16 v[16:19], a[68:71], v[60:63], v[16:19]
    buffer_load_dwordx4 v[60:63], v0, s[52:55], s86 offen offset:3072 sc1
    s_waitcnt vmcnt(21)
    v_mfma_f32_16x16x32_bf16 v[8:11], a[72:75], v[64:67], v[8:11]
    v_mfma_f32_16x16x32_bf16 v[12:15], a[76:79], v[64:67], v[12:15]
    v_mfma_f32_16x16x32_bf16 v[16:19], a[80:83], v[64:67], v[16:19]
    s_add_u32 s86, s84, 28672
    buffer_load_dwordx4 v[64:67], v0, s[52:55], s86 offen offset:0 sc1
    s_waitcnt vmcnt(21)
    v_mfma_f32_16x16x32_bf16 v[8:11], a[84:87], v[68:71], v[8:11]
    v_mfma_f32_16x16x32_bf16 v[12:15], a[88:91], v[68:71], v[12:15]
    v_mfma_f32_16x16x32_bf16 v[16:19], a[92:95], v[68:71], v[16:19]
    buffer_load_dwordx4 v[68:71], v0, s[52:55], s86 offen offset:1024 sc1
    s_waitcnt vmcnt(21)
    v_mfma_f32_16x16x32_bf16 v[8:11], a[96:99], v[72:75], v[8:11]
    v_mfma_f32_16x16x32_bf16 v[12:15], a[100:103], v[72:75], v[12:15]
    v_mfma_f32_16x16x32_bf16 v[16:19], a[104:107], v[72:75], v[16:19]
    buffer_load_dwordx4 v[72:75], v0, s[52:55], s86 offen offset:2048 sc1
    s_waitcnt vmcnt(21)
    v_mfma_f32_16x16x32_bf16 v[8:11], a[108:111], v[76:79], v[8:11]
    v_mfma_f32_16x16x32_bf16 v[12:15], a[112:115], v[76:79], v[12:15]
    v_mfma_f32_16x16x32_bf16 v[16:19], a[116:119], v[76:79], v[16:19]
    buffer_load_dwordx4 v[76:79], v0, s[52:55], s86 offen offset:3072 sc1
    s_waitcnt vmcnt(21)
    v_mfma_f32_16x16x32_bf16 v[8:11], a[120:123], v[80:83], v[8:11]
    v_mfma_f32_16x16x32_bf16 v[12:15], a[124:127], v[80:83], v[12:15]
    v_mfma_f32_16x16x32_bf16 v[16:19], a[128:131], v[80:83], v[16:19]
    s_waitcnt vmcnt(20)
    v_mfma_f32_16x16x32_bf16 v[8:11], a[132:135], v[84:87], v[8:11]
    v_mfma_f32_16x16x32_bf16 v[12:15], a[136:139], v[84:87], v[12:15]
    v_mfma_f32_16x16x32_bf16 v[16:19], a[140:143], v[84:87], v[16:19]
    s_waitcnt vmcnt(19)
    v_mfma_f32_16x16x32_bf16 v[8:11], a[144:147], v[88:91], v[8:11]
    v_mfma_f32_16x16x32_bf16 v[12:15], a[148:151], v[88:91], v[12:15]
    v_mfma_f32_16x16x32_bf16 v[16:19], a[152:155], v[88:91], v[16:19]
    s_waitcnt vmcnt(18)
    v_mfma_f32_16x16x32_bf16 v[8:11], a[156:159], v[92:95], v[8:11]
    v_mfma_f32_16x16x32_bf16 v[12:15], a[160:163], v[92:95], v[12:15]
    v_mfma_f32_16x16x32_bf16 v[16:19], a[164:167], v[92:95], v[16:19]
    s_waitcnt vmcnt(17)
    v_mfma_f32_16x16x32_bf16 v[8:11], a[168:171], v[96:99], v[8:11]
    v_mfma_f32_16x16x32_bf16 v[12:15], a[172:175], v[96:99], v[12:15]
    v_mfma_f32_16x16x32_bf16 v[16:19], a[176:179], v[96:99], v[16:19]
    s_waitcnt vmcnt(16)
    v_mfma_f32_16x16x32_bf16 v[8:11], a[180:183], v[100:103], v[8:11]
    v_mfma_f32_16x16x32_bf16 v[12:15], a[184:187], v[100:103], v[12:15]
    v_mfma_f32_16x16x32_bf16 v[16:19], a[188:191], v[100:103], v[16:19]
    s_waitcnt vmcnt(15)
    v_mfma_f32_16x16x32_bf16 v[8:11], a[192:195], v[104:107], v[8:11]
    v_mfma_f32_16x16x32_bf16 v[12:15], a[196:199], v[104:107], v[12:15]
    v_mfma_f32_16x16x32_bf16 v[16:19], a[200:203], v[104:107], v[16:19]
    s_waitcnt vmcnt(14)
    v_mfma_f32_16x16x32_bf16 v[8:11], a[204:207], v[108:111], v[8:11]
    v_mfma_f32_16x16x32_bf16 v[12:15], a[208:211], v[108:111], v[12:15]
    v_mfma_f32_16x16x32_bf16 v[16:19], a[212:215], v[108:111], v[16:19]
    s_waitcnt vmcnt(13)
    v_mfma_f32_16x16x32_bf16 v[8:11], a[216:219], v[112:115], v[8:11]
    v_mfma_f32_16x16x32_bf16 v[12:15], a[220:223], v[112:115], v[12:15]
    v_mfma_f32_16x16x32_bf16 v[16:19], a[224:227], v[112:115], v[16:19]
    s_waitcnt vmcnt(12)
    v_mfma_f32_16x16x32_bf16 v[8:11], a[228:231], v[116:119], v[8:11]
    v_mfma_f32_16x16x32_bf16 v[12:15], a[232:235], v[116:119], v[12:15]
    v_mfma_f32_16x16x32_bf16 v[16:19], a[236:239], v[116:119], v[16:19]
    s_waitcnt vmcnt(11)
    v_mfma_f32_16x16x32_bf16 v[8:11], a[240:243], v[120:123], v[8:11]
    v_mfma_f32_16x16x32_bf16 v[12:15], a[244:247], v[120:123], v[12:15]
    v_mfma_f32_16x16x32_bf16 v[16:19], a[248:251], v[120:123], v[16:19]
    s_waitcnt vmcnt(10)
    v_mfma_f32_16x16x32_bf16 v[8:11], a[252:255], v[124:127], v[8:11]
    v_mfma_f32_16x16x32_bf16 v[12:15], v[128:131], v[124:127], v[12:15]
    v_mfma_f32_16x16x32_bf16 v[16:19], v[132:135], v[124:127], v[16:19]
    s_waitcnt vmcnt(9)
    v_mfma_f32_16x16x32_bf16 v[8:11], v[136:139], v[40:43], v[8:11]
    v_mfma_f32_16x16x32_bf16 v[12:15], v[140:143], v[40:43], v[12:15]
    v_mfma_f32_16x16x32_bf16 v[16:19], v[144:147], v[40:43], v[16:19]
    s_waitcnt vmcnt(8)
    v_mfma_f32_16x16x32_bf16 v[8:11], v[148:151], v[44:47], v[8:11]
    v_mfma_f32_16x16x32_bf16 v[12:15], v[152:155], v[44:47], v[12:15]
    v_mfma_f32_16x16x32_bf16 v[16:19], v[156:159], v[44:47], v[16:19]
    s_waitcnt vmcnt(7)
    v_mfma_f32_16x16x32_bf16 v[8:11], v[160:163], v[48:51], v[8:11]
    v_mfma_f32_16x16x32_bf16 v[12:15], v[164:167], v[48:51], v[12:15]
    v_mfma_f32_16x16x32_bf16 v[16:19], v[168:171], v[48:51], v[16:19]
    s_waitcnt vmcnt(6)
    v_mfma_f32_16x16x32_bf16 v[8:11], v[172:175], v[52:55], v[8:11]
    v_mfma_f32_16x16x32_bf16 v[12:15], v[176:179], v[52:55], v[12:15]
    v_mfma_f32_16x16x32_bf16 v[16:19], v[180:183], v[52:55], v[16:19]
    s_waitcnt vmcnt(5)
    v_mfma_f32_16x16x32_bf16 v[8:11], v[184:187], v[56:59], v[8:11]
    v_mfma_f32_16x16x32_bf16 v[12:15], v[188:191], v[56:59], v[12:15]
    v_mfma_f32_16x16x32_bf16 v[16:19], v[192:195], v[56:59], v[16:19]
    s_waitcnt vmcnt(4)
    v_mfma_f32_16x16x32_bf16 v[8:11], v[196:199], v[60:63], v[8:11]
    v_mfma_f32_16x16x32_bf16 v[12:15], v[200:203], v[60:63], v[12:15]
    v_mfma_f32_16x16x32_bf16 v[16:19], v[204:207], v[60:63], v[16:19]
    s_waitcnt vmcnt(3)
    v_mfma_f32_16x16x32_bf16 v[8:11], v[208:211], v[64:67], v[8:11]
    v_mfma_f32_16x16x32_bf16 v[12:15], v[212:215], v[64:67], v[12:15]
    v_mfma_f32_16x16x32_bf16 v[16:19], v[216:219], v[64:67], v[16:19]
    s_waitcnt vmcnt(2)
    v_mfma_f32_16x16x32_bf16 v[8:11], v[220:223], v[68:71], v[8:11]
    v_mfma_f32_16x16x32_bf16 v[12:15], v[224:227], v[68:71], v[12:15]
    v_mfma_f32_16x16x32_bf16 v[16:19], v[228:231], v[68:71], v[16:19]
    s_waitcnt vmcnt(1)
    v_mfma_f32_16x16x32_bf16 v[8:11], v[232:235], v[72:75], v[8:11]
    v_mfma_f32_16x16x32_bf16 v[12:15], v[236:239], v[72:75], v[12:15]
    v_mfma_f32_16x16x32_bf16 v[16:19], v[240:243], v[72:75], v[16:19]
    s_waitcnt vmcnt(0)
    v_mfma_f32_16x16x32_bf16 v[8:11], v[244:247], v[76:79], v[8:11]
    v_mfma_f32_16x16x32_bf16 v[12:15], v[248:251], v[76:79], v[12:15]
    v_mfma_f32_16x16x32_bf16 v[16:19], v[252:255], v[76:79], v[16:19]
    s_nop 5
    ds_write_b128 v4, v[8:11] offset:0
    ds_write_b128 v4, v[12:15] offset:1024
    ds_write_b128 v4, v[16:19] offset:2048
    v_add_f32 v24, v24, v28
    v_add_f32 v32, v32, v36
    v_add_f32 v24, v24, v32
    v_add_f32 v25, v25, v29
    v_add_f32 v33, v33, v37
    v_add_f32 v25, v25, v33
    v_add_f32 v26, v26, v30
    v_add_f32 v34, v34, v38
    v_add_f32 v26, v26, v34
    v_add_f32 v27, v27, v31
    v_add_f32 v35, v35, v39
    v_add_f32 v27, v27, v35
    s_waitcnt lgkmcnt(0)
    s_barrier
    ds_read_b128 v[64:67], v5 offset:0
    ds_read_b128 v[68:71], v5 offset:6144
    ds_read_b128 v[72:75], v5 offset:12288
    ds_read_b128 v[76:79], v5 offset:18432
    s_waitcnt lgkmcnt(2)
    v_add_f32 v64, v64, v68
    s_waitcnt lgkmcnt(0)
    v_add_f32 v72, v72, v76
    v_add_f32 v64, v64, v72
    v_add_f32 v65, v65, v69
    v_add_f32 v73, v73, v77
    v_add_f32 v65, v65, v73
    v_add_f32 v66, v66, v70
    v_add_f32 v74, v74, v78
    v_add_f32 v66, v66, v74
    v_add_f32 v67, v67, v71
    v_add_f32 v75, v75, v79
    v_add_f32 v67, v67, v75
    v_cvt_pk_bf16_f32 v96, v64, v65
    v_cvt_pk_bf16_f32 v97, v24, v25
    v_lshlrev_b32 v98, 16, v96
    v_and_b32 v99, 0xffff0000, v96
    v_lshlrev_b32 v100, 16, v20
    v_and_b32 v101, 0xffff0000, v20
    v_add_f32 v98, v98, v100
    v_add_f32 v99, v99, v101
    v_cvt_pk_bf16_f32 v96, v98, v99
    v_lshlrev_b32 v98, 16, v96
    v_and_b32 v99, 0xffff0000, v96
    v_lshlrev_b32 v100, 16, v97
    v_and_b32 v101, 0xffff0000, v97
    v_add_f32 v98, v98, v100
    v_add_f32 v99, v99, v101
    v_cvt_pk_bf16_f32 v104, v98, v99
    v_cvt_pk_bf16_f32 v96, v66, v67
    v_cvt_pk_bf16_f32 v97, v26, v27
    v_lshlrev_b32 v98, 16, v96
    v_and_b32 v99, 0xffff0000, v96
    v_lshlrev_b32 v100, 16, v21
    v_and_b32 v101, 0xffff0000, v21
    v_add_f32 v98, v98, v100
    v_add_f32 v99, v99, v101
    v_cvt_pk_bf16_f32 v96, v98, v99
    v_lshlrev_b32 v98, 16, v96
    v_and_b32 v99, 0xffff0000, v96
    v_lshlrev_b32 v100, 16, v97
    v_and_b32 v101, 0xffff0000, v97
    v_add_f32 v98, v98, v100
    v_add_f32 v99, v99, v101
    v_cvt_pk_bf16_f32 v105, v98, v99
    s_cmp_eq_u32 s3, 3
    s_nop 0
    s_cbranch_scc1 L_wf_skipma
    buffer_store_dwordx2 v[104:105], v2, s[44:47], s88 offen
L_wf_skipma:
    s_add_u32 s98, s98, s100
    s_cmp_ge_u32 s98, s101
    s_cbranch_scc1 L_m_wfe
    s_lshr_b32 s82, s98, 3
    s_mul_i32 s82, s82, 3
    s_lshr_b32 s84, s99, 2
    s_add_u32 s82, s82, s84
    s_lshl_b32 s82, s82, 7
    s_add_u32 s82, s82, 0x8303000
    v_mov_b32 v6, 0
    s_nop 1
L_wait_41:
    buffer_load_dword v7, v6, s[52:55], s82 offen offset:0 sc1
    s_waitcnt vmcnt(0)
    v_readfirstlane_b32 s83, v7
    s_nop 0
    s_cmp_ge_u32 s83, 4
    s_nop 2
    s_cbranch_scc1 L_waitok_42
    s_sleep 2
    s_sub_u32 s81, s81, 1
    s_cbranch_scc1 L_main_done
    s_branch L_wait_41
L_waitok_42:
    s_min_u32 s88, s3, 2
    s_lshl_b32 s88, s88, 5
    s_mul_i32 s89, s99, 96
    s_add_u32 s88, s88, s89
    s_mul_i32 s89, s98, 18432
    s_add_u32 s88, s88, s89
    s_lshl_b32 s89, s88, 1
    s_add_u32 s89, s89, 0x8800000
    buffer_load_dwordx2 v[20:21], v2, s[8:11], s88 offen
    s_add_u32 s90, s89, 0
    buffer_load_dwordx4 v[24:27], v3, s[52:55], s90 offen sc1
    s_add_u32 s90, s89, 4718592
    buffer_load_dwordx4 v[28:31], v3, s[52:55], s90 offen sc1
    s_add_u32 s90, s89, 9437184
    buffer_load_dwordx4 v[32:35], v3, s[52:55], s90 offen sc1
    s_add_u32 s90, s89, 14155776
    buffer_load_dwordx4 v[36:39], v3, s[52:55], s90 offen sc1
    s_lshl_b32 s84, s98, 17
    s_lshl_b32 s85, s3, 15
    s_add_u32 s84, s84, s85
    s_add_u32 s84, s84, 0x6000000
    s_lshr_b32 s82, s98, 1
    s_lshl_b32 s82, s82, 7
    s_lshl_b32 s85, s3, 5
    s_add_u32 s82, s82, s85
    s_add_u32 s82, s82, 0x8301000
    v_mov_b32 v6, 0
    s_nop 1
    s_waitcnt vmcnt(0)
L_wait_43:
    buffer_load_dword v7, v6, s[52:55], s82 offen offset:0 sc1
    s_waitcnt vmcnt(0)
    v_readfirstlane_b32 s83, v7
    s_nop 0
    s_cmp_ge_u32 s83, 8
    s_nop 2
    s_cbranch_scc1 L_waitok_44
    s_sleep 1
    s_sub_u32 s81, s81, 1
    s_cbranch_scc1 L_main_done
    s_branch L_wait_43
L_waitok_44:
    s_add_u32 s86, s84, 0
    buffer_load_dwordx4 v[40:43], v0, s[52:55], s86 offen offset:0 sc1
    buffer_load_dwordx4 v[44:47], v0, s[52:55], s86 offen offset:1024 sc1
    buffer_load_dwordx4 v[48:51], v0, s[52:55], s86 offen offset:2048 sc1
    buffer_load_dwordx4 v[52:55], v0, s[52:55], s86 offen offset:3072 sc1
    s_add_u32 s86, s84, 4096
    buffer_load_dwordx4 v[56:59], v0, s[52:55], s86 offen offset:0 sc1
    buffer_load_dwordx4 v[60:63], v0, s[52:55], s86 offen offset:1024 sc1
    buffer_load_dwordx4 v[64:67], v0, s[52:55], s86 offen offset:2048 sc1
    buffer_load_dwordx4 v[68:71], v0, s[52:55], s86 offen offset:3072 sc1
    s_add_u32 s86, s84, 8192
    buffer_load_dwordx4 v[72:75], v0, s[52:55], s86 offen offset:0 sc1
    buffer_load_dwordx4 v[76:79], v0, s[52:55], s86 offen offset:1024 sc1
    buffer_load_dwordx4 v[80:83], v0, s[52:55], s86 offen offset:2048 sc1
    buffer_load_dwordx4 v[84:87], v0, s[52:55], s86 offen offset:3072 sc1
    s_add_u32 s86, s84, 12288
    buffer_load_dwordx4 v[88:91], v0, s[52:55], s86 offen offset:0 sc1
    buffer_load_dwordx4 v[92:95], v0, s[52:55], s86 offen offset:1024 sc1
    buffer_load_dwordx4 v[96:99], v0, s[52:55], s86 offen offset:2048 sc1
    buffer_load_dwordx4 v[100:103], v0, s[52:55], s86 offen offset:3072 sc1
    s_add_u32 s86, s84, 16384
    buffer_load_dwordx4 v[104:107], v0, s[52:55], s86 offen offset:0 sc1
    buffer_load_dwordx4 v[108:111], v0, s[52:55], s86 offen offset:1024 sc1
    buffer_load_dwordx4 v[112:115], v0, s[52:55], s86 offen offset:2048 sc1
    buffer_load_dwordx4 v[116:119], v0, s[52:55], s86 offen offset:3072 sc1
    s_add_u32 s86, s84, 20480
    buffer_load_dwordx4 v[120:123], v0, s[52:55], s86 offen offset:0 sc1
    buffer_load_dwordx4 v[124:127], v0, s[52:55], s86 offen offset:1024 sc1
    s_waitcnt vmcnt(21)
    v_mfma_f32_16x16x32_bf16 v[8:11], a[0:3], v[40:43], 0
    v_mfma_f32_16x16x32_bf16 v[12:15], a[4:7], v[40:43], 0
    v_mfma_f32_16x16x32_bf16 v[16:19], a[8:11], v[40:43], 0
    s_add_u32 s86, s84, 20480
    buffer_load_dwordx4 v[40:43], v0, s[52:55], s86 offen offset:2048 sc1
    s_waitcnt vmcnt(21)
    v_mfma_f32_16x16x32_bf16 v[8:11], a[12:15], v[44:47], v[8:11]
    v_mfma_f32_16x16x32_bf16 v[12:15], a[16:19], v[44:47], v[12:15]
    v_mfma_f32_16x16x32_bf16 v[16:19], a[20:23], v[44:47], v[16:19]
    buffer_load_dwordx4 v[44:47], v0, s[52:55], s86 offen offset:3072 sc1
    s_waitcnt vmcnt(21)
    v_mfma_f32_16x16x32_bf16 v[8:11], a[24:27], v[48:51], v[8:11]
    v_mfma_f32_16x16x32_bf16 v[12:15], a[28:31], v[48:51], v[12:15]
    v_mfma_f32_16x16x32_bf16 v[16:19], a[32:35], v[48:51], v[16:19]
    s_add_u32 s86, s84, 24576
    buffer_load_dwordx4 v[48:51], v0, s[52:55], s86 offen offset:0 sc1
    s_waitcnt vmcnt(21)
    v_mfma_f32_16x16x32_bf16 v[8:11], a[36:39], v[52:55], v[8:11]
    v_mfma_f32_16x16x32_bf16 v[12:15], a[40:43], v[52:55], v[12:15]
    v_mfma_f32_16x16x32_bf16 v[16:19], a[44:47], v[52:55], v[16:19]
    buffer_load_dwordx4 v[52:55], v0, s[52:55], s86 offen offset:1024 sc1
    s_waitcnt vmcnt(21)
    v_mfma_f32_16x16x32_bf16 v[8:11], a[48:51], v[56:59], v[8:11]
    v_mfma_f32_16x16x32_bf16 v[12:15], a[52:55], v[56:59], v[12:15]
    v_mfma_f32_16x16x32_bf16 v[16:19], a[56:59], v[56:59], v[16:19]
    buffer_load_dwordx4 v[56:59], v0, s[52:55], s86 offen offset:2048 sc1
    s_waitcnt vmcnt(21)
    v_mfma_f32_16x16x32_bf16 v[8:11], a[60:63], v[60:63], v[8:11]
    v_mfma_f32_16x16x32_bf16 v[12:15], a[64:67], v[60:63], v[12:15]
    v_mfma_f32_16x16x32_bf16 v[16:19], a[68:71], v[60:63], v[16:19]
    buffer_load_dwordx4 v[60:63], v0, s[52:55], s86 offen offset:3072 sc1
    s_waitcnt vmcnt(21)
    v_mfma_f32_16x16x32_bf16 v[8:11], a[72:75], v[64:67], v[8:11]
    v_mfma_f32_16x16x32_bf16 v[12:15], a[76:79], v[64:67], v[12:15]
    v_mfma_f32_16x16x32_bf16 v[16:19], a[80:83], v[64:67], v[16:19]
    s_add_u32 s86, s84, 28672
    buffer_load_dwordx4 v[64:67], v0, s[52:55], s86 offen offset:0 sc1
    s_waitcnt vmcnt(21)
    v_mfma_f32_16x16x32_bf16 v[8:11], a[84:87], v[68:71], v[8:11]
    v_mfma_f32_16x16x32_bf16 v[12:15], a[88:91], v[68:71], v[12:15]
    v_mfma_f32_16x16x32_bf16 v[16:19], a[92:95], v[68:71], v[16:19]
    buffer_load_dwordx4 v[68:71], v0, s[52:55], s86 offen offset:1024 sc1
    s_waitcnt vmcnt(21)
    v_mfma_f32_16x16x32_bf16 v[8:11], a[96:99], v[72:75], v[8:11]
    v_mfma_f32_16x16x32_bf16 v[12:15], a[100:103], v[72:75], v[12:15]
    v_mfma_f32_16x16x32_bf16 v[16:19], a[104:107], v[72:75], v[16:19]
    buffer_load_dwordx4 v[72:75], v0, s[52:55], s86 offen offset:2048 sc1
    s_waitcnt vmcnt(21)
    v_mfma_f32_16x16x32_bf16 v[8:11], a[108:111], v[76:79], v[8:11]
    v_mfma_f32_16x16x32_bf16 v[12:15], a[112:115], v[76:79], v[12:15]
    v_mfma_f32_16x16x32_bf16 v[16:19], a[116:119], v[76:79], v[16:19]
    buffer_load_dwordx4 v[76:79], v0, s[52:55], s86 offen offset:3072 sc1
    s_waitcnt vmcnt(21)
    v_mfma_f32_16x16x32_bf16 v[8:11], a[120:123], v[80:83], v[8:11]
    v_mfma_f32_16x16x32_bf16 v[12:15], a[124:127], v[80:83], v[12:15]
    v_mfma_f32_16x16x32_bf16 v[16:19], a[128:131], v[80:83], v[16:19]
    s_waitcnt vmcnt(20)
    v_mfma_f32_16x16x32_bf16 v[8:11], a[132:135], v[84:87], v[8:11]
    v_mfma_f32_16x16x32_bf16 v[12:15], a[136:139], v[84:87], v[12:15]
    v_mfma_f32_16x16x32_bf16 v[16:19], a[140:143], v[84:87], v[16:19]
    s_waitcnt vmcnt(19)
    v_mfma_f32_16x16x32_bf16 v[8:11], a[144:147], v[88:91], v[8:11]
    v_mfma_f32_16x16x32_bf16 v[12:15], a[148:151], v[88:91], v[12:15]
    v_mfma_f32_16x16x32_bf16 v[16:19], a[152:155], v[88:91], v[16:19]
    s_waitcnt vmcnt(18)
    v_mfma_f32_16x16x32_bf16 v[8:11], a[156:159], v[92:95], v[8:11]
    v_mfma_f32_16x16x32_bf16 v[12:15], a[160:163], v[92:95], v[12:15]
    v_mfma_f32_16x16x32_bf16 v[16:19], a[164:167], v[92:95], v[16:19]
    s_waitcnt vmcnt(17)
    v_mfma_f32_16x16x32_bf16 v[8:11], a[168:171], v[96:99], v[8:11]
    v_mfma_f32_16x16x32_bf16 v[12:15], a[172:175], v[96:99], v[12:15]
    v_mfma_f32_16x16x32_bf16 v[16:19], a[176:179], v[96:99], v[16:19]
    s_waitcnt vmcnt(16)
    v_mfma_f32_16x16x32_bf16 v[8:11], a[180:183], v[100:103], v[8:11]
    v_mfma_f32_16x16x32_bf16 v[12:15], a[184:187], v[100:103], v[12:15]
    v_mfma_f32_16x16x32_bf16 v[16:19], a[188:191], v[100:103], v[16:19]
    s_waitcnt vmcnt(15)
    v_mfma_f32_16x16x32_bf16 v[8:11], a[192:195], v[104:107], v[8:11]
    v_mfma_f32_16x16x32_bf16 v[12:15], a[196:199], v[104:107], v[12:15]
    v_mfma_f32_16x16x32_bf16 v[16:19], a[200:203], v[104:107], v[16:19]
    s_waitcnt vmcnt(14)
    v_mfma_f32_16x16x32_bf16 v[8:11], a[204:207], v[108:111], v[8:11]
    v_mfma_f32_16x16x32_bf16 v[12:15], a[208:211], v[108:111], v[12:15]
    v_mfma_f32_16x16x32_bf16 v[16:19], a[212:215], v[108:111], v[16:19]
    s_waitcnt vmcnt(13)
    v_mfma_f32_16x16x32_bf16 v[8:11], a[216:219], v[112:115], v[8:11]
    v_mfma_f32_16x16x32_bf16 v[12:15], a[220:223], v[112:115], v[12:15]
    v_mfma_f32_16x16x32_bf16 v[16:19], a[224:227], v[112:115], v[16:19]
    s_waitcnt vmcnt(12)
    v_mfma_f32_16x16x32_bf16 v[8:11], a[228:231], v[116:119], v[8:11]
    v_mfma_f32_16x16x32_bf16 v[12:15], a[232:235], v[116:119], v[12:15]
    v_mfma_f32_16x16x32_bf16 v[16:19], a[236:239], v[116:119], v[16:19]
    s_waitcnt vmcnt(11)
    v_mfma_f32_16x16x32_bf16 v[8:11], a[240:243], v[120:123], v[8:11]
    v_mfma_f32_16x16x32_bf16 v[12:15], a[244:247], v[120:123], v[12:15]
    v_mfma_f32_16x16x32_bf16 v[16:19], a[248:251], v[120:123], v[16:19]
    s_waitcnt vmcnt(10)
    v_mfma_f32_16x16x32_bf16 v[8:11], a[252:255], v[124:127], v[8:11]
    v_mfma_f32_16x16x32_bf16 v[12:15], v[128:131], v[124:127], v[12:15]
    v_mfma_f32_16x16x32_bf16 v[16:19], v[132:135], v[124:127], v[16:19]
    s_waitcnt vmcnt(9)
    v_mfma_f32_16x16x32_bf16 v[8:11], v[136:139], v[40:43], v[8:11]
    v_mfma_f32_16x16x32_bf16 v[12:15], v[140:143], v[40:43], v[12:15]
    v_mfma_f32_16x16x32_bf16 v[16:19], v[144:147], v[40:43], v[16:19]
    s_waitcnt vmcnt(8)
    v_mfma_f32_16x16x32_bf16 v[8:11], v[148:151], v[44:47], v[8:11]
    v_mfma_f32_16x16x32_bf16 v[12:15], v[152:155], v[44:47], v[12:15]
    v_mfma_f32_16x16x32_bf16 v[16:19], v[156:159], v[44:47], v[16:19]
    s_waitcnt vmcnt(7)
    v_mfma_f32_16x16x32_bf16 v[8:11], v[160:163], v[48:51], v[8:11]
    v_mfma_f32_16x16x32_bf16 v[12:15], v[164:167], v[48:51], v[12:15]
    v_mfma_f32_16x16x32_bf16 v[16:19], v[168:171], v[48:51], v[16:19]
    s_waitcnt vmcnt(6)
    v_mfma_f32_16x16x32_bf16 v[8:11], v[172:175], v[52:55], v[8:11]
    v_mfma_f32_16x16x32_bf16 v[12:15], v[176:179], v[52:55], v[12:15]
    v_mfma_f32_16x16x32_bf16 v[16:19], v[180:183], v[52:55], v[16:19]
    s_waitcnt vmcnt(5)
    v_mfma_f32_16x16x32_bf16 v[8:11], v[184:187], v[56:59], v[8:11]
    v_mfma_f32_16x16x32_bf16 v[12:15], v[188:191], v[56:59], v[12:15]
    v_mfma_f32_16x16x32_bf16 v[16:19], v[192:195], v[56:59], v[16:19]
    s_waitcnt vmcnt(4)
    v_mfma_f32_16x16x32_bf16 v[8:11], v[196:199], v[60:63], v[8:11]
    v_mfma_f32_16x16x32_bf16 v[12:15], v[200:203], v[60:63], v[12:15]
    v_mfma_f32_16x16x32_bf16 v[16:19], v[204:207], v[60:63], v[16:19]
    s_waitcnt vmcnt(3)
    v_mfma_f32_16x16x32_bf16 v[8:11], v[208:211], v[64:67], v[8:11]
    v_mfma_f32_16x16x32_bf16 v[12:15], v[212:215], v[64:67], v[12:15]
    v_mfma_f32_16x16x32_bf16 v[16:19], v[216:219], v[64:67], v[16:19]
    s_waitcnt vmcnt(2)
    v_mfma_f32_16x16x32_bf16 v[8:11], v[220:223], v[68:71], v[8:11]
    v_mfma_f32_16x16x32_bf16 v[12:15], v[224:227], v[68:71], v[12:15]
    v_mfma_f32_16x16x32_bf16 v[16:19], v[228:231], v[68:71], v[16:19]
    s_waitcnt vmcnt(1)
    v_mfma_f32_16x16x32_bf16 v[8:11], v[232:235], v[72:75], v[8:11]
    v_mfma_f32_16x16x32_bf16 v[12:15], v[236:239], v[72:75], v[12:15]
    v_mfma_f32_16x16x32_bf16 v[16:19], v[240:243], v[72:75], v[16:19]
    s_waitcnt vmcnt(0)
    v_mfma_f32_16x16x32_bf16 v[8:11], v[244:247], v[76:79], v[8:11]
    v_mfma_f32_16x16x32_bf16 v[12:15], v[248:251], v[76:79], v[12:15]
    v_mfma_f32_16x16x32_bf16 v[16:19], v[252:255], v[76:79], v[16:19]
    s_nop 5
    ds_write_b128 v4, v[8:11] offset:24576
    ds_write_b128 v4, v[12:15] offset:25600
    ds_write_b128 v4, v[16:19] offset:26624
    v_add_f32 v24, v24, v28
    v_add_f32 v32, v32, v36
    v_add_f32 v24, v24, v32
    v_add_f32 v25, v25, v29
    v_add_f32 v33, v33, v37
    v_add_f32 v25, v25, v33
    v_add_f32 v26, v26, v30
    v_add_f32 v34, v34, v38
    v_add_f32 v26, v26, v34
    v_add_f32 v27, v27, v31
    v_add_f32 v35, v35, v39
    v_add_f32 v27, v27, v35
    s_waitcnt lgkmcnt(0)
    s_barrier
    ds_read_b128 v[64:67], v5 offset:24576
    ds_read_b128 v[68:71], v5 offset:30720
    ds_read_b128 v[72:75], v5 offset:36864
    ds_read_b128 v[76:79], v5 offset:43008
    s_waitcnt lgkmcnt(2)
    v_add_f32 v64, v64, v68
    s_waitcnt lgkmcnt(0)
    v_add_f32 v72, v72, v76
    v_add_f32 v64, v64, v72
    v_add_f32 v65, v65, v69
    v_add_f32 v73, v73, v77
    v_add_f32 v65, v65, v73
    v_add_f32 v66, v66, v70
    v_add_f32 v74, v74, v78
    v_add_f32 v66, v66, v74
    v_add_f32 v67, v67, v71
    v_add_f32 v75, v75, v79
    v_add_f32 v67, v67, v75
    v_cvt_pk_bf16_f32 v96, v64, v65
    v_cvt_pk_bf16_f32 v97, v24, v25
    v_lshlrev_b32 v98, 16, v96
    v_and_b32 v99, 0xffff0000, v96
    v_lshlrev_b32 v100, 16, v20
    v_and_b32 v101, 0xffff0000, v20
    v_add_f32 v98, v98, v100
    v_add_f32 v99, v99, v101
    v_cvt_pk_bf16_f32 v96, v98, v99
    v_lshlrev_b32 v98, 16, v96
    v_and_b32 v99, 0xffff0000, v96
    v_lshlrev_b32 v100, 16, v97
    v_and_b32 v101, 0xffff0000, v97
    v_add_f32 v98, v98, v100
    v_add_f32 v99, v99, v101
    v_cvt_pk_bf16_f32 v104, v98, v99
    v_cvt_pk_bf16_f32 v96, v66, v67
    v_cvt_pk_bf16_f32 v97, v26, v27
    v_lshlrev_b32 v98, 16, v96
    v_and_b32 v99, 0xffff0000, v96
    v_lshlrev_b32 v100, 16, v21
    v_and_b32 v101, 0xffff0000, v21
    v_add_f32 v98, v98, v100
    v_add_f32 v99, v99, v101
    v_cvt_pk_bf16_f32 v96, v98, v99
    v_lshlrev_b32 v98, 16, v96
    v_and_b32 v99, 0xffff0000, v96
    v_lshlrev_b32 v100, 16, v97
    v_and_b32 v101, 0xffff0000, v97
    v_add_f32 v98, v98, v100
    v_add_f32 v99, v99, v101
    v_cvt_pk_bf16_f32 v105, v98, v99
    s_cmp_eq_u32 s3, 3
    s_nop 0
    s_cbranch_scc1 L_wf_skipmb
    buffer_store_dwordx2 v[104:105], v2, s[44:47], s88 offen
L_wf_skipmb:
    s_add_u32 s98, s98, s100
    s_cmp_lt_u32 s98, s101
    s_cbranch_scc1 L_m_wfl
L_m_wfe:
L_main_done:
    s_endpgm
.section .rodata,"a"
.p2align 6
.amdhsa_kernel parallel_sum__memory_aug_recurrent_mem_tr__glu_gated_geglu__prompt_kernel
  .amdhsa_next_free_vgpr 512
  .amdhsa_next_free_sgpr 102
  .amdhsa_accum_offset 256
  .amdhsa_group_segment_fixed_size 0
  .amdhsa_kernarg_size 112
  .amdhsa_user_sgpr_count 2
  .amdhsa_user_sgpr_kernarg_segment_ptr 1
  .amdhsa_system_sgpr_workgroup_id_x 1
  .amdhsa_float_denorm_mode_32 3
.end_amdhsa_kernel
```
